```python
import torch

def _softmax(x, axis=-1):
    return torch.softmax(x, dim=axis)
def _gelu(x):
    return torch.nn.functional.gelu(x, approximate="tanh")
def _silu(x):
    return torch.nn.functional.silu(x)
def _sigmoid(x):
    return torch.sigmoid(x)
def _layernorm(x, axis=-1, eps=1e-5):
    m = x.mean(dim=axis, keepdim=True)
    v = x.var(dim=axis, keepdim=True, unbiased=False)
    return (x - m) / torch.sqrt(v + eps)
def _scatter_add(tgt, idx, src, axis=0):
    return tgt.clone().index_add_(axis, idx, src)
def _segment_sum(src, seg, n):
    out = torch.zeros((n,) + src.shape[1:], dtype=src.dtype)
    return out.index_add_(0, seg, src)
def _pad(x, pw):
    flat = tuple(v for pair in reversed(pw) for v in pair)
    return torch.nn.functional.pad(x, flat)

kernel_name = 'parallel_sum__linear_kernel_hedgehog__geglu_ffn__prompt'

def setup_inputs():

    _w = (lambda a: (lambda t: t.to(torch.bfloat16) if t.is_floating_point() else t)(torch.as_tensor(a)))
    def _A_setup():
        B, S, D, H = 1, 2048, 448, 16
        Dh = D // H
        return {
            "x": _w((lambda *s: torch.randn(*s, dtype=torch.bfloat16) * 0.05)(B, S, D)),
            "wqkv": _w((lambda *s: torch.randn(*s, dtype=torch.bfloat16) * 0.8)(D, 3 * D)),
            "w_phi": _w((lambda *s: torch.randn(*s, dtype=torch.bfloat16) * 0.8)(H, Dh, Dh) * (Dh ** -0.5)),
            "wo": _w((lambda *s: torch.randn(*s, dtype=torch.bfloat16) * 0.2)(D, D)),
        }
    _A_in = _A_setup()

    def _B_setup():
        B, S, D, F = 1, 2048, 448, 1792
        return {
            "x": _w((lambda *s: torch.randn(*s, dtype=torch.bfloat16) * 0.05)(B, S, D)),
            "w_gate": _w((lambda *s: torch.randn(*s, dtype=torch.bfloat16) * 0.1)(D, F)),
            "w_up": _w((lambda *s: torch.randn(*s, dtype=torch.bfloat16) * 0.1)(D, F)),
            "w_down": _w((lambda *s: torch.randn(*s, dtype=torch.bfloat16) * 0.1)(F, D)),
        }
    _B_in = _B_setup()

    return {
        "A_x": _A_in["x"],
        "A_wqkv": _A_in["wqkv"],
        "A_w_phi": _A_in["w_phi"],
        "A_wo": _A_in["wo"],
        "B_x": _B_in["x"],
        "B_w_gate": _B_in["w_gate"],
        "B_w_up": _B_in["w_up"],
        "B_w_down": _B_in["w_down"],
    }

def reference(A_x, A_wqkv, A_w_phi, A_wo, B_x, B_w_gate, B_w_up, B_w_down):
    def _A_ref(x, wqkv, w_phi, wo):
        B, S, D = x.shape
        H = 16; Dh = D // H
        qkv = (lambda x, *d: x.permute(*d))((x @ wqkv).reshape(B, S, 3, H, Dh), 2, 0, 3, 1, 4)
        q, k, v = qkv[0], qkv[1], qkv[2]
        pq = torch.einsum("bhsd,hdf->bhsf", q, w_phi)
        pk = torch.einsum("bhsd,hdf->bhsf", k, w_phi)
        phi_q = torch.concatenate([_softmax(pq, axis=-1), _softmax(-pq, axis=-1)], axis=-1)
        phi_k = torch.concatenate([_softmax(pk, axis=-1), _softmax(-pk, axis=-1)], axis=-1)
        kv = torch.einsum("bhsf,bhsd->bhfd", phi_k, v)
        z  = torch.einsum("bhsf->bhf", phi_k)
        num = torch.einsum("bhqf,bhfd->bhqd", phi_q, kv)
        den = torch.einsum("bhqf,bhf->bhq", phi_q, z)[..., None] + 1e-6
        o = num / den
        return (lambda x, *d: x.permute(*d))(o, 0, 2, 1, 3).reshape(B, S, D) @ wo

    def _B_ref(x, w_gate, w_up, w_down):
        return (_gelu(x @ w_gate) * (x @ w_up)) @ w_down

    x = A_x
    xn = _layernorm(x, axis=-1)
    return x + _A_ref(xn, A_wqkv, A_w_phi, A_wo) + _B_ref(xn, B_w_gate, B_w_up, B_w_down)
```

```asm
; @launch grid=(256,1,1) block=(512,1,1) lds=156672
.amdgcn_target "amdgcn-amd-amdhsa--gfx950"
.text
.globl parallel_sum__linear_kernel_hedgehog__geglu_ffn__prompt_kernel
.p2align 8
.type parallel_sum__linear_kernel_hedgehog__geglu_ffn__prompt_kernel,@function
parallel_sum__linear_kernel_hedgehog__geglu_ffn__prompt_kernel:
    s_cmp_ge_u32 s2, 0x100
    s_cbranch_scc1 K1_END
    s_nop 0
    s_load_dwordx8 s[4:11], s[0:1], 0
    s_load_dwordx8 s[12:19], s[0:1], 32
    s_load_dwordx4 s[20:23], s[0:1], 64
    s_load_dwordx2 s[24:25], s[0:1], 0x50
    v_lshrrev_b32 v1, 6, v0
    s_nop 0
    v_readfirstlane_b32 s3, v1
    v_and_b32 v0, 63, v0
    s_and_b32 s60, s2, 7
    s_lshr_b32 s61, s2, 3
    s_and_b32 s62, s60, 1
    s_lshl_b32 s62, s62, 3
    s_and_b32 s63, s61, 7
    s_add_u32 s26, s62, s63
    s_lshr_b32 s62, s60, 1
    s_lshr_b32 s61, s61, 3
    s_lshl_b32 s27, s62, 2
    s_add_u32 s27, s27, s61
    s_lshl_b32 s72, s63, 0
    s_and_b32 s77, s60, 1
    s_add_u32 s72, s72, s77
    s_cmp_ge_u32 s72, 7
    s_cselect_b32 s62, 7, 0
    s_sub_u32 s72, s72, s62
    s_cmp_ge_u32 s72, 7
    s_cselect_b32 s62, 7, 0
    s_sub_u32 s72, s72, s62
    s_lshl_b32 s58, s61, 1
    s_add_u32 s58, s58, s3
    s_and_b32 s58, s58, 7
    v_lshrrev_b32 v1, 3, v0
    v_and_b32 v2, 7, v0
    s_lshl_b32 s60, s26, 7
    s_lshl_b32 s61, s58, 4
    s_add_u32 s60, s60, s61
    v_add_u32 v3, s60, v1
    v_mul_u32_u24 v3, 0x380, v3
    v_lshl_add_u32 v3, v2, 4, v3
    v_add_u32 v4, 0x1c00, v3
    s_lshl_b32 s60, s72, 7
    v_mov_b32 v208, v3
    v_mov_b32 v209, v4
    s_mov_b32 s57, s60
    s_waitcnt lgkmcnt(0)
    s_mov_b32 s28, s4
    s_and_b32 s29, s5, 0xffff
    s_mov_b32 s30, 0x1c0000
    s_mov_b32 s31, 0x20000
    buffer_load_dwordx4 v[8:11], v208, s[28:31], s57 offen
    buffer_load_dwordx4 v[12:15], v209, s[28:31], s57 offen
    s_add_u32 s57, s57, 0x80
    s_cmp_eq_u32 s57, 0x380
    s_cselect_b32 s57, 0, s57
    s_nop 0
    buffer_load_dwordx4 v[16:19], v208, s[28:31], s57 offen
    buffer_load_dwordx4 v[20:23], v209, s[28:31], s57 offen
    s_add_u32 s57, s57, 0x80
    s_cmp_eq_u32 s57, 0x380
    s_cselect_b32 s57, 0, s57
    s_nop 0
    buffer_load_dwordx4 v[24:27], v208, s[28:31], s57 offen
    buffer_load_dwordx4 v[28:31], v209, s[28:31], s57 offen
    s_add_u32 s57, s57, 0x80
    s_cmp_eq_u32 s57, 0x380
    s_cselect_b32 s57, 0, s57
    s_nop 0
    buffer_load_dwordx4 v[32:35], v208, s[28:31], s57 offen
    buffer_load_dwordx4 v[36:39], v209, s[28:31], s57 offen
    s_add_u32 s57, s57, 0x80
    s_cmp_eq_u32 s57, 0x380
    s_cselect_b32 s57, 0, s57
    s_nop 0
    buffer_load_dwordx4 v[40:43], v208, s[28:31], s57 offen
    buffer_load_dwordx4 v[44:47], v209, s[28:31], s57 offen
    s_add_u32 s57, s57, 0x80
    s_cmp_eq_u32 s57, 0x380
    s_cselect_b32 s57, 0, s57
    s_nop 0
    buffer_load_dwordx4 v[48:51], v208, s[28:31], s57 offen
    buffer_load_dwordx4 v[52:55], v209, s[28:31], s57 offen
    s_add_u32 s57, s57, 0x80
    s_cmp_eq_u32 s57, 0x380
    s_cselect_b32 s57, 0, s57
    buffer_load_dwordx4 v[56:59], v208, s[28:31], s57 offen
    buffer_load_dwordx4 v[60:63], v209, s[28:31], s57 offen
    s_cmp_lt_u32 s3, 4
    s_cbranch_scc1 K1_NB0
    s_barrier
K1_NB0:
    s_getpc_b64 s[56:57]
CP_L:
    s_sub_u32 s56, s56, CP_L-parallel_sum__linear_kernel_hedgehog__geglu_ffn__prompt_kernel
    s_subb_u32 s57, s57, 0
    s_lshr_b32 s60, s2, 3
    s_lshl_b32 s61, s3, 5
    s_add_u32 s60, s60, s61
    s_lshl_b32 s60, s60, 10
    s_cmp_lt_u32 s60, CODE_END-parallel_sum__linear_kernel_hedgehog__geglu_ffn__prompt_kernel-1024
    s_cbranch_scc0 CP_L_SKIP
    v_lshl_add_u32 v3, v0, 4, s60
    global_load_dwordx4 v[64:67], v3, s[56:57]
CP_L_SKIP:
    s_mov_b32 s32, s6
    s_and_b32 s33, s7, 0xffff
    s_mov_b32 s34, 0x126000
    s_mov_b32 s35, 0x20000
    s_lshl_b32 s61, s27, 8
    s_sub_u32 s62, s27, 14
    s_mul_i32 s62, s62, 0x1c0
    s_mov_b32 s77, 0xa80
    s_mov_b32 s78, 0x126000
    s_cmp_lt_u32 s27, 14
    s_cselect_b32 s36, s14, s6
    s_cselect_b32 s37, s15, s7
    s_cselect_b32 s40, s16, s6
    s_cselect_b32 s41, s17, s7
    s_cselect_b32 s77, 0xe00, s77
    s_cselect_b32 s76, 0x188000, s78
    s_cselect_b32 s61, s61, s62
    s_cselect_b32 s78, 2, 0
    s_nop 0
    s_cselect_b32 s79, 0, 0xe0
    s_and_b32 s37, s37, 0xffff
    s_and_b32 s41, s41, 0xffff
    s_mov_b32 s38, s76
    s_mov_b32 s42, s76
    s_mov_b32 s39, 0x20000
    s_mov_b32 s43, 0x20000
    s_lshl_b32 s75, s77, 5
    s_mul_i32 s65, s72, s75
    s_lshl_b32 s65, s65, 1
    v_lshrrev_b32 v3, 4, v0
    v_and_b32 v4, 15, v0
    v_lshlrev_b32 v5, 2, v3
    v_xor_b32 v4, v4, v5
    s_lshl_b32 s60, s3, 2
    v_add_u32 v3, s60, v3
    v_mul_u32_u24 v3, s77, v3
    v_add_u32_e64 v3, s61, v3
    v_lshl_add_u32 v225, v4, 4, v3
    v_xor_b32_e64 v4, s78, v4
    v_lshl_add_u32 v226, v4, 4, v3
    v_add_u32 v226, s79, v226
    s_lshl_b32 s66, s3, 10
    v_bfe_u32 v5, v1, 1, 1
    v_lshlrev_b32 v5, 2, v5
    v_xor_b32 v5, v5, v2
    s_lshl_b32 s60, s3, 3
    v_add_u32 v6, s60, v1
    v_lshrrev_b32_e64 v3, 2, v5
    v_mul_u32_u24 v3, 0x380, v3
    v_and_b32_e64 v4, 3, v5
    v_lshl_add_u32 v3, v4, 4, v3
    v_mul_u32_u24 v4, 0xa80, v6
    v_add_u32 v3, v3, v4
    s_mul_i32 s61, s27, 56
    s_add_u32 s61, s61, 0x380
    v_add_u32_e64 v224, s61, v3
    s_mul_i32 s64, s72, 0x2a000
    v_mul_u32_u24 v222, 0x210, v2
    v_lshl_add_u32 v222, v1, 4, v222
    s_lshr_b32 s60, s58, 1
    s_mul_i32 s60, s60, 0x1080
    s_and_b32 s61, s58, 1
    s_lshl_b32 s62, s61, 8
    s_add_u32 s60, s60, s62
    s_add_u32 s60, s60, 0x1e000
    v_add_u32 v222, s60, v222
    s_and_b32 s61, s3, 1
    s_mov_b32 s44, s24
    s_nop 0
    s_and_b32 s45, s25, 0xffff
    s_mov_b32 s46, 0x1400000
    s_mov_b32 s47, 0x20000
    v_lshlrev_b32 v227, 4, v0
    v_and_b32 v236, 31, v0
    v_lshrrev_b32_e64 v237, 5, v0
    v_mul_u32_u24 v223, 0x210, v237
    v_lshl_add_u32 v223, v236, 4, v223
    s_mul_i32 s62, s61, 0x2100
    s_add_u32 s62, s62, 0x1e000
    v_add_u32_e64 v223, s62, v223
    v_mov_b32 v233, 0xbdd2d3e8
    v_mov_b32 v204, 0x3f803f80
    v_mov_b32 v200, 0
    v_mov_b32 v201, 0
    v_mov_b32 v202, 0
    v_mov_b32 v203, 0
    s_waitcnt vmcnt(13)
    v_dot2c_f32_bf16 v200, v8, v204
    v_dot2c_f32_bf16 v202, v8, v8
    v_dot2c_f32_bf16 v200, v9, v204
    v_dot2c_f32_bf16 v202, v9, v9
    v_dot2c_f32_bf16 v200, v10, v204
    v_dot2c_f32_bf16 v202, v10, v10
    v_dot2c_f32_bf16 v200, v11, v204
    v_dot2c_f32_bf16 v202, v11, v11
    s_waitcnt vmcnt(12)
    v_dot2c_f32_bf16 v201, v12, v204
    v_dot2c_f32_bf16 v203, v12, v12
    v_dot2c_f32_bf16 v201, v13, v204
    v_dot2c_f32_bf16 v203, v13, v13
    v_dot2c_f32_bf16 v201, v14, v204
    v_dot2c_f32_bf16 v203, v14, v14
    v_dot2c_f32_bf16 v201, v15, v204
    v_dot2c_f32_bf16 v203, v15, v15
    s_waitcnt vmcnt(11)
    v_dot2c_f32_bf16 v200, v16, v204
    v_dot2c_f32_bf16 v202, v16, v16
    v_dot2c_f32_bf16 v200, v17, v204
    v_dot2c_f32_bf16 v202, v17, v17
    v_dot2c_f32_bf16 v200, v18, v204
    v_dot2c_f32_bf16 v202, v18, v18
    v_dot2c_f32_bf16 v200, v19, v204
    v_dot2c_f32_bf16 v202, v19, v19
    s_waitcnt vmcnt(10)
    v_dot2c_f32_bf16 v201, v20, v204
    v_dot2c_f32_bf16 v203, v20, v20
    v_dot2c_f32_bf16 v201, v21, v204
    v_dot2c_f32_bf16 v203, v21, v21
    v_dot2c_f32_bf16 v201, v22, v204
    v_dot2c_f32_bf16 v203, v22, v22
    v_dot2c_f32_bf16 v201, v23, v204
    v_dot2c_f32_bf16 v203, v23, v23
    s_waitcnt vmcnt(9)
    v_dot2c_f32_bf16 v200, v24, v204
    v_dot2c_f32_bf16 v202, v24, v24
    v_dot2c_f32_bf16 v200, v25, v204
    v_dot2c_f32_bf16 v202, v25, v25
    v_dot2c_f32_bf16 v200, v26, v204
    v_dot2c_f32_bf16 v202, v26, v26
    v_dot2c_f32_bf16 v200, v27, v204
    v_dot2c_f32_bf16 v202, v27, v27
    s_waitcnt vmcnt(8)
    v_dot2c_f32_bf16 v201, v28, v204
    v_dot2c_f32_bf16 v203, v28, v28
    v_dot2c_f32_bf16 v201, v29, v204
    v_dot2c_f32_bf16 v203, v29, v29
    v_dot2c_f32_bf16 v201, v30, v204
    v_dot2c_f32_bf16 v203, v30, v30
    v_dot2c_f32_bf16 v201, v31, v204
    v_dot2c_f32_bf16 v203, v31, v31
    s_waitcnt vmcnt(7)
    v_dot2c_f32_bf16 v200, v32, v204
    v_dot2c_f32_bf16 v202, v32, v32
    v_dot2c_f32_bf16 v200, v33, v204
    v_dot2c_f32_bf16 v202, v33, v33
    v_dot2c_f32_bf16 v200, v34, v204
    v_dot2c_f32_bf16 v202, v34, v34
    v_dot2c_f32_bf16 v200, v35, v204
    v_dot2c_f32_bf16 v202, v35, v35
    s_waitcnt vmcnt(6)
    v_dot2c_f32_bf16 v201, v36, v204
    v_dot2c_f32_bf16 v203, v36, v36
    v_dot2c_f32_bf16 v201, v37, v204
    v_dot2c_f32_bf16 v203, v37, v37
    v_dot2c_f32_bf16 v201, v38, v204
    v_dot2c_f32_bf16 v203, v38, v38
    v_dot2c_f32_bf16 v201, v39, v204
    v_dot2c_f32_bf16 v203, v39, v39
    s_waitcnt vmcnt(5)
    v_dot2c_f32_bf16 v200, v40, v204
    v_dot2c_f32_bf16 v202, v40, v40
    v_dot2c_f32_bf16 v200, v41, v204
    v_dot2c_f32_bf16 v202, v41, v41
    v_dot2c_f32_bf16 v200, v42, v204
    v_dot2c_f32_bf16 v202, v42, v42
    v_dot2c_f32_bf16 v200, v43, v204
    v_dot2c_f32_bf16 v202, v43, v43
    s_waitcnt vmcnt(4)
    v_dot2c_f32_bf16 v201, v44, v204
    v_dot2c_f32_bf16 v203, v44, v44
    v_dot2c_f32_bf16 v201, v45, v204
    v_dot2c_f32_bf16 v203, v45, v45
    v_dot2c_f32_bf16 v201, v46, v204
    v_dot2c_f32_bf16 v203, v46, v46
    v_dot2c_f32_bf16 v201, v47, v204
    v_dot2c_f32_bf16 v203, v47, v47
    s_waitcnt vmcnt(3)
    v_dot2c_f32_bf16 v200, v48, v204
    v_dot2c_f32_bf16 v202, v48, v48
    v_dot2c_f32_bf16 v200, v49, v204
    v_dot2c_f32_bf16 v202, v49, v49
    v_dot2c_f32_bf16 v200, v50, v204
    v_dot2c_f32_bf16 v202, v50, v50
    v_dot2c_f32_bf16 v200, v51, v204
    v_dot2c_f32_bf16 v202, v51, v51
    s_waitcnt vmcnt(2)
    v_dot2c_f32_bf16 v201, v52, v204
    v_dot2c_f32_bf16 v203, v52, v52
    v_dot2c_f32_bf16 v201, v53, v204
    v_dot2c_f32_bf16 v203, v53, v53
    v_dot2c_f32_bf16 v201, v54, v204
    v_dot2c_f32_bf16 v203, v54, v54
    v_dot2c_f32_bf16 v201, v55, v204
    v_dot2c_f32_bf16 v203, v55, v55
    s_waitcnt vmcnt(1)
    v_dot2c_f32_bf16 v200, v56, v204
    v_dot2c_f32_bf16 v202, v56, v56
    v_dot2c_f32_bf16 v200, v57, v204
    v_dot2c_f32_bf16 v202, v57, v57
    v_dot2c_f32_bf16 v200, v58, v204
    v_dot2c_f32_bf16 v202, v58, v58
    v_dot2c_f32_bf16 v200, v59, v204
    v_dot2c_f32_bf16 v202, v59, v59
    s_waitcnt vmcnt(0)
    v_dot2c_f32_bf16 v201, v60, v204
    v_dot2c_f32_bf16 v203, v60, v60
    v_dot2c_f32_bf16 v201, v61, v204
    v_dot2c_f32_bf16 v203, v61, v61
    v_dot2c_f32_bf16 v201, v62, v204
    v_dot2c_f32_bf16 v203, v62, v62
    v_dot2c_f32_bf16 v201, v63, v204
    v_dot2c_f32_bf16 v203, v63, v63
    v_add_f32_dpp v200, v200, v200 quad_perm:[1,0,3,2] row_mask:0xf bank_mask:0xf
    s_nop 0
    s_nop 0
    v_add_f32_dpp v201, v201, v201 quad_perm:[1,0,3,2] row_mask:0xf bank_mask:0xf
    v_add_f32_dpp v202, v202, v202 quad_perm:[1,0,3,2] row_mask:0xf bank_mask:0xf
    v_add_f32_dpp v203, v203, v203 quad_perm:[1,0,3,2] row_mask:0xf bank_mask:0xf
    v_add_f32_dpp v200, v200, v200 quad_perm:[2,3,0,1] row_mask:0xf bank_mask:0xf
    v_add_f32_dpp v201, v201, v201 quad_perm:[2,3,0,1] row_mask:0xf bank_mask:0xf
    v_add_f32_dpp v202, v202, v202 quad_perm:[2,3,0,1] row_mask:0xf bank_mask:0xf
    v_add_f32_dpp v203, v203, v203 quad_perm:[2,3,0,1] row_mask:0xf bank_mask:0xf
    v_add_f32_dpp v200, v200, v200 row_half_mirror row_mask:0xf bank_mask:0xf
    v_add_f32_dpp v201, v201, v201 row_half_mirror row_mask:0xf bank_mask:0xf
    v_add_f32_dpp v202, v202, v202 row_half_mirror row_mask:0xf bank_mask:0xf
    v_add_f32_dpp v203, v203, v203 row_half_mirror row_mask:0xf bank_mask:0xf
    v_mul_f32 v200, 0x3b124925, v200
    v_mul_f32 v202, 0x3b124925, v202
    v_mul_f32 v201, 0x3b124925, v201
    v_mul_f32 v203, 0x3b124925, v203
    v_fma_f32 v202, -v200, v200, v202
    v_fma_f32 v203, -v201, v201, v203
    v_max_f32 v202, 0, v202
    v_max_f32 v203, 0, v203
    v_add_f32 v202, 0x3727c5ac, v202
    v_add_f32 v203, 0x3727c5ac, v203
    v_rsq_f32 v228, v202
    v_rsq_f32 v229, v203
    v_mul_f32_e64 v230, -v200, v228
    v_mul_f32_e64 v231, -v201, v229
    s_lshr_b32 s77, s75, 1
    s_cmp_ge_u32 s3, 4
    s_cbranch_scc1 K1_NB1
    s_barrier
K1_NB1:
    s_cmp_ge_u32 s3, 4
    s_cbranch_scc1 K1_NODMA
    s_mov_b32 s78, s65
    s_add_u32 m0, s66, 0
    s_nop 0
    buffer_load_dwordx4 v225, s[36:39], s78 offen lds
    s_add_u32 m0, s66, 0x2000
    s_nop 0
    buffer_load_dwordx4 v226, s[40:43], s78 offen lds
    s_add_u32 s79, s78, s77
    s_add_u32 m0, s66, 0x1000
    s_nop 0
    buffer_load_dwordx4 v225, s[36:39], s79 offen lds
    s_add_u32 m0, s66, 0x3000
    s_nop 0
    buffer_load_dwordx4 v226, s[40:43], s79 offen lds
    s_add_u32 s78, s78, s75
    s_add_u32 s79, s64, 0x15000
    s_add_u32 m0, s66, 0x18000
    s_nop 0
    buffer_load_dwordx4 v224, s[32:35], s64 offen lds
    s_add_u32 m0, s66, 0x19000
    s_nop 0
    buffer_load_dwordx4 v224, s[32:35], s79 offen lds
    s_add_u32 m0, s66, 0x4000
    s_nop 0
    buffer_load_dwordx4 v225, s[36:39], s78 offen lds
    s_add_u32 m0, s66, 0x6000
    s_nop 0
    buffer_load_dwordx4 v226, s[40:43], s78 offen lds
    s_add_u32 s79, s78, s77
    s_add_u32 m0, s66, 0x5000
    s_nop 0
    buffer_load_dwordx4 v225, s[36:39], s79 offen lds
    s_add_u32 m0, s66, 0x7000
    s_nop 0
    buffer_load_dwordx4 v226, s[40:43], s79 offen lds
K1_NODMA:
    s_add_u32 s65, s65, s75
    s_add_u32 s65, s65, s75
    s_cmp_eq_u32 s65, s76
    s_cselect_b32 s65, 0, s65
    s_add_u32 s64, s64, 0x2a000
    s_cmp_eq_u32 s64, 0x126000
    s_cselect_b32 s64, 0, s64
    v_lshlrev_b32_e64 v200, 16, v8
    v_and_b32 v201, 0xffff0000, v8
    v_lshlrev_b32_e64 v202, 16, v9
    v_and_b32 v203, 0xffff0000, v9
    v_lshlrev_b32_e64 v204, 16, v10
    v_and_b32 v205, 0xffff0000, v10
    v_lshlrev_b32_e64 v206, 16, v11
    v_and_b32 v207, 0xffff0000, v11
    v_fma_f32 v200, v200, v228, v230
    v_fma_f32 v201, v201, v228, v230
    v_fma_f32 v202, v202, v228, v230
    v_fma_f32 v203, v203, v228, v230
    v_fma_f32 v204, v204, v228, v230
    v_fma_f32 v205, v205, v228, v230
    v_fma_f32 v206, v206, v228, v230
    v_fma_f32 v207, v207, v228, v230
    v_cvt_pk_bf16_f32 v8, v200, v201
    v_cvt_pk_bf16_f32 v9, v202, v203
    v_cvt_pk_bf16_f32 v10, v204, v205
    v_cvt_pk_bf16_f32 v11, v206, v207
    ds_write_b128 v222, v[8:11] offset:0
    v_lshlrev_b32_e64 v200, 16, v12
    v_and_b32 v201, 0xffff0000, v12
    v_lshlrev_b32_e64 v202, 16, v13
    v_and_b32 v203, 0xffff0000, v13
    v_lshlrev_b32_e64 v204, 16, v14
    v_and_b32 v205, 0xffff0000, v14
    v_lshlrev_b32_e64 v206, 16, v15
    v_and_b32 v207, 0xffff0000, v15
    v_fma_f32 v200, v200, v229, v231
    v_fma_f32 v201, v201, v229, v231
    v_fma_f32 v202, v202, v229, v231
    v_fma_f32 v203, v203, v229, v231
    v_fma_f32 v204, v204, v229, v231
    v_fma_f32 v205, v205, v229, v231
    v_fma_f32 v206, v206, v229, v231
    v_fma_f32 v207, v207, v229, v231
    v_cvt_pk_bf16_f32 v12, v200, v201
    v_cvt_pk_bf16_f32 v13, v202, v203
    v_cvt_pk_bf16_f32 v14, v204, v205
    v_cvt_pk_bf16_f32 v15, v206, v207
    ds_write_b128 v222, v[12:15] offset:128
    s_add_u32 m0, s66, 0x8000
    s_nop 0
    buffer_load_dwordx4 v225, s[36:39], s65 offen lds
    s_add_u32 m0, s66, 0xa000
    s_nop 0
    buffer_load_dwordx4 v226, s[40:43], s65 offen lds
    s_add_u32 s65, s65, s75
    s_add_u32 m0, s66, 0x1a000
    s_nop 0
    buffer_load_dwordx4 v224, s[32:35], s64 offen lds
    s_add_u32 s64, s64, 0x2a000
    s_cmp_eq_u32 s64, 0x126000
    s_cselect_b32 s64, 0, s64
    s_cmp_ge_u32 s27, 14
    s_cbranch_scc1 K1_Q
    s_cmp_ge_u32 s3, 4
    s_cbranch_scc1 K1_F1
    v_bfe_u32 v3, v0, 4, 1
    v_bfe_u32 v4, v0, 2, 2
    v_and_b32 v5, 3, v0
    v_lshl_add_u32 v6, v237, 3, v4
    v_lshlrev_b32_e64 v5, 3, v5
    v_lshl_add_u32 v1, v3, 5, v5
    v_lshlrev_b32 v7, 6, v4
    s_lshr_b32 s60, s3, 1
    s_and_b32 s60, s60, 1
    s_mul_i32 s61, s60, 3
    s_lshl_b32 s62, s61, 5
    v_xor_b32 v2, s62, v1
    v_xor_b32_e64 v2, v2, v7
    v_lshl_add_u32 v2, v3, 13, v2
    v_lshl_add_u32 v216, v6, 8, v2
    v_add_u32 v217, 0xc000, v216
    s_add_u32 s61, s61, 1
    s_lshl_b32 s62, s61, 5
    v_xor_b32 v2, s62, v1
    v_xor_b32 v2, v2, v7
    v_lshl_add_u32 v2, v3, 13, v2
    v_lshl_add_u32 v218, v6, 8, v2
    v_add_u32 v219, 0xc000, v218
    s_add_u32 s61, s61, 1
    s_lshl_b32 s62, s61, 5
    v_xor_b32 v2, s62, v1
    v_xor_b32 v2, v2, v7
    v_lshl_add_u32 v2, v3, 13, v2
    v_lshl_add_u32 v220, v6, 8, v2
    v_add_u32 v221, 0xc000, v220
    s_and_b32 s62, s3, 1
    s_lshl_b32 s62, s62, 1
    s_lshl_b32 s63, s26, 2
    s_add_u32 s62, s62, s63
    s_sub_u32 s61, s61, 2
    s_mul_i32 s70, s62, 0x24000
    s_lshl_b32 s63, s27, 3
    s_add_u32 s63, s63, s61
    s_lshl_b32 s63, s63, 10
    s_add_u32 s70, s70, s63
    v_lshlrev_b32 v200, 16, v16
    v_and_b32 v201, 0xffff0000, v16
    v_lshlrev_b32_e64 v202, 16, v17
    v_and_b32 v203, 0xffff0000, v17
    v_lshlrev_b32_e64 v204, 16, v18
    v_and_b32 v205, 0xffff0000, v18
    v_lshlrev_b32_e64 v206, 16, v19
    v_and_b32 v207, 0xffff0000, v19
    v_fma_f32 v200, v200, v228, v230
    v_fma_f32 v201, v201, v228, v230
    v_fma_f32 v202, v202, v228, v230
    v_fma_f32 v203, v203, v228, v230
    v_fma_f32 v204, v204, v228, v230
    v_fma_f32 v205, v205, v228, v230
    v_fma_f32 v206, v206, v228, v230
    v_fma_f32 v207, v207, v228, v230
    v_cvt_pk_bf16_f32 v16, v200, v201
    v_cvt_pk_bf16_f32 v17, v202, v203
    v_cvt_pk_bf16_f32 v18, v204, v205
    v_cvt_pk_bf16_f32 v19, v206, v207
    s_waitcnt vmcnt(3) lgkmcnt(0)
    s_barrier
    ds_read_b128 v[184:187], v223 offset:0
    ds_read_b64_tr_b16 v[160:161], v216 offset:0
    ds_read_b64_tr_b16 v[162:163], v216 offset:1024
    ds_read_b128 v[188:191], v223 offset:4224
    ds_read_b64_tr_b16 v[164:165], v218 offset:0
    ds_read_b64_tr_b16 v[166:167], v218 offset:1024
    ds_read_b64_tr_b16 v[168:169], v220 offset:0
    ds_read_b64_tr_b16 v[170:171], v220 offset:1024
    s_waitcnt lgkmcnt(5)
    s_nop 0
    v_mfma_f32_32x32x16_bf16 v[64:79], v[160:163], v[184:187], 0
    ds_read_b128 v[192:195], v223 offset:1056
    ds_read_b64_tr_b16 v[172:173], v216 offset:4096
    s_waitcnt lgkmcnt(6)
    s_nop 0
    v_mfma_f32_32x32x16_bf16 v[80:95], v[160:163], v[188:191], 0
    ds_read_b64_tr_b16 v[174:175], v216 offset:5120
    ds_read_b128 v[196:199], v223 offset:5280
    s_waitcnt lgkmcnt(6)
    s_nop 0
    v_mfma_f32_32x32x16_bf16 v[96:111], v[164:167], v[184:187], 0
    ds_read_b64_tr_b16 v[176:177], v218 offset:4096
    ds_read_b64_tr_b16 v[178:179], v218 offset:5120
    v_mfma_f32_32x32x16_bf16 v[112:127], v[164:167], v[188:191], 0
    ds_read_b64_tr_b16 v[180:181], v220 offset:4096
    ds_read_b64_tr_b16 v[182:183], v220 offset:5120
    s_waitcnt lgkmcnt(8)
    v_mfma_f32_32x32x16_bf16 v[128:143], v[168:171], v[184:187], 0
    v_mfma_f32_32x32x16_bf16 v[144:159], v[168:171], v[188:191], 0
    s_waitcnt lgkmcnt(5)
    v_mfma_f32_32x32x16_bf16 v[64:79], v[172:175], v[192:195], v[64:79]
    ds_read_b128 v[184:187], v223 offset:2112
    ds_read_b64_tr_b16 v[160:161], v216 offset:16384
    s_waitcnt lgkmcnt(6)
    s_nop 0
    v_mfma_f32_32x32x16_bf16 v[80:95], v[172:175], v[196:199], v[80:95]
    ds_read_b64_tr_b16 v[162:163], v216 offset:17408
    ds_read_b128 v[188:191], v223 offset:6336
    s_waitcnt lgkmcnt(6)
    s_nop 0
    v_mfma_f32_32x32x16_bf16 v[96:111], v[176:179], v[192:195], v[96:111]
    ds_read_b64_tr_b16 v[164:165], v218 offset:16384
    ds_read_b64_tr_b16 v[166:167], v218 offset:17408
    v_mfma_f32_32x32x16_bf16 v[112:127], v[176:179], v[196:199], v[112:127]
    ds_read_b64_tr_b16 v[168:169], v220 offset:16384
    ds_read_b64_tr_b16 v[170:171], v220 offset:17408
    s_waitcnt lgkmcnt(8)
    s_nop 0
    v_mfma_f32_32x32x16_bf16 v[128:143], v[180:183], v[192:195], v[128:143]
    v_mfma_f32_32x32x16_bf16 v[144:159], v[180:183], v[196:199], v[144:159]
    s_add_u32 m0, s66, 0xc000
    s_nop 0
    buffer_load_dwordx4 v225, s[36:39], s65 offen lds
    ds_write_b128 v222, v[16:19] offset:16896
    v_lshlrev_b32 v200, 16, v20
    v_and_b32 v201, 0xffff0000, v20
    v_lshlrev_b32_e64 v202, 16, v21
    v_and_b32 v203, 0xffff0000, v21
    s_add_u32 m0, s66, 0xe000
    s_nop 0
    buffer_load_dwordx4 v226, s[40:43], s65 offen lds
    v_lshlrev_b32 v204, 16, v22
    v_and_b32 v205, 0xffff0000, v22
    v_lshlrev_b32_e64 v206, 16, v23
    v_and_b32 v207, 0xffff0000, v23
    v_fma_f32 v200, v200, v229, v231
    s_add_u32 s65, s65, s75
    s_cmp_eq_u32 s65, s76
    s_cselect_b32 s65, 0, s65
    s_add_u32 m0, s66, 0x10000
    s_nop 0
    buffer_load_dwordx4 v225, s[36:39], s65 offen lds
    v_fma_f32 v201, v201, v229, v231
    v_fma_f32 v202, v202, v229, v231
    v_fma_f32 v203, v203, v229, v231
    v_fma_f32 v204, v204, v229, v231
    v_fma_f32 v205, v205, v229, v231
    s_add_u32 m0, s66, 0x12000
    s_nop 0
    buffer_load_dwordx4 v226, s[40:43], s65 offen lds
    s_add_u32 s65, s65, s75
    v_fma_f32 v206, v206, v229, v231
    v_fma_f32 v207, v207, v229, v231
    v_cvt_pk_bf16_f32 v20, v200, v201
    v_cvt_pk_bf16_f32 v21, v202, v203
    v_cvt_pk_bf16_f32 v22, v204, v205
    v_cvt_pk_bf16_f32 v23, v206, v207
    ds_write_b128 v222, v[20:23] offset:17024
    s_waitcnt vmcnt(4) lgkmcnt(0)
    s_barrier
    v_mfma_f32_32x32x16_bf16 v[64:79], v[160:163], v[184:187], v[64:79]
    ds_read_b128 v[192:195], v223 offset:3168
    ds_read_b64_tr_b16 v[172:173], v216 offset:20480
    v_mfma_f32_32x32x16_bf16 v[80:95], v[160:163], v[188:191], v[80:95]
    ds_read_b64_tr_b16 v[174:175], v216 offset:21504
    ds_read_b128 v[196:199], v223 offset:7392
    v_mfma_f32_32x32x16_bf16 v[96:111], v[164:167], v[184:187], v[96:111]
    ds_read_b64_tr_b16 v[176:177], v218 offset:20480
    ds_read_b64_tr_b16 v[178:179], v218 offset:21504
    v_mfma_f32_32x32x16_bf16 v[112:127], v[164:167], v[188:191], v[112:127]
    ds_read_b64_tr_b16 v[180:181], v220 offset:20480
    ds_read_b64_tr_b16 v[182:183], v220 offset:21504
    v_mfma_f32_32x32x16_bf16 v[128:143], v[168:171], v[184:187], v[128:143]
    v_mfma_f32_32x32x16_bf16 v[144:159], v[168:171], v[188:191], v[144:159]
    s_waitcnt lgkmcnt(5)
    s_nop 0
    v_mfma_f32_32x32x16_bf16 v[64:79], v[172:175], v[192:195], v[64:79]
    ds_read_b128 v[184:187], v223 offset:16896
    ds_read_b64_tr_b16 v[160:161], v216 offset:32768
    s_waitcnt lgkmcnt(6)
    s_nop 0
    v_mfma_f32_32x32x16_bf16 v[80:95], v[172:175], v[196:199], v[80:95]
    ds_read_b64_tr_b16 v[162:163], v216 offset:33792
    ds_read_b128 v[188:191], v223 offset:21120
    s_waitcnt lgkmcnt(6)
    s_nop 0
    v_mfma_f32_32x32x16_bf16 v[96:111], v[176:179], v[192:195], v[96:111]
    ds_read_b64_tr_b16 v[164:165], v218 offset:32768
    ds_read_b64_tr_b16 v[166:167], v218 offset:33792
    v_mfma_f32_32x32x16_bf16 v[112:127], v[176:179], v[196:199], v[112:127]
    ds_read_b64_tr_b16 v[168:169], v220 offset:32768
    ds_read_b64_tr_b16 v[170:171], v220 offset:33792
    s_waitcnt lgkmcnt(8)
    s_nop 0
    v_mfma_f32_32x32x16_bf16 v[128:143], v[180:183], v[192:195], v[128:143]
    v_mfma_f32_32x32x16_bf16 v[144:159], v[180:183], v[196:199], v[144:159]
    s_add_u32 m0, s66, 0x14000
    s_nop 0
    buffer_load_dwordx4 v225, s[36:39], s65 offen lds
    v_lshlrev_b32 v200, 16, v24
    v_and_b32 v201, 0xffff0000, v24
    v_lshlrev_b32_e64 v202, 16, v25
    v_and_b32 v203, 0xffff0000, v25
    s_add_u32 m0, s66, 0x16000
    s_nop 0
    buffer_load_dwordx4 v226, s[40:43], s65 offen lds
    v_lshlrev_b32 v204, 16, v26
    v_and_b32 v205, 0xffff0000, v26
    v_lshlrev_b32_e64 v206, 16, v27
    v_and_b32 v207, 0xffff0000, v27
    s_add_u32 s65, s65, s75
    s_cmp_eq_u32 s65, s76
    s_cselect_b32 s65, 0, s65
    s_add_u32 m0, s66, 0
    s_nop 0
    s_nop 0
    buffer_load_dwordx4 v225, s[36:39], s65 offen lds
    v_fma_f32 v200, v200, v228, v230
    v_fma_f32 v201, v201, v228, v230
    v_fma_f32 v202, v202, v228, v230
    v_fma_f32 v203, v203, v228, v230
    s_add_u32 m0, s66, 0x2000
    s_nop 0
    s_nop 0
    buffer_load_dwordx4 v226, s[40:43], s65 offen lds
    v_fma_f32 v204, v204, v228, v230
    v_fma_f32 v205, v205, v228, v230
    v_fma_f32 v206, v206, v228, v230
    v_fma_f32 v207, v207, v228, v230
    s_add_u32 s65, s65, s75
    s_add_u32 m0, s66, 0x1c000
    s_nop 0
    buffer_load_dwordx4 v224, s[32:35], s64 offen lds
    s_add_u32 s64, s64, 0x2a000
    s_cmp_eq_u32 s64, 0x126000
    s_cselect_b32 s64, 0, s64
    s_nop 0
    v_cvt_pk_bf16_f32 v24, v200, v201
    v_cvt_pk_bf16_f32 v25, v202, v203
    v_cvt_pk_bf16_f32 v26, v204, v205
    v_cvt_pk_bf16_f32 v27, v206, v207
    s_waitcnt vmcnt(7)
    s_barrier
    s_waitcnt lgkmcnt(5)
    s_nop 0
    v_mfma_f32_32x32x16_bf16 v[64:79], v[160:163], v[184:187], v[64:79]
    ds_read_b128 v[192:195], v223 offset:17952
    ds_read_b64_tr_b16 v[172:173], v216 offset:36864
    s_waitcnt lgkmcnt(6)
    s_nop 0
    v_mfma_f32_32x32x16_bf16 v[80:95], v[160:163], v[188:191], v[80:95]
    ds_read_b64_tr_b16 v[174:175], v216 offset:37888
    ds_read_b128 v[196:199], v223 offset:22176
    s_waitcnt lgkmcnt(6)
    s_nop 0
    v_mfma_f32_32x32x16_bf16 v[96:111], v[164:167], v[184:187], v[96:111]
    ds_read_b64_tr_b16 v[176:177], v218 offset:36864
    ds_read_b64_tr_b16 v[178:179], v218 offset:37888
    v_mfma_f32_32x32x16_bf16 v[112:127], v[164:167], v[188:191], v[112:127]
    ds_read_b64_tr_b16 v[180:181], v220 offset:36864
    ds_read_b64_tr_b16 v[182:183], v220 offset:37888
    s_waitcnt lgkmcnt(8)
    v_mfma_f32_32x32x16_bf16 v[128:143], v[168:171], v[184:187], v[128:143]
    v_mfma_f32_32x32x16_bf16 v[144:159], v[168:171], v[188:191], v[144:159]
    s_waitcnt lgkmcnt(5)
    v_mfma_f32_32x32x16_bf16 v[64:79], v[172:175], v[192:195], v[64:79]
    ds_read_b128 v[184:187], v223 offset:19008
    ds_read_b64_tr_b16 v[160:161], v217 offset:0
    s_waitcnt lgkmcnt(6)
    s_nop 0
    v_mfma_f32_32x32x16_bf16 v[80:95], v[172:175], v[196:199], v[80:95]
    ds_read_b64_tr_b16 v[162:163], v217 offset:1024
    ds_read_b128 v[188:191], v223 offset:23232
    s_waitcnt lgkmcnt(6)
    s_nop 0
    v_mfma_f32_32x32x16_bf16 v[96:111], v[176:179], v[192:195], v[96:111]
    ds_read_b64_tr_b16 v[164:165], v219 offset:0
    ds_read_b64_tr_b16 v[166:167], v219 offset:1024
    v_mfma_f32_32x32x16_bf16 v[112:127], v[176:179], v[196:199], v[112:127]
    ds_read_b64_tr_b16 v[168:169], v221 offset:0
    ds_read_b64_tr_b16 v[170:171], v221 offset:1024
    s_waitcnt lgkmcnt(8)
    s_nop 0
    v_mfma_f32_32x32x16_bf16 v[128:143], v[180:183], v[192:195], v[128:143]
    v_mfma_f32_32x32x16_bf16 v[144:159], v[180:183], v[196:199], v[144:159]
    s_add_u32 m0, s66, 0x4000
    s_nop 0
    buffer_load_dwordx4 v225, s[36:39], s65 offen lds
    ds_write_b128 v222, v[24:27] offset:0
    v_lshlrev_b32 v200, 16, v28
    v_and_b32 v201, 0xffff0000, v28
    v_lshlrev_b32_e64 v202, 16, v29
    v_and_b32 v203, 0xffff0000, v29
    v_lshlrev_b32_e64 v204, 16, v30
    v_and_b32 v205, 0xffff0000, v30
    v_lshlrev_b32_e64 v206, 16, v31
    v_and_b32 v207, 0xffff0000, v31
    v_fma_f32 v200, v200, v229, v231
    v_fma_f32 v201, v201, v229, v231
    s_add_u32 m0, s66, 0x6000
    s_nop 0
    buffer_load_dwordx4 v226, s[40:43], s65 offen lds
    s_add_u32 s65, s65, s75
    s_cmp_eq_u32 s65, s76
    s_cselect_b32 s65, 0, s65
    v_fma_f32 v202, v202, v229, v231
    v_fma_f32 v203, v203, v229, v231
    v_fma_f32 v204, v204, v229, v231
    v_fma_f32 v205, v205, v229, v231
    v_fma_f32 v206, v206, v229, v231
    v_fma_f32 v207, v207, v229, v231
    v_cvt_pk_bf16_f32 v28, v200, v201
    v_cvt_pk_bf16_f32 v29, v202, v203
    v_cvt_pk_bf16_f32 v30, v204, v205
    v_cvt_pk_bf16_f32 v31, v206, v207
    ds_write_b128 v222, v[28:31] offset:128
    s_waitcnt vmcnt(2) lgkmcnt(0)
    s_barrier
    v_mfma_f32_32x32x16_bf16 v[64:79], v[160:163], v[184:187], v[64:79]
    ds_read_b128 v[192:195], v223 offset:20064
    ds_read_b64_tr_b16 v[172:173], v217 offset:4096
    v_mfma_f32_32x32x16_bf16 v[80:95], v[160:163], v[188:191], v[80:95]
    ds_read_b64_tr_b16 v[174:175], v217 offset:5120
    ds_read_b128 v[196:199], v223 offset:24288
    v_mfma_f32_32x32x16_bf16 v[96:111], v[164:167], v[184:187], v[96:111]
    ds_read_b64_tr_b16 v[176:177], v219 offset:4096
    ds_read_b64_tr_b16 v[178:179], v219 offset:5120
    v_mfma_f32_32x32x16_bf16 v[112:127], v[164:167], v[188:191], v[112:127]
    ds_read_b64_tr_b16 v[180:181], v221 offset:4096
    ds_read_b64_tr_b16 v[182:183], v221 offset:5120
    v_mfma_f32_32x32x16_bf16 v[128:143], v[168:171], v[184:187], v[128:143]
    v_mfma_f32_32x32x16_bf16 v[144:159], v[168:171], v[188:191], v[144:159]
    s_waitcnt lgkmcnt(5)
    s_nop 0
    v_mfma_f32_32x32x16_bf16 v[64:79], v[172:175], v[192:195], v[64:79]
    ds_read_b128 v[184:187], v223 offset:0
    ds_read_b64_tr_b16 v[160:161], v217 offset:16384
    s_waitcnt lgkmcnt(6)
    s_nop 0
    v_mfma_f32_32x32x16_bf16 v[80:95], v[172:175], v[196:199], v[80:95]
    ds_read_b64_tr_b16 v[162:163], v217 offset:17408
    ds_read_b128 v[188:191], v223 offset:4224
    s_waitcnt lgkmcnt(6)
    s_nop 0
    v_mfma_f32_32x32x16_bf16 v[96:111], v[176:179], v[192:195], v[96:111]
    ds_read_b64_tr_b16 v[164:165], v219 offset:16384
    ds_read_b64_tr_b16 v[166:167], v219 offset:17408
    v_mfma_f32_32x32x16_bf16 v[112:127], v[176:179], v[196:199], v[112:127]
    ds_read_b64_tr_b16 v[168:169], v221 offset:16384
    ds_read_b64_tr_b16 v[170:171], v221 offset:17408
    s_waitcnt lgkmcnt(8)
    s_nop 0
    v_mfma_f32_32x32x16_bf16 v[128:143], v[180:183], v[192:195], v[128:143]
    v_mfma_f32_32x32x16_bf16 v[144:159], v[180:183], v[196:199], v[144:159]
    s_add_u32 m0, s66, 0x8000
    s_nop 0
    buffer_load_dwordx4 v225, s[36:39], s65 offen lds
    v_lshlrev_b32 v200, 16, v32
    v_and_b32 v201, 0xffff0000, v32
    v_lshlrev_b32_e64 v202, 16, v33
    v_and_b32 v203, 0xffff0000, v33
    v_lshlrev_b32_e64 v204, 16, v34
    v_and_b32 v205, 0xffff0000, v34
    s_add_u32 m0, s66, 0xa000
    s_nop 0
    buffer_load_dwordx4 v226, s[40:43], s65 offen lds
    v_lshlrev_b32 v206, 16, v35
    v_and_b32 v207, 0xffff0000, v35
    v_fma_f32 v200, v200, v228, v230
    v_fma_f32 v201, v201, v228, v230
    v_fma_f32 v202, v202, v228, v230
    v_fma_f32 v203, v203, v228, v230
    s_add_u32 s65, s65, s75
    s_add_u32 m0, s66, 0x18000
    s_nop 0
    buffer_load_dwordx4 v224, s[32:35], s64 offen lds
    s_add_u32 s64, s64, 0x2a000
    s_cmp_eq_u32 s64, 0x126000
    s_cselect_b32 s64, 0, s64
    s_nop 0
    v_fma_f32 v204, v204, v228, v230
    v_fma_f32 v205, v205, v228, v230
    v_fma_f32 v206, v206, v228, v230
    v_fma_f32 v207, v207, v228, v230
    v_cvt_pk_bf16_f32 v32, v200, v201
    v_cvt_pk_bf16_f32 v33, v202, v203
    v_cvt_pk_bf16_f32 v34, v204, v205
    v_cvt_pk_bf16_f32 v35, v206, v207
    s_lshl_b32 s60, s2, 3
    s_add_u32 s60, s60, s3
    s_lshl_b32 s60, s60, 10
    s_nop 0
    s_sub_u32 s61, s60, 0x188000
    s_mov_b32 s62, 0x62000
    s_cmp_lt_u32 s60, 0x188000
    s_cselect_b32 s28, s18, s10
    s_cselect_b32 s29, s19, s11
    s_cselect_b32 s30, 0x188000, s62
    s_cselect_b32 s60, s60, s61
    s_and_b32 s29, s29, 0xffff
    buffer_load_dwordx4 v[8:11], v227, s[28:31], s60 offen
    s_barrier
    s_waitcnt lgkmcnt(5)
    s_nop 0
    v_mfma_f32_32x32x16_bf16 v[64:79], v[160:163], v[184:187], v[64:79]
    ds_read_b128 v[192:195], v223 offset:1056
    ds_read_b64_tr_b16 v[172:173], v217 offset:20480
    s_waitcnt lgkmcnt(6)
    s_nop 0
    v_mfma_f32_32x32x16_bf16 v[80:95], v[160:163], v[188:191], v[80:95]
    ds_read_b64_tr_b16 v[174:175], v217 offset:21504
    ds_read_b128 v[196:199], v223 offset:5280
    s_waitcnt lgkmcnt(6)
    s_nop 0
    v_mfma_f32_32x32x16_bf16 v[96:111], v[164:167], v[184:187], v[96:111]
    ds_read_b64_tr_b16 v[176:177], v219 offset:20480
    ds_read_b64_tr_b16 v[178:179], v219 offset:21504
    v_mfma_f32_32x32x16_bf16 v[112:127], v[164:167], v[188:191], v[112:127]
    ds_read_b64_tr_b16 v[180:181], v221 offset:20480
    ds_read_b64_tr_b16 v[182:183], v221 offset:21504
    s_waitcnt lgkmcnt(8)
    v_mfma_f32_32x32x16_bf16 v[128:143], v[168:171], v[184:187], v[128:143]
    v_mfma_f32_32x32x16_bf16 v[144:159], v[168:171], v[188:191], v[144:159]
    s_waitcnt lgkmcnt(5)
    v_mfma_f32_32x32x16_bf16 v[64:79], v[172:175], v[192:195], v[64:79]
    ds_read_b128 v[184:187], v223 offset:2112
    ds_read_b64_tr_b16 v[160:161], v217 offset:32768
    s_waitcnt lgkmcnt(6)
    s_nop 0
    v_mfma_f32_32x32x16_bf16 v[80:95], v[172:175], v[196:199], v[80:95]
    ds_read_b64_tr_b16 v[162:163], v217 offset:33792
    ds_read_b128 v[188:191], v223 offset:6336
    s_waitcnt lgkmcnt(6)
    s_nop 0
    v_mfma_f32_32x32x16_bf16 v[96:111], v[176:179], v[192:195], v[96:111]
    ds_read_b64_tr_b16 v[164:165], v219 offset:32768
    ds_read_b64_tr_b16 v[166:167], v219 offset:33792
    v_mfma_f32_32x32x16_bf16 v[112:127], v[176:179], v[196:199], v[112:127]
    ds_read_b64_tr_b16 v[168:169], v221 offset:32768
    ds_read_b64_tr_b16 v[170:171], v221 offset:33792
    s_waitcnt lgkmcnt(8)
    s_nop 0
    v_mfma_f32_32x32x16_bf16 v[128:143], v[180:183], v[192:195], v[128:143]
    v_mfma_f32_32x32x16_bf16 v[144:159], v[180:183], v[196:199], v[144:159]
    s_add_u32 m0, s66, 0xc000
    s_nop 0
    buffer_load_dwordx4 v225, s[36:39], s65 offen lds
    ds_write_b128 v222, v[32:35] offset:16896
    v_lshlrev_b32 v200, 16, v36
    v_and_b32 v201, 0xffff0000, v36
    v_lshlrev_b32_e64 v202, 16, v37
    v_and_b32 v203, 0xffff0000, v37
    v_lshlrev_b32_e64 v204, 16, v38
    v_and_b32 v205, 0xffff0000, v38
    v_lshlrev_b32_e64 v206, 16, v39
    v_and_b32 v207, 0xffff0000, v39
    v_fma_f32 v200, v200, v229, v231
    v_fma_f32 v201, v201, v229, v231
    s_add_u32 m0, s66, 0xe000
    s_nop 0
    buffer_load_dwordx4 v226, s[40:43], s65 offen lds
    s_add_u32 s65, s65, s75
    s_cmp_eq_u32 s65, s76
    s_cselect_b32 s65, 0, s65
    v_fma_f32 v202, v202, v229, v231
    v_fma_f32 v203, v203, v229, v231
    v_fma_f32 v204, v204, v229, v231
    v_fma_f32 v205, v205, v229, v231
    v_fma_f32 v206, v206, v229, v231
    v_fma_f32 v207, v207, v229, v231
    v_cvt_pk_bf16_f32 v36, v200, v201
    v_cvt_pk_bf16_f32 v37, v202, v203
    v_cvt_pk_bf16_f32 v38, v204, v205
    v_cvt_pk_bf16_f32 v39, v206, v207
    ds_write_b128 v222, v[36:39] offset:17024
    s_waitcnt vmcnt(3) lgkmcnt(0)
    s_barrier
    v_mfma_f32_32x32x16_bf16 v[64:79], v[160:163], v[184:187], v[64:79]
    ds_read_b128 v[192:195], v223 offset:3168
    ds_read_b64_tr_b16 v[172:173], v217 offset:36864
    v_mfma_f32_32x32x16_bf16 v[80:95], v[160:163], v[188:191], v[80:95]
    ds_read_b64_tr_b16 v[174:175], v217 offset:37888
    ds_read_b128 v[196:199], v223 offset:7392
    v_mfma_f32_32x32x16_bf16 v[96:111], v[164:167], v[184:187], v[96:111]
    ds_read_b64_tr_b16 v[176:177], v219 offset:36864
    ds_read_b64_tr_b16 v[178:179], v219 offset:37888
    v_mfma_f32_32x32x16_bf16 v[112:127], v[164:167], v[188:191], v[112:127]
    ds_read_b64_tr_b16 v[180:181], v221 offset:36864
    ds_read_b64_tr_b16 v[182:183], v221 offset:37888
    v_mfma_f32_32x32x16_bf16 v[128:143], v[168:171], v[184:187], v[128:143]
    v_mfma_f32_32x32x16_bf16 v[144:159], v[168:171], v[188:191], v[144:159]
    s_waitcnt lgkmcnt(5)
    s_nop 0
    v_mfma_f32_32x32x16_bf16 v[64:79], v[172:175], v[192:195], v[64:79]
    ds_read_b128 v[184:187], v223 offset:16896
    ds_read_b64_tr_b16 v[160:161], v216 offset:0
    s_waitcnt lgkmcnt(6)
    s_nop 0
    v_mfma_f32_32x32x16_bf16 v[80:95], v[172:175], v[196:199], v[80:95]
    ds_read_b64_tr_b16 v[162:163], v216 offset:1024
    ds_read_b128 v[188:191], v223 offset:21120
    s_waitcnt lgkmcnt(6)
    s_nop 0
    v_mfma_f32_32x32x16_bf16 v[96:111], v[176:179], v[192:195], v[96:111]
    ds_read_b64_tr_b16 v[164:165], v218 offset:0
    ds_read_b64_tr_b16 v[166:167], v218 offset:1024
    v_mfma_f32_32x32x16_bf16 v[112:127], v[176:179], v[196:199], v[112:127]
    ds_read_b64_tr_b16 v[168:169], v220 offset:0
    ds_read_b64_tr_b16 v[170:171], v220 offset:1024
    s_waitcnt lgkmcnt(8)
    s_nop 0
    v_mfma_f32_32x32x16_bf16 v[128:143], v[180:183], v[192:195], v[128:143]
    v_mfma_f32_32x32x16_bf16 v[144:159], v[180:183], v[196:199], v[144:159]
    s_add_u32 m0, s66, 0x10000
    s_nop 0
    buffer_load_dwordx4 v225, s[36:39], s65 offen lds
    v_lshlrev_b32 v200, 16, v40
    v_and_b32 v201, 0xffff0000, v40
    v_lshlrev_b32_e64 v202, 16, v41
    v_and_b32 v203, 0xffff0000, v41
    v_lshlrev_b32_e64 v204, 16, v42
    v_and_b32 v205, 0xffff0000, v42
    s_add_u32 m0, s66, 0x12000
    s_nop 0
    buffer_load_dwordx4 v226, s[40:43], s65 offen lds
    v_lshlrev_b32 v206, 16, v43
    v_and_b32 v207, 0xffff0000, v43
    v_fma_f32 v200, v200, v228, v230
    v_fma_f32 v201, v201, v228, v230
    v_fma_f32 v202, v202, v228, v230
    v_fma_f32 v203, v203, v228, v230
    s_add_u32 s65, s65, s75
    s_add_u32 m0, s66, 0x1a000
    s_nop 0
    buffer_load_dwordx4 v224, s[32:35], s64 offen lds
    s_add_u32 s64, s64, 0x2a000
    s_cmp_eq_u32 s64, 0x126000
    s_cselect_b32 s64, 0, s64
    s_nop 0
    v_fma_f32 v204, v204, v228, v230
    v_fma_f32 v205, v205, v228, v230
    v_fma_f32 v206, v206, v228, v230
    v_fma_f32 v207, v207, v228, v230
    v_cvt_pk_bf16_f32 v40, v200, v201
    v_cvt_pk_bf16_f32 v41, v202, v203
    v_cvt_pk_bf16_f32 v42, v204, v205
    v_cvt_pk_bf16_f32 v43, v206, v207
    s_barrier
    s_waitcnt lgkmcnt(5)
    v_mfma_f32_32x32x16_bf16 v[64:79], v[160:163], v[184:187], v[64:79]
    ds_read_b128 v[192:195], v223 offset:17952
    ds_read_b64_tr_b16 v[172:173], v216 offset:4096
    s_waitcnt lgkmcnt(6)
    s_nop 0
    v_mfma_f32_32x32x16_bf16 v[80:95], v[160:163], v[188:191], v[80:95]
    ds_read_b64_tr_b16 v[174:175], v216 offset:5120
    ds_read_b128 v[196:199], v223 offset:22176
    s_waitcnt lgkmcnt(6)
    s_nop 0
    v_mfma_f32_32x32x16_bf16 v[96:111], v[164:167], v[184:187], v[96:111]
    ds_read_b64_tr_b16 v[176:177], v218 offset:4096
    ds_read_b64_tr_b16 v[178:179], v218 offset:5120
    v_mfma_f32_32x32x16_bf16 v[112:127], v[164:167], v[188:191], v[112:127]
    ds_read_b64_tr_b16 v[180:181], v220 offset:4096
    ds_read_b64_tr_b16 v[182:183], v220 offset:5120
    s_waitcnt lgkmcnt(8)
    v_mfma_f32_32x32x16_bf16 v[128:143], v[168:171], v[184:187], v[128:143]
    v_mfma_f32_32x32x16_bf16 v[144:159], v[168:171], v[188:191], v[144:159]
    s_waitcnt lgkmcnt(5)
    v_mfma_f32_32x32x16_bf16 v[64:79], v[172:175], v[192:195], v[64:79]
    ds_read_b128 v[184:187], v223 offset:19008
    ds_read_b64_tr_b16 v[160:161], v216 offset:16384
    s_waitcnt lgkmcnt(6)
    s_nop 0
    v_mfma_f32_32x32x16_bf16 v[80:95], v[172:175], v[196:199], v[80:95]
    ds_read_b64_tr_b16 v[162:163], v216 offset:17408
    ds_read_b128 v[188:191], v223 offset:23232
    s_waitcnt lgkmcnt(6)
    s_nop 0
    v_mfma_f32_32x32x16_bf16 v[96:111], v[176:179], v[192:195], v[96:111]
    ds_read_b64_tr_b16 v[164:165], v218 offset:16384
    ds_read_b64_tr_b16 v[166:167], v218 offset:17408
    v_mfma_f32_32x32x16_bf16 v[112:127], v[176:179], v[196:199], v[112:127]
    ds_read_b64_tr_b16 v[168:169], v220 offset:16384
    ds_read_b64_tr_b16 v[170:171], v220 offset:17408
    s_waitcnt lgkmcnt(8)
    s_nop 0
    v_mfma_f32_32x32x16_bf16 v[128:143], v[180:183], v[192:195], v[128:143]
    v_mfma_f32_32x32x16_bf16 v[144:159], v[180:183], v[196:199], v[144:159]
    s_add_u32 m0, s66, 0x14000
    s_nop 0
    buffer_load_dwordx4 v225, s[36:39], s65 offen lds
    ds_write_b128 v222, v[40:43] offset:0
    v_lshlrev_b32 v200, 16, v44
    v_and_b32 v201, 0xffff0000, v44
    v_lshlrev_b32_e64 v202, 16, v45
    v_and_b32 v203, 0xffff0000, v45
    v_lshlrev_b32_e64 v204, 16, v46
    v_and_b32 v205, 0xffff0000, v46
    v_lshlrev_b32_e64 v206, 16, v47
    v_and_b32 v207, 0xffff0000, v47
    v_fma_f32 v200, v200, v229, v231
    v_fma_f32 v201, v201, v229, v231
    s_add_u32 m0, s66, 0x16000
    s_nop 0
    buffer_load_dwordx4 v226, s[40:43], s65 offen lds
    s_add_u32 s65, s65, s75
    s_cmp_eq_u32 s65, s76
    s_cselect_b32 s65, 0, s65
    v_fma_f32 v202, v202, v229, v231
    v_fma_f32 v203, v203, v229, v231
    v_fma_f32 v204, v204, v229, v231
    v_fma_f32 v205, v205, v229, v231
    v_fma_f32 v206, v206, v229, v231
    v_fma_f32 v207, v207, v229, v231
    v_cvt_pk_bf16_f32 v44, v200, v201
    v_cvt_pk_bf16_f32 v45, v202, v203
    v_cvt_pk_bf16_f32 v46, v204, v205
    v_cvt_pk_bf16_f32 v47, v206, v207
    ds_write_b128 v222, v[44:47] offset:128
    s_waitcnt vmcnt(2) lgkmcnt(0)
    s_barrier
    v_mfma_f32_32x32x16_bf16 v[64:79], v[160:163], v[184:187], v[64:79]
    ds_read_b128 v[192:195], v223 offset:20064
    ds_read_b64_tr_b16 v[172:173], v216 offset:20480
    v_mfma_f32_32x32x16_bf16 v[80:95], v[160:163], v[188:191], v[80:95]
    ds_read_b64_tr_b16 v[174:175], v216 offset:21504
    ds_read_b128 v[196:199], v223 offset:24288
    v_mfma_f32_32x32x16_bf16 v[96:111], v[164:167], v[184:187], v[96:111]
    ds_read_b64_tr_b16 v[176:177], v218 offset:20480
    ds_read_b64_tr_b16 v[178:179], v218 offset:21504
    v_mfma_f32_32x32x16_bf16 v[112:127], v[164:167], v[188:191], v[112:127]
    ds_read_b64_tr_b16 v[180:181], v220 offset:20480
    ds_read_b64_tr_b16 v[182:183], v220 offset:21504
    v_mfma_f32_32x32x16_bf16 v[128:143], v[168:171], v[184:187], v[128:143]
    v_mfma_f32_32x32x16_bf16 v[144:159], v[168:171], v[188:191], v[144:159]
    s_waitcnt lgkmcnt(5)
    s_nop 0
    v_mfma_f32_32x32x16_bf16 v[64:79], v[172:175], v[192:195], v[64:79]
    ds_read_b128 v[184:187], v223 offset:0
    ds_read_b64_tr_b16 v[160:161], v216 offset:32768
    s_waitcnt lgkmcnt(6)
    s_nop 0
    v_mfma_f32_32x32x16_bf16 v[80:95], v[172:175], v[196:199], v[80:95]
    ds_read_b64_tr_b16 v[162:163], v216 offset:33792
    ds_read_b128 v[188:191], v223 offset:4224
    s_waitcnt lgkmcnt(6)
    s_nop 0
    v_mfma_f32_32x32x16_bf16 v[96:111], v[176:179], v[192:195], v[96:111]
    ds_read_b64_tr_b16 v[164:165], v218 offset:32768
    ds_read_b64_tr_b16 v[166:167], v218 offset:33792
    v_mfma_f32_32x32x16_bf16 v[112:127], v[176:179], v[196:199], v[112:127]
    ds_read_b64_tr_b16 v[168:169], v220 offset:32768
    ds_read_b64_tr_b16 v[170:171], v220 offset:33792
    s_waitcnt lgkmcnt(8)
    v_mfma_f32_32x32x16_bf16 v[128:143], v[180:183], v[192:195], v[128:143]
    v_mfma_f32_32x32x16_bf16 v[144:159], v[180:183], v[196:199], v[144:159]
    s_add_u32 m0, s66, 0
    s_nop 0
    buffer_load_dwordx4 v225, s[36:39], s65 offen lds
    v_lshlrev_b32 v200, 16, v48
    v_and_b32 v201, 0xffff0000, v48
    v_lshlrev_b32_e64 v202, 16, v49
    v_and_b32 v203, 0xffff0000, v49
    v_lshlrev_b32_e64 v204, 16, v50
    v_and_b32 v205, 0xffff0000, v50
    s_add_u32 m0, s66, 0x2000
    s_nop 0
    buffer_load_dwordx4 v226, s[40:43], s65 offen lds
    v_lshlrev_b32 v206, 16, v51
    v_and_b32 v207, 0xffff0000, v51
    v_fma_f32 v200, v200, v228, v230
    v_fma_f32 v201, v201, v228, v230
    v_fma_f32 v202, v202, v228, v230
    v_fma_f32 v203, v203, v228, v230
    s_add_u32 s65, s65, s75
    s_add_u32 m0, s66, 0x1c000
    s_nop 0
    buffer_load_dwordx4 v224, s[32:35], s64 offen lds
    s_add_u32 s64, s64, 0x2a000
    s_cmp_eq_u32 s64, 0x126000
    s_cselect_b32 s64, 0, s64
    s_nop 0
    v_fma_f32 v204, v204, v228, v230
    v_fma_f32 v205, v205, v228, v230
    v_fma_f32 v206, v206, v228, v230
    v_fma_f32 v207, v207, v228, v230
    v_cvt_pk_bf16_f32 v48, v200, v201
    v_cvt_pk_bf16_f32 v49, v202, v203
    v_cvt_pk_bf16_f32 v50, v204, v205
    v_cvt_pk_bf16_f32 v51, v206, v207
    s_barrier
    s_waitcnt lgkmcnt(5)
    v_mfma_f32_32x32x16_bf16 v[64:79], v[160:163], v[184:187], v[64:79]
    ds_read_b128 v[192:195], v223 offset:1056
    ds_read_b64_tr_b16 v[172:173], v216 offset:36864
    s_waitcnt lgkmcnt(6)
    s_nop 0
    v_mfma_f32_32x32x16_bf16 v[80:95], v[160:163], v[188:191], v[80:95]
    ds_read_b64_tr_b16 v[174:175], v216 offset:37888
    ds_read_b128 v[196:199], v223 offset:5280
    s_waitcnt lgkmcnt(6)
    s_nop 0
    v_mfma_f32_32x32x16_bf16 v[96:111], v[164:167], v[184:187], v[96:111]
    ds_read_b64_tr_b16 v[176:177], v218 offset:36864
    ds_read_b64_tr_b16 v[178:179], v218 offset:37888
    v_mfma_f32_32x32x16_bf16 v[112:127], v[164:167], v[188:191], v[112:127]
    ds_read_b64_tr_b16 v[180:181], v220 offset:36864
    ds_read_b64_tr_b16 v[182:183], v220 offset:37888
    s_waitcnt lgkmcnt(8)
    v_mfma_f32_32x32x16_bf16 v[128:143], v[168:171], v[184:187], v[128:143]
    v_mfma_f32_32x32x16_bf16 v[144:159], v[168:171], v[188:191], v[144:159]
    s_waitcnt lgkmcnt(5)
    v_mfma_f32_32x32x16_bf16 v[64:79], v[172:175], v[192:195], v[64:79]
    ds_read_b128 v[184:187], v223 offset:2112
    ds_read_b64_tr_b16 v[160:161], v217 offset:0
    s_waitcnt lgkmcnt(6)
    s_nop 0
    v_mfma_f32_32x32x16_bf16 v[80:95], v[172:175], v[196:199], v[80:95]
    ds_read_b64_tr_b16 v[162:163], v217 offset:1024
    ds_read_b128 v[188:191], v223 offset:6336
    s_waitcnt lgkmcnt(6)
    s_nop 0
    v_mfma_f32_32x32x16_bf16 v[96:111], v[176:179], v[192:195], v[96:111]
    ds_read_b64_tr_b16 v[164:165], v219 offset:0
    ds_read_b64_tr_b16 v[166:167], v219 offset:1024
    v_mfma_f32_32x32x16_bf16 v[112:127], v[176:179], v[196:199], v[112:127]
    ds_read_b64_tr_b16 v[168:169], v221 offset:0
    ds_read_b64_tr_b16 v[170:171], v221 offset:1024
    s_waitcnt lgkmcnt(8)
    s_nop 0
    v_mfma_f32_32x32x16_bf16 v[128:143], v[180:183], v[192:195], v[128:143]
    v_mfma_f32_32x32x16_bf16 v[144:159], v[180:183], v[196:199], v[144:159]
    s_add_u32 m0, s66, 0x4000
    s_nop 0
    buffer_load_dwordx4 v225, s[36:39], s65 offen lds
    ds_write_b128 v222, v[48:51] offset:16896
    v_lshlrev_b32 v200, 16, v52
    v_and_b32 v201, 0xffff0000, v52
    v_lshlrev_b32_e64 v202, 16, v53
    v_and_b32 v203, 0xffff0000, v53
    v_lshlrev_b32_e64 v204, 16, v54
    v_and_b32 v205, 0xffff0000, v54
    v_lshlrev_b32_e64 v206, 16, v55
    v_and_b32 v207, 0xffff0000, v55
    v_fma_f32 v200, v200, v229, v231
    v_fma_f32 v201, v201, v229, v231
    s_add_u32 m0, s66, 0x6000
    s_nop 0
    s_nop 0
    buffer_load_dwordx4 v226, s[40:43], s65 offen lds
    v_fma_f32 v202, v202, v229, v231
    v_fma_f32 v203, v203, v229, v231
    v_fma_f32 v204, v204, v229, v231
    v_fma_f32 v205, v205, v229, v231
    v_fma_f32 v206, v206, v229, v231
    v_fma_f32 v207, v207, v229, v231
    v_cvt_pk_bf16_f32 v52, v200, v201
    v_cvt_pk_bf16_f32 v53, v202, v203
    v_cvt_pk_bf16_f32 v54, v204, v205
    v_cvt_pk_bf16_f32 v55, v206, v207
    ds_write_b128 v222, v[52:55] offset:17024
    s_mov_b32 s48, s18
    s_nop 0
    s_and_b32 s49, s19, 0xffff
    s_mov_b32 s50, 0x188000
    s_mov_b32 s51, 0x20000
    s_sub_u32 s62, s2, 32
    s_and_b32 s60, s62, 7
    s_lshr_b32 s61, s62, 3
    s_mul_i32 s62, s61, 37
    s_lshr_b32 s62, s62, 8
    s_lshl_b32 s67, s60, 2
    s_add_u32 s67, s67, s62
    s_mul_i32 s62, s62, 7
    s_sub_u32 s68, s61, s62
    s_lshl_b32 s60, s68, 7
    s_mul_i32 s69, s3, 0x62000
    s_add_u32 s69, s69, s60
    s_cmp_lt_u32 s2, 32
    s_cselect_b32 s69, 0x7fff0000, s69
    s_lshl_b32 s58, s3, 11
    v_lshrrev_b32 v1, 3, v0
    v_and_b32_e64 v2, 7, v0
    v_bfe_u32 v3, v0, 4, 1
    v_lshlrev_b32 v3, 2, v3
    v_xor_b32 v2, v2, v3
    v_mul_u32_u24 v244, 0x380, v1
    v_lshl_add_u32 v244, v2, 4, v244
    s_waitcnt vmcnt(2) lgkmcnt(0)
    s_barrier
    v_mfma_f32_32x32x16_bf16 v[64:79], v[160:163], v[184:187], v[64:79]
    ds_read_b128 v[192:195], v223 offset:3168
    ds_read_b64_tr_b16 v[172:173], v217 offset:4096
    v_mfma_f32_32x32x16_bf16 v[80:95], v[160:163], v[188:191], v[80:95]
    ds_read_b64_tr_b16 v[174:175], v217 offset:5120
    ds_read_b128 v[196:199], v223 offset:7392
    v_mfma_f32_32x32x16_bf16 v[96:111], v[164:167], v[184:187], v[96:111]
    ds_read_b64_tr_b16 v[176:177], v219 offset:4096
    ds_read_b64_tr_b16 v[178:179], v219 offset:5120
    v_mfma_f32_32x32x16_bf16 v[112:127], v[164:167], v[188:191], v[112:127]
    ds_read_b64_tr_b16 v[180:181], v221 offset:4096
    ds_read_b64_tr_b16 v[182:183], v221 offset:5120
    v_mfma_f32_32x32x16_bf16 v[128:143], v[168:171], v[184:187], v[128:143]
    v_mfma_f32_32x32x16_bf16 v[144:159], v[168:171], v[188:191], v[144:159]
    s_waitcnt lgkmcnt(5)
    s_nop 0
    v_mfma_f32_32x32x16_bf16 v[64:79], v[172:175], v[192:195], v[64:79]
    ds_read_b128 v[184:187], v223 offset:16896
    ds_read_b64_tr_b16 v[160:161], v217 offset:16384
    s_waitcnt lgkmcnt(6)
    s_nop 0
    v_mfma_f32_32x32x16_bf16 v[80:95], v[172:175], v[196:199], v[80:95]
    ds_read_b64_tr_b16 v[162:163], v217 offset:17408
    ds_read_b128 v[188:191], v223 offset:21120
    s_waitcnt lgkmcnt(6)
    s_nop 0
    v_mfma_f32_32x32x16_bf16 v[96:111], v[176:179], v[192:195], v[96:111]
    ds_read_b64_tr_b16 v[164:165], v219 offset:16384
    ds_read_b64_tr_b16 v[166:167], v219 offset:17408
    v_mfma_f32_32x32x16_bf16 v[112:127], v[176:179], v[196:199], v[112:127]
    ds_read_b64_tr_b16 v[168:169], v221 offset:16384
    ds_read_b64_tr_b16 v[170:171], v221 offset:17408
    s_waitcnt lgkmcnt(8)
    s_nop 0
    v_mfma_f32_32x32x16_bf16 v[128:143], v[180:183], v[192:195], v[128:143]
    v_mfma_f32_32x32x16_bf16 v[144:159], v[180:183], v[196:199], v[144:159]
    s_add_u32 m0, s66, 0x18000
    s_nop 0
    buffer_load_dwordx4 v224, s[32:35], s64 offen lds
    v_lshlrev_b32 v200, 16, v56
    v_and_b32 v201, 0xffff0000, v56
    v_lshlrev_b32_e64 v202, 16, v57
    v_and_b32 v203, 0xffff0000, v57
    v_lshlrev_b32_e64 v204, 16, v58
    v_and_b32 v205, 0xffff0000, v58
    v_lshlrev_b32_e64 v206, 16, v59
    v_and_b32 v207, 0xffff0000, v59
    v_fma_f32 v200, v200, v228, v230
    v_fma_f32 v201, v201, v228, v230
    v_fma_f32 v202, v202, v228, v230
    v_fma_f32 v203, v203, v228, v230
    v_fma_f32 v204, v204, v228, v230
    v_fma_f32 v205, v205, v228, v230
    v_fma_f32 v206, v206, v228, v230
    v_fma_f32 v207, v207, v228, v230
    v_cvt_pk_bf16_f32 v56, v200, v201
    v_cvt_pk_bf16_f32 v57, v202, v203
    v_cvt_pk_bf16_f32 v58, v204, v205
    v_cvt_pk_bf16_f32 v59, v206, v207
    s_add_u32 s59, s69, 0
    s_add_u32 m0, s58, 0x8000
    s_nop 0
    buffer_load_dwordx4 v244, s[48:51], s59 offen lds
    s_add_u32 s59, s69, 0x1c00
    s_add_u32 m0, s58, 0x8400
    s_nop 0
    s_nop 0
    buffer_load_dwordx4 v244, s[48:51], s59 offen lds
    s_add_u32 s59, s69, 0x3800
    s_add_u32 m0, s58, 0xa000
    s_nop 0
    s_nop 0
    buffer_load_dwordx4 v244, s[48:51], s59 offen lds
    s_add_u32 s59, s69, 0x5400
    s_add_u32 m0, s58, 0xa400
    s_nop 0
    buffer_load_dwordx4 v244, s[48:51], s59 offen lds
    s_barrier
    s_waitcnt lgkmcnt(5)
    s_nop 0
    v_mfma_f32_32x32x16_bf16 v[64:79], v[160:163], v[184:187], v[64:79]
    ds_read_b128 v[192:195], v223 offset:17952
    ds_read_b64_tr_b16 v[172:173], v217 offset:20480
    s_waitcnt lgkmcnt(6)
    s_nop 0
    v_mfma_f32_32x32x16_bf16 v[80:95], v[160:163], v[188:191], v[80:95]
    ds_read_b64_tr_b16 v[174:175], v217 offset:21504
    ds_read_b128 v[196:199], v223 offset:22176
    s_waitcnt lgkmcnt(6)
    s_nop 0
    v_mfma_f32_32x32x16_bf16 v[96:111], v[164:167], v[184:187], v[96:111]
    ds_read_b64_tr_b16 v[176:177], v219 offset:20480
    ds_read_b64_tr_b16 v[178:179], v219 offset:21504
    v_mfma_f32_32x32x16_bf16 v[112:127], v[164:167], v[188:191], v[112:127]
    ds_read_b64_tr_b16 v[180:181], v221 offset:20480
    ds_read_b64_tr_b16 v[182:183], v221 offset:21504
    s_waitcnt lgkmcnt(8)
    v_mfma_f32_32x32x16_bf16 v[128:143], v[168:171], v[184:187], v[128:143]
    v_mfma_f32_32x32x16_bf16 v[144:159], v[168:171], v[188:191], v[144:159]
    s_waitcnt lgkmcnt(5)
    v_mfma_f32_32x32x16_bf16 v[64:79], v[172:175], v[192:195], v[64:79]
    ds_read_b128 v[184:187], v223 offset:19008
    ds_read_b64_tr_b16 v[160:161], v217 offset:32768
    s_waitcnt lgkmcnt(6)
    s_nop 0
    v_mfma_f32_32x32x16_bf16 v[80:95], v[172:175], v[196:199], v[80:95]
    ds_read_b64_tr_b16 v[162:163], v217 offset:33792
    ds_read_b128 v[188:191], v223 offset:23232
    s_waitcnt lgkmcnt(6)
    s_nop 0
    v_mfma_f32_32x32x16_bf16 v[96:111], v[176:179], v[192:195], v[96:111]
    ds_read_b64_tr_b16 v[164:165], v219 offset:32768
    ds_read_b64_tr_b16 v[166:167], v219 offset:33792
    v_mfma_f32_32x32x16_bf16 v[112:127], v[176:179], v[196:199], v[112:127]
    ds_read_b64_tr_b16 v[168:169], v221 offset:32768
    ds_read_b64_tr_b16 v[170:171], v221 offset:33792
    s_waitcnt lgkmcnt(8)
    s_nop 0
    v_mfma_f32_32x32x16_bf16 v[128:143], v[180:183], v[192:195], v[128:143]
    v_mfma_f32_32x32x16_bf16 v[144:159], v[180:183], v[196:199], v[144:159]
    ds_write_b128 v222, v[56:59] offset:0
    v_lshlrev_b32_e64 v200, 16, v60
    v_and_b32 v201, 0xffff0000, v60
    v_lshlrev_b32_e64 v202, 16, v61
    v_and_b32 v203, 0xffff0000, v61
    v_lshlrev_b32_e64 v204, 16, v62
    v_and_b32 v205, 0xffff0000, v62
    v_lshlrev_b32_e64 v206, 16, v63
    v_and_b32 v207, 0xffff0000, v63
    v_fma_f32 v200, v200, v229, v231
    v_fma_f32 v201, v201, v229, v231
    v_fma_f32 v202, v202, v229, v231
    v_fma_f32 v203, v203, v229, v231
    v_fma_f32 v204, v204, v229, v231
    v_fma_f32 v205, v205, v229, v231
    v_fma_f32 v206, v206, v229, v231
    v_fma_f32 v207, v207, v229, v231
    v_cvt_pk_bf16_f32 v60, v200, v201
    v_cvt_pk_bf16_f32 v61, v202, v203
    v_cvt_pk_bf16_f32 v62, v204, v205
    v_cvt_pk_bf16_f32 v63, v206, v207
    ds_write_b128 v222, v[60:63] offset:128
    s_add_u32 s59, s69, 0x7000
    s_add_u32 m0, s58, 0xc000
    s_nop 0
    s_nop 0
    buffer_load_dwordx4 v244, s[48:51], s59 offen lds
    s_add_u32 s59, s69, 0x8c00
    s_add_u32 m0, s58, 0xc400
    s_nop 0
    s_nop 0
    buffer_load_dwordx4 v244, s[48:51], s59 offen lds
    s_add_u32 s59, s69, 0xa800
    s_add_u32 m0, s58, 0xe000
    s_nop 0
    s_nop 0
    buffer_load_dwordx4 v244, s[48:51], s59 offen lds
    s_add_u32 s59, s69, 0xc400
    s_add_u32 m0, s58, 0xe400
    s_nop 0
    s_nop 0
    buffer_load_dwordx4 v244, s[48:51], s59 offen lds
    s_add_u32 s59, s69, 0xe000
    s_add_u32 m0, s58, 0x1a000
    s_nop 0
    s_nop 0
    buffer_load_dwordx4 v244, s[48:51], s59 offen lds
    s_add_u32 s59, s69, 0xfc00
    s_add_u32 m0, s58, 0x1a400
    s_nop 0
    buffer_load_dwordx4 v244, s[48:51], s59 offen lds
    s_waitcnt vmcnt(10) lgkmcnt(0)
    s_barrier
    s_nop 0
    v_mfma_f32_32x32x16_bf16 v[64:79], v[160:163], v[184:187], v[64:79]
    ds_read_b128 v[192:195], v223 offset:20064
    ds_read_b64_tr_b16 v[172:173], v217 offset:36864
    v_mfma_f32_32x32x16_bf16 v[80:95], v[160:163], v[188:191], v[80:95]
    ds_read_b64_tr_b16 v[174:175], v217 offset:37888
    ds_read_b128 v[196:199], v223 offset:24288
    v_mfma_f32_32x32x16_bf16 v[96:111], v[164:167], v[184:187], v[96:111]
    ds_read_b64_tr_b16 v[176:177], v219 offset:36864
    ds_read_b64_tr_b16 v[178:179], v219 offset:37888
    v_mfma_f32_32x32x16_bf16 v[112:127], v[164:167], v[188:191], v[112:127]
    ds_read_b64_tr_b16 v[180:181], v221 offset:36864
    ds_read_b64_tr_b16 v[182:183], v221 offset:37888
    v_mfma_f32_32x32x16_bf16 v[128:143], v[168:171], v[184:187], v[128:143]
    v_mfma_f32_32x32x16_bf16 v[144:159], v[168:171], v[188:191], v[144:159]
    s_waitcnt lgkmcnt(5)
    s_nop 0
    v_mfma_f32_32x32x16_bf16 v[64:79], v[172:175], v[192:195], v[64:79]
    ds_read_b128 v[184:187], v223 offset:0
    ds_read_b64_tr_b16 v[160:161], v216 offset:0
    s_waitcnt lgkmcnt(6)
    s_nop 0
    v_mfma_f32_32x32x16_bf16 v[80:95], v[172:175], v[196:199], v[80:95]
    ds_read_b64_tr_b16 v[162:163], v216 offset:1024
    ds_read_b128 v[188:191], v223 offset:4224
    s_waitcnt lgkmcnt(6)
    s_nop 0
    v_mfma_f32_32x32x16_bf16 v[96:111], v[176:179], v[192:195], v[96:111]
    ds_read_b64_tr_b16 v[164:165], v218 offset:0
    ds_read_b64_tr_b16 v[166:167], v218 offset:1024
    v_mfma_f32_32x32x16_bf16 v[112:127], v[176:179], v[196:199], v[112:127]
    ds_read_b64_tr_b16 v[168:169], v220 offset:0
    ds_read_b64_tr_b16 v[170:171], v220 offset:1024
    s_waitcnt lgkmcnt(8)
    v_mfma_f32_32x32x16_bf16 v[128:143], v[180:183], v[192:195], v[128:143]
    v_mfma_f32_32x32x16_bf16 v[144:159], v[180:183], v[196:199], v[144:159]
    s_mov_b32 s52, s22
    s_and_b32 s53, s23, 0xffff
    s_mov_b32 s54, 0x100
    s_mov_b32 s55, 0x20000
    v_lshlrev_b32_e64 v235, 2, v0
    buffer_load_dword v234, v235, s[52:55], 0 offen sc1
    s_add_u32 s59, s69, 0x11800
    s_add_u32 m0, s58, 0x10000
    s_nop 0
    s_nop 0
    buffer_load_dwordx4 v244, s[48:51], s59 offen lds
    s_add_u32 s59, s69, 0x13400
    s_add_u32 m0, s58, 0x10400
    s_nop 0
    s_nop 0
    buffer_load_dwordx4 v244, s[48:51], s59 offen lds
    s_add_u32 s59, s69, 0x15000
    s_add_u32 m0, s58, 0x12000
    s_nop 0
    s_nop 0
    buffer_load_dwordx4 v244, s[48:51], s59 offen lds
    s_add_u32 s59, s69, 0x16c00
    s_add_u32 m0, s58, 0x12400
    s_nop 0
    buffer_load_dwordx4 v244, s[48:51], s59 offen lds
    s_barrier
    s_waitcnt lgkmcnt(5)
    s_nop 0
    v_mfma_f32_32x32x16_bf16 v[64:79], v[160:163], v[184:187], v[64:79]
    ds_read_b128 v[192:195], v223 offset:1056
    ds_read_b64_tr_b16 v[172:173], v216 offset:4096
    s_waitcnt lgkmcnt(6)
    s_nop 0
    v_mfma_f32_32x32x16_bf16 v[80:95], v[160:163], v[188:191], v[80:95]
    ds_read_b64_tr_b16 v[174:175], v216 offset:5120
    ds_read_b128 v[196:199], v223 offset:5280
    s_waitcnt lgkmcnt(6)
    s_nop 0
    v_mfma_f32_32x32x16_bf16 v[96:111], v[164:167], v[184:187], v[96:111]
    ds_read_b64_tr_b16 v[176:177], v218 offset:4096
    ds_read_b64_tr_b16 v[178:179], v218 offset:5120
    v_mfma_f32_32x32x16_bf16 v[112:127], v[164:167], v[188:191], v[112:127]
    ds_read_b64_tr_b16 v[180:181], v220 offset:4096
    ds_read_b64_tr_b16 v[182:183], v220 offset:5120
    s_waitcnt lgkmcnt(8)
    v_mfma_f32_32x32x16_bf16 v[128:143], v[168:171], v[184:187], v[128:143]
    v_mfma_f32_32x32x16_bf16 v[144:159], v[168:171], v[188:191], v[144:159]
    s_waitcnt lgkmcnt(5)
    v_mfma_f32_32x32x16_bf16 v[64:79], v[172:175], v[192:195], v[64:79]
    ds_read_b128 v[184:187], v223 offset:2112
    ds_read_b64_tr_b16 v[160:161], v216 offset:16384
    s_waitcnt lgkmcnt(6)
    s_nop 0
    v_mfma_f32_32x32x16_bf16 v[80:95], v[172:175], v[196:199], v[80:95]
    ds_read_b64_tr_b16 v[162:163], v216 offset:17408
    ds_read_b128 v[188:191], v223 offset:6336
    s_waitcnt lgkmcnt(6)
    s_nop 0
    v_mfma_f32_32x32x16_bf16 v[96:111], v[176:179], v[192:195], v[96:111]
    ds_read_b64_tr_b16 v[164:165], v218 offset:16384
    ds_read_b64_tr_b16 v[166:167], v218 offset:17408
    v_mfma_f32_32x32x16_bf16 v[112:127], v[176:179], v[196:199], v[112:127]
    ds_read_b64_tr_b16 v[168:169], v220 offset:16384
    ds_read_b64_tr_b16 v[170:171], v220 offset:17408
    s_waitcnt lgkmcnt(8)
    v_mfma_f32_32x32x16_bf16 v[128:143], v[180:183], v[192:195], v[128:143]
    v_mfma_f32_32x32x16_bf16 v[144:159], v[180:183], v[196:199], v[144:159]
    v_mov_b32 v208, 0
    v_mov_b32 v209, 0x26000
    ds_write_b32 v209, v208
    s_add_u32 s59, s69, 0x18800
    s_add_u32 m0, s58, 0x14000
    s_nop 0
    s_nop 0
    buffer_load_dwordx4 v244, s[48:51], s59 offen lds
    s_add_u32 s59, s69, 0x1a400
    s_add_u32 m0, s58, 0x14400
    s_nop 0
    s_nop 0
    buffer_load_dwordx4 v244, s[48:51], s59 offen lds
    s_add_u32 s59, s69, 0x1c000
    s_add_u32 m0, s58, 0x16000
    s_nop 0
    s_nop 0
    buffer_load_dwordx4 v244, s[48:51], s59 offen lds
    s_add_u32 s59, s69, 0x1dc00
    s_add_u32 m0, s58, 0x16400
    s_nop 0
    s_nop 0
    buffer_load_dwordx4 v244, s[48:51], s59 offen lds
    s_add_u32 s59, s69, 0x1f800
    s_add_u32 m0, s58, 0x1c000
    s_nop 0
    s_nop 0
    buffer_load_dwordx4 v244, s[48:51], s59 offen lds
    s_add_u32 s59, s69, 0x21400
    s_add_u32 m0, s58, 0x1c400
    s_nop 0
    buffer_load_dwordx4 v244, s[48:51], s59 offen lds
    s_waitcnt lgkmcnt(0)
    s_barrier
    s_nop 0
    v_mfma_f32_32x32x16_bf16 v[64:79], v[160:163], v[184:187], v[64:79]
    ds_read_b128 v[192:195], v223 offset:3168
    ds_read_b64_tr_b16 v[172:173], v216 offset:20480
    v_mfma_f32_32x32x16_bf16 v[80:95], v[160:163], v[188:191], v[80:95]
    ds_read_b64_tr_b16 v[174:175], v216 offset:21504
    ds_read_b128 v[196:199], v223 offset:7392
    v_mfma_f32_32x32x16_bf16 v[96:111], v[164:167], v[184:187], v[96:111]
    ds_read_b64_tr_b16 v[176:177], v218 offset:20480
    ds_read_b64_tr_b16 v[178:179], v218 offset:21504
    v_mfma_f32_32x32x16_bf16 v[112:127], v[164:167], v[188:191], v[112:127]
    ds_read_b64_tr_b16 v[180:181], v220 offset:20480
    ds_read_b64_tr_b16 v[182:183], v220 offset:21504
    v_mfma_f32_32x32x16_bf16 v[128:143], v[168:171], v[184:187], v[128:143]
    v_mfma_f32_32x32x16_bf16 v[144:159], v[168:171], v[188:191], v[144:159]
    s_waitcnt lgkmcnt(5)
    v_mfma_f32_32x32x16_bf16 v[64:79], v[172:175], v[192:195], v[64:79]
    s_waitcnt lgkmcnt(4)
    v_mfma_f32_32x32x16_bf16 v[80:95], v[172:175], v[196:199], v[80:95]
    s_waitcnt lgkmcnt(2)
    v_mfma_f32_32x32x16_bf16 v[96:111], v[176:179], v[192:195], v[96:111]
    v_mfma_f32_32x32x16_bf16 v[112:127], v[176:179], v[196:199], v[112:127]
    s_waitcnt lgkmcnt(0)
    v_mfma_f32_32x32x16_bf16 v[128:143], v[180:183], v[192:195], v[128:143]
    v_mfma_f32_32x32x16_bf16 v[144:159], v[180:183], v[196:199], v[144:159]
    s_add_u32 s59, s69, 0x23000
    s_add_u32 m0, s58, 0
    s_nop 0
    buffer_load_dwordx4 v244, s[48:51], s59 offen lds
    s_add_u32 s59, s69, 0x24c00
    s_add_u32 m0, s58, 0x400
    s_nop 0
    s_nop 0
    buffer_load_dwordx4 v244, s[48:51], s59 offen lds
    s_add_u32 s59, s69, 0x26800
    s_add_u32 m0, s58, 0x2000
    s_nop 0
    s_nop 0
    buffer_load_dwordx4 v244, s[48:51], s59 offen lds
    s_add_u32 s59, s69, 0x28400
    s_add_u32 m0, s58, 0x2400
    s_nop 0
    buffer_load_dwordx4 v244, s[48:51], s59 offen lds
    s_barrier
    s_waitcnt vmcnt(14)
    v_mov_b32 v234, v234
    v_cmp_ne_u32 vcc, 1, v234
    s_nop 4
    s_cbranch_vccz SP_Z_F0_OK
    s_mov_b32 s61, 0
SP_Z_F0:
    buffer_load_dword v234, v235, s[52:55], 0 offen sc1
    s_add_u32 s61, s61, 1
    s_cmp_gt_u32 s61, 0x20000
    s_cbranch_scc1 SP_Z_F0_OK
    s_waitcnt vmcnt(0)
    v_cmp_ne_u32 vcc, 1, v234
    s_nop 4
    s_cbranch_vccz SP_Z_F0_OK
    s_sleep 4
    s_branch SP_Z_F0
SP_Z_F0_OK:
    v_mov_b32 v56, 0xbdd2d3e8
    v_mov_b32 v57, 0xc0135761
    v_mov_b32_e64 v241, 1
    v_mov_b32 v240, 0x7fff0000
    v_cmp_eq_u32 vcc, 0, v0
    s_nop 1
    v_cndmask_b32 v242, v240, 0, vcc
    s_mov_b32 s36, s10
    s_nop 0
    s_and_b32 s37, s11, 0xffff
    s_mov_b32 s38, 0x62000
    s_mov_b32 s39, 0x20000
    s_mov_b32 s40, s20
    s_nop 0
    s_and_b32 s41, s21, 0xffff
    s_mov_b32 s42, 0x1c0000
    s_mov_b32 s43, 0x20000
    s_lshl_b32 s60, s68, 7
    s_mul_i32 s66, s3, 0x18800
    s_add_u32 s66, s66, s60
    v_cmp_gt_u32 vcc, 32, v0
    s_nop 1
    v_cndmask_b32 v245, v240, v244, vcc
    s_nop 0
    v_bfe_u32 v1, v0, 2, 2
    v_lshl_add_u32 v1, v237, 2, v1
    v_bfe_u32 v2, v0, 4, 1
    v_and_b32 v3, 3, v0
    v_lshlrev_b32 v3, 3, v3
    v_lshl_add_u32 v2, v2, 5, v3
    v_bfe_u32 v3, v0, 3, 1
    v_lshlrev_b32 v3, 6, v3
    v_xor_b32 v2, v2, v3
    v_lshl_add_u32 v246, v1, 7, v2
    v_add_u32 v246, s58, v246
    v_xor_b32 v238, 64, v246
    v_add_u32 v247, 0xe000, v246
    v_add_u32 v239, 0xe000, v238
    s_add_u32 s63, s70, 0x24000
    s_add_u32 s78, s70, 0x800
    s_add_u32 s79, s63, 0x800
    s_add_u32 s59, s69, 0x2a000
    s_add_u32 m0, s58, 0x4000
    s_nop 0
    s_nop 0
    buffer_load_dwordx4 v244, s[48:51], s59 offen lds
    v_pk_mul_f32 v[40:41], v[64:65], v[64:65]
    v_pk_mul_f32 v[42:43], v[66:67], v[66:67]
    v_pk_mul_f32 v[44:45], v[68:69], v[68:69]
    v_pk_mul_f32 v[46:47], v[70:71], v[70:71]
    v_pk_fma_f32 v[40:41], v[40:41], v[56:57], v[56:57] op_sel:[0,0,1] op_sel_hi:[1,0,1]
    v_pk_fma_f32 v[42:43], v[42:43], v[56:57], v[56:57] op_sel:[0,0,1] op_sel_hi:[1,0,1]
    v_pk_fma_f32 v[44:45], v[44:45], v[56:57], v[56:57] op_sel:[0,0,1] op_sel_hi:[1,0,1]
    v_pk_fma_f32 v[46:47], v[46:47], v[56:57], v[56:57] op_sel:[0,0,1] op_sel_hi:[1,0,1]
    v_pk_mul_f32 v[40:41], v[40:41], v[64:65]
    v_pk_mul_f32 v[42:43], v[42:43], v[66:67]
    v_pk_mul_f32 v[44:45], v[44:45], v[68:69]
    v_pk_mul_f32 v[46:47], v[46:47], v[70:71]
    v_exp_f32 v40, v40
    v_exp_f32 v41, v41
    v_pk_mul_f32 v[72:73], v[64:65], v[72:73]
    v_exp_f32 v42, v42
    v_exp_f32 v43, v43
    v_pk_mul_f32 v[74:75], v[66:67], v[74:75]
    v_exp_f32 v44, v44
    v_exp_f32 v45, v45
    v_pk_mul_f32 v[76:77], v[68:69], v[76:77]
    v_exp_f32_e64 v46, v46
    s_add_u32 s59, s69, 0x2bc00
    s_add_u32 m0, s58, 0x4400
    s_nop 0
    buffer_load_dwordx4 v244, s[48:51], s59 offen lds
    v_exp_f32 v47, v47
    v_pk_mul_f32 v[78:79], v[70:71], v[78:79]
    v_pk_add_f32 v[40:41], v[40:41], 1.0 op_sel_hi:[1,0]
    v_pk_add_f32 v[42:43], v[42:43], 1.0 op_sel_hi:[1,0]
    v_pk_add_f32 v[44:45], v[44:45], 1.0 op_sel_hi:[1,0]
    v_pk_add_f32 v[46:47], v[46:47], 1.0 op_sel_hi:[1,0]
    v_rcp_f32 v40, v40
    v_rcp_f32 v41, v41
    v_rcp_f32 v42, v42
    v_rcp_f32 v43, v43
    v_rcp_f32 v44, v44
    v_rcp_f32 v45, v45
    v_rcp_f32 v46, v46
    v_rcp_f32 v47, v47
    v_pk_mul_f32 v[40:41], v[40:41], v[72:73]
    v_pk_mul_f32 v[42:43], v[42:43], v[74:75]
    v_pk_mul_f32 v[44:45], v[44:45], v[76:77]
    v_pk_mul_f32 v[46:47], v[46:47], v[78:79]
    v_cvt_pk_bf16_f32 v160, v40, v41
    v_cvt_pk_bf16_f32 v161, v42, v43
    v_cvt_pk_bf16_f32 v162, v44, v45
    v_cvt_pk_bf16_f32 v163, v46, v47
    s_add_u32 s59, s69, 0x2d800
    s_add_u32 m0, s58, 0x6000
    s_nop 0
    s_nop 0
    buffer_load_dwordx4 v244, s[48:51], s59 offen lds
    buffer_store_dwordx4 v[160:163], v227, s[44:47], s70 offen offset:0 sc1
    v_pk_mul_f32 v[48:49], v[80:81], v[80:81]
    v_pk_mul_f32 v[50:51], v[82:83], v[82:83]
    v_pk_mul_f32 v[52:53], v[84:85], v[84:85]
    v_pk_mul_f32 v[54:55], v[86:87], v[86:87]
    v_pk_fma_f32 v[48:49], v[48:49], v[56:57], v[56:57] op_sel:[0,0,1] op_sel_hi:[1,0,1]
    v_pk_fma_f32 v[50:51], v[50:51], v[56:57], v[56:57] op_sel:[0,0,1] op_sel_hi:[1,0,1]
    v_pk_fma_f32 v[52:53], v[52:53], v[56:57], v[56:57] op_sel:[0,0,1] op_sel_hi:[1,0,1]
    v_pk_fma_f32 v[54:55], v[54:55], v[56:57], v[56:57] op_sel:[0,0,1] op_sel_hi:[1,0,1]
    v_pk_mul_f32 v[48:49], v[48:49], v[80:81]
    v_pk_mul_f32 v[50:51], v[50:51], v[82:83]
    v_pk_mul_f32 v[52:53], v[52:53], v[84:85]
    v_pk_mul_f32 v[54:55], v[54:55], v[86:87]
    v_exp_f32 v48, v48
    v_exp_f32 v49, v49
    v_pk_mul_f32 v[88:89], v[80:81], v[88:89]
    v_exp_f32 v50, v50
    v_exp_f32 v51, v51
    v_pk_mul_f32 v[90:91], v[82:83], v[90:91]
    v_exp_f32 v52, v52
    v_exp_f32 v53, v53
    v_pk_mul_f32 v[92:93], v[84:85], v[92:93]
    s_add_u32 s59, s69, 0x2f400
    s_add_u32 m0, s58, 0x6400
    s_nop 0
    buffer_load_dwordx4 v244, s[48:51], s59 offen lds
    v_exp_f32 v54, v54
    v_exp_f32_e64 v55, v55
    v_pk_mul_f32 v[94:95], v[86:87], v[94:95]
    v_pk_add_f32 v[48:49], v[48:49], 1.0 op_sel_hi:[1,0]
    v_pk_add_f32 v[50:51], v[50:51], 1.0 op_sel_hi:[1,0]
    v_pk_add_f32 v[52:53], v[52:53], 1.0 op_sel_hi:[1,0]
    v_pk_add_f32 v[54:55], v[54:55], 1.0 op_sel_hi:[1,0]
    v_rcp_f32 v48, v48
    v_rcp_f32 v49, v49
    v_rcp_f32 v50, v50
    v_rcp_f32 v51, v51
    v_rcp_f32 v52, v52
    v_rcp_f32 v53, v53
    v_rcp_f32 v54, v54
    v_rcp_f32 v55, v55
    v_pk_mul_f32 v[48:49], v[48:49], v[88:89]
    v_pk_mul_f32 v[50:51], v[50:51], v[90:91]
    v_pk_mul_f32 v[52:53], v[52:53], v[92:93]
    v_pk_mul_f32 v[54:55], v[54:55], v[94:95]
    v_cvt_pk_bf16_f32 v164, v48, v49
    v_cvt_pk_bf16_f32 v165, v50, v51
    v_cvt_pk_bf16_f32 v166, v52, v53
    s_add_u32 s59, s69, 0x31000
    s_add_u32 m0, s58, 0x18000
    s_nop 0
    s_nop 0
    buffer_load_dwordx4 v244, s[48:51], s59 offen lds
    v_cvt_pk_bf16_f32 v167, v54, v55
    buffer_store_dwordx4 v[164:167], v227, s[44:47], s63 offen offset:0 sc1
    v_pk_mul_f32 v[40:41], v[96:97], v[96:97]
    v_pk_mul_f32 v[42:43], v[98:99], v[98:99]
    v_pk_mul_f32 v[44:45], v[100:101], v[100:101]
    v_pk_mul_f32 v[46:47], v[102:103], v[102:103]
    v_pk_fma_f32 v[40:41], v[40:41], v[56:57], v[56:57] op_sel:[0,0,1] op_sel_hi:[1,0,1]
    v_pk_fma_f32 v[42:43], v[42:43], v[56:57], v[56:57] op_sel:[0,0,1] op_sel_hi:[1,0,1]
    v_pk_fma_f32 v[44:45], v[44:45], v[56:57], v[56:57] op_sel:[0,0,1] op_sel_hi:[1,0,1]
    v_pk_fma_f32 v[46:47], v[46:47], v[56:57], v[56:57] op_sel:[0,0,1] op_sel_hi:[1,0,1]
    v_pk_mul_f32 v[40:41], v[40:41], v[96:97]
    v_pk_mul_f32 v[42:43], v[42:43], v[98:99]
    v_pk_mul_f32 v[44:45], v[44:45], v[100:101]
    v_pk_mul_f32 v[46:47], v[46:47], v[102:103]
    v_exp_f32 v40, v40
    v_exp_f32 v41, v41
    v_pk_mul_f32 v[104:105], v[96:97], v[104:105]
    v_exp_f32 v42, v42
    v_exp_f32 v43, v43
    v_pk_mul_f32 v[106:107], v[98:99], v[106:107]
    v_exp_f32 v44, v44
    v_exp_f32 v45, v45
    s_add_u32 s59, s69, 0x32c00
    s_add_u32 m0, s58, 0x18400
    s_nop 0
    buffer_load_dwordx4 v244, s[48:51], s59 offen lds
    v_pk_mul_f32 v[108:109], v[100:101], v[108:109]
    v_exp_f32 v46, v46
    v_exp_f32_e64 v47, v47
    v_pk_mul_f32 v[110:111], v[102:103], v[110:111]
    v_pk_add_f32 v[40:41], v[40:41], 1.0 op_sel_hi:[1,0]
    v_pk_add_f32 v[42:43], v[42:43], 1.0 op_sel_hi:[1,0]
    v_pk_add_f32 v[44:45], v[44:45], 1.0 op_sel_hi:[1,0]
    v_pk_add_f32 v[46:47], v[46:47], 1.0 op_sel_hi:[1,0]
    v_rcp_f32 v40, v40
    v_rcp_f32 v41, v41
    v_rcp_f32 v42, v42
    v_rcp_f32 v43, v43
    v_rcp_f32 v44, v44
    v_rcp_f32 v45, v45
    v_rcp_f32 v46, v46
    v_rcp_f32 v47, v47
    v_pk_mul_f32 v[40:41], v[40:41], v[104:105]
    v_pk_mul_f32 v[42:43], v[42:43], v[106:107]
    v_pk_mul_f32 v[44:45], v[44:45], v[108:109]
    v_pk_mul_f32 v[46:47], v[46:47], v[110:111]
    v_cvt_pk_bf16_f32 v168, v40, v41
    v_cvt_pk_bf16_f32 v169, v42, v43
    v_cvt_pk_bf16_f32 v170, v44, v45
    v_cvt_pk_bf16_f32 v171, v46, v47
    buffer_store_dwordx4 v[168:171], v227, s[44:47], s70 offen offset:1024 sc1
    v_pk_mul_f32 v[48:49], v[112:113], v[112:113]
    v_pk_mul_f32 v[50:51], v[114:115], v[114:115]
    v_pk_mul_f32 v[52:53], v[116:117], v[116:117]
    v_pk_mul_f32 v[54:55], v[118:119], v[118:119]
    v_pk_fma_f32 v[48:49], v[48:49], v[56:57], v[56:57] op_sel:[0,0,1] op_sel_hi:[1,0,1]
    v_pk_fma_f32 v[50:51], v[50:51], v[56:57], v[56:57] op_sel:[0,0,1] op_sel_hi:[1,0,1]
    v_pk_fma_f32 v[52:53], v[52:53], v[56:57], v[56:57] op_sel:[0,0,1] op_sel_hi:[1,0,1]
    v_pk_fma_f32 v[54:55], v[54:55], v[56:57], v[56:57] op_sel:[0,0,1] op_sel_hi:[1,0,1]
    v_pk_mul_f32 v[48:49], v[48:49], v[112:113]
    v_pk_mul_f32 v[50:51], v[50:51], v[114:115]
    v_pk_mul_f32 v[52:53], v[52:53], v[116:117]
    v_pk_mul_f32 v[54:55], v[54:55], v[118:119]
    v_exp_f32 v48, v48
    v_exp_f32 v49, v49
    v_pk_mul_f32 v[120:121], v[112:113], v[120:121]
    v_exp_f32 v50, v50
    v_exp_f32 v51, v51
    v_pk_mul_f32 v[122:123], v[114:115], v[122:123]
    v_exp_f32 v52, v52
    v_exp_f32 v53, v53
    v_pk_mul_f32 v[124:125], v[116:117], v[124:125]
    v_exp_f32 v54, v54
    v_exp_f32 v55, v55
    v_pk_mul_f32 v[126:127], v[118:119], v[126:127]
    v_pk_add_f32 v[48:49], v[48:49], 1.0 op_sel_hi:[1,0]
    v_pk_add_f32 v[50:51], v[50:51], 1.0 op_sel_hi:[1,0]
    v_pk_add_f32 v[52:53], v[52:53], 1.0 op_sel_hi:[1,0]
    v_pk_add_f32 v[54:55], v[54:55], 1.0 op_sel_hi:[1,0]
    v_rcp_f32 v48, v48
    v_rcp_f32 v49, v49
    v_rcp_f32 v50, v50
    v_rcp_f32 v51, v51
    v_rcp_f32 v52, v52
    v_rcp_f32 v53, v53
    v_rcp_f32 v54, v54
    v_rcp_f32 v55, v55
    v_pk_mul_f32 v[48:49], v[48:49], v[120:121]
    v_pk_mul_f32 v[50:51], v[50:51], v[122:123]
    v_pk_mul_f32 v[52:53], v[52:53], v[124:125]
    v_pk_mul_f32 v[54:55], v[54:55], v[126:127]
    v_cvt_pk_bf16_f32 v172, v48, v49
    v_cvt_pk_bf16_f32 v173, v50, v51
    v_cvt_pk_bf16_f32 v174, v52, v53
    v_cvt_pk_bf16_f32 v175, v54, v55
    buffer_store_dwordx4 v[172:175], v227, s[44:47], s63 offen offset:1024 sc1
    v_pk_mul_f32 v[40:41], v[128:129], v[128:129]
    v_pk_mul_f32 v[42:43], v[130:131], v[130:131]
    v_pk_mul_f32 v[44:45], v[132:133], v[132:133]
    v_pk_mul_f32 v[46:47], v[134:135], v[134:135]
    v_pk_fma_f32 v[40:41], v[40:41], v[56:57], v[56:57] op_sel:[0,0,1] op_sel_hi:[1,0,1]
    v_pk_fma_f32 v[42:43], v[42:43], v[56:57], v[56:57] op_sel:[0,0,1] op_sel_hi:[1,0,1]
    v_pk_fma_f32 v[44:45], v[44:45], v[56:57], v[56:57] op_sel:[0,0,1] op_sel_hi:[1,0,1]
    v_pk_fma_f32 v[46:47], v[46:47], v[56:57], v[56:57] op_sel:[0,0,1] op_sel_hi:[1,0,1]
    v_pk_mul_f32 v[40:41], v[40:41], v[128:129]
    v_pk_mul_f32 v[42:43], v[42:43], v[130:131]
    v_pk_mul_f32 v[44:45], v[44:45], v[132:133]
    v_pk_mul_f32 v[46:47], v[46:47], v[134:135]
    v_exp_f32 v40, v40
    v_exp_f32 v41, v41
    v_pk_mul_f32 v[136:137], v[128:129], v[136:137]
    v_exp_f32 v42, v42
    v_exp_f32 v43, v43
    v_pk_mul_f32 v[138:139], v[130:131], v[138:139]
    v_exp_f32 v44, v44
    v_exp_f32 v45, v45
    v_pk_mul_f32 v[140:141], v[132:133], v[140:141]
    v_exp_f32 v46, v46
    v_exp_f32 v47, v47
    v_pk_mul_f32 v[142:143], v[134:135], v[142:143]
    v_pk_add_f32 v[40:41], v[40:41], 1.0 op_sel_hi:[1,0]
    v_pk_add_f32 v[42:43], v[42:43], 1.0 op_sel_hi:[1,0]
    v_pk_add_f32 v[44:45], v[44:45], 1.0 op_sel_hi:[1,0]
    v_pk_add_f32 v[46:47], v[46:47], 1.0 op_sel_hi:[1,0]
    v_rcp_f32 v40, v40
    v_rcp_f32 v41, v41
    v_rcp_f32 v42, v42
    v_rcp_f32 v43, v43
    v_rcp_f32 v44, v44
    v_rcp_f32 v45, v45
    v_rcp_f32 v46, v46
    v_rcp_f32 v47, v47
    v_pk_mul_f32 v[40:41], v[40:41], v[136:137]
    v_pk_mul_f32 v[42:43], v[42:43], v[138:139]
    v_pk_mul_f32 v[44:45], v[44:45], v[140:141]
    v_pk_mul_f32 v[46:47], v[46:47], v[142:143]
    v_cvt_pk_bf16_f32 v176, v40, v41
    v_cvt_pk_bf16_f32 v177, v42, v43
    v_cvt_pk_bf16_f32 v178, v44, v45
    v_cvt_pk_bf16_f32 v179, v46, v47
    buffer_store_dwordx4 v[176:179], v227, s[44:47], s78 offen offset:0 sc1
    v_pk_mul_f32 v[48:49], v[144:145], v[144:145]
    v_pk_mul_f32 v[50:51], v[146:147], v[146:147]
    v_pk_mul_f32 v[52:53], v[148:149], v[148:149]
    v_pk_mul_f32 v[54:55], v[150:151], v[150:151]
    v_pk_fma_f32 v[48:49], v[48:49], v[56:57], v[56:57] op_sel:[0,0,1] op_sel_hi:[1,0,1]
    v_pk_fma_f32 v[50:51], v[50:51], v[56:57], v[56:57] op_sel:[0,0,1] op_sel_hi:[1,0,1]
    v_pk_fma_f32 v[52:53], v[52:53], v[56:57], v[56:57] op_sel:[0,0,1] op_sel_hi:[1,0,1]
    v_pk_fma_f32 v[54:55], v[54:55], v[56:57], v[56:57] op_sel:[0,0,1] op_sel_hi:[1,0,1]
    v_pk_mul_f32 v[48:49], v[48:49], v[144:145]
    v_pk_mul_f32 v[50:51], v[50:51], v[146:147]
    v_pk_mul_f32 v[52:53], v[52:53], v[148:149]
    v_pk_mul_f32 v[54:55], v[54:55], v[150:151]
    v_exp_f32 v48, v48
    v_exp_f32 v49, v49
    v_pk_mul_f32 v[152:153], v[144:145], v[152:153]
    v_exp_f32 v50, v50
    v_exp_f32 v51, v51
    v_pk_mul_f32 v[154:155], v[146:147], v[154:155]
    v_exp_f32 v52, v52
    v_exp_f32 v53, v53
    v_pk_mul_f32 v[156:157], v[148:149], v[156:157]
    v_exp_f32 v54, v54
    v_exp_f32 v55, v55
    v_pk_mul_f32 v[158:159], v[150:151], v[158:159]
    v_pk_add_f32 v[48:49], v[48:49], 1.0 op_sel_hi:[1,0]
    v_pk_add_f32 v[50:51], v[50:51], 1.0 op_sel_hi:[1,0]
    v_pk_add_f32 v[52:53], v[52:53], 1.0 op_sel_hi:[1,0]
    v_pk_add_f32 v[54:55], v[54:55], 1.0 op_sel_hi:[1,0]
    v_rcp_f32 v48, v48
    v_rcp_f32 v49, v49
    v_rcp_f32 v50, v50
    v_rcp_f32 v51, v51
    v_rcp_f32 v52, v52
    v_rcp_f32 v53, v53
    v_rcp_f32 v54, v54
    v_rcp_f32 v55, v55
    v_pk_mul_f32 v[48:49], v[48:49], v[152:153]
    v_pk_mul_f32 v[50:51], v[50:51], v[154:155]
    v_pk_mul_f32 v[52:53], v[52:53], v[156:157]
    v_pk_mul_f32 v[54:55], v[54:55], v[158:159]
    v_cvt_pk_bf16_f32 v180, v48, v49
    v_cvt_pk_bf16_f32 v181, v50, v51
    v_cvt_pk_bf16_f32 v182, v52, v53
    v_cvt_pk_bf16_f32 v183, v54, v55
    buffer_store_dwordx4 v[180:183], v227, s[44:47], s79 offen offset:0 sc1
    s_lshl_b32 s60, s26, 1
    s_and_b32 s61, s3, 1
    s_add_u32 s60, s60, s61
    s_lshl_b32 s60, s60, 8
    s_lshl_b32 s61, s27, 2
    s_lshr_b32 s62, s3, 1
    s_add_u32 s61, s61, s62
    s_lshl_b32 s61, s61, 2
    s_add_u32 s60, s60, s61
    s_add_u32 s60, s60, 0x1100000
    s_waitcnt vmcnt(0)
    buffer_store_dword v241, v242, s[44:47], s60 offen sc1
    s_cmp_lt_u32 s2, 32
    s_cbranch_scc1 P2_END_F0
    s_mul_i32 s60, s3, 0x7000
    s_mul_i32 s61, s67, 0x48000
    s_add_u32 s70, s61, s60
    s_add_u32 s71, s70, 0x24000
    s_lshl_b32 s60, s3, 13
    s_add_u32 s60, s60, 0x1c000
    s_add_u32 s73, s61, s60
    s_add_u32 s74, s73, 0x24000
    v_add_u32 v56, 0, v227
    v_add_u32 v57, 0x1000, v227
    v_add_u32 v58, 0x2000, v227
    v_add_u32 v59, 0x3000, v227
    v_add_u32 v60, 0x4000, v227
    v_add_u32 v61, 0x5000, v227
    v_add_u32 v62, 0x6000, v227
    s_mov_b32 s28, s4
    s_nop 0
    s_and_b32 s29, s5, 0xffff
    s_mov_b32 s30, 0x1c0000
    s_mov_b32 s31, 0x20000
    s_lshl_b32 s60, s3, 6
    v_add_u32 v1, s60, v0
    v_lshrrev_b32 v2, 3, v1
    v_and_b32 v3, 7, v1
    s_lshl_b32 s60, s67, 6
    v_add_u32 v230, s60, v2
    v_mul_u32_u24 v230, 0x380, v230
    v_lshl_add_u32 v230, v3, 4, v230
    s_lshl_b32 s60, s68, 7
    v_add_u32 v230, s60, v230
    v_mul_u32_u24 v231, 0x110, v2
    v_lshl_add_u32 v231, v3, 5, v231
    v_mul_u32_u24 v232, 0x110, v236
    v_lshl_add_u32 v232, v237, 4, v232
    s_mul_i32 s60, s3, 0x4400
    v_add_u32 v232, s60, v232
    v_lshlrev_b32 v229, 2, v0
    s_mul_i32 s60, s3, 7
    s_lshr_b32 s60, s60, 1
    s_lshl_b32 s60, s60, 2
    s_mov_b32 s56, 0xffff
    s_mov_b32 s57, 0
    s_lshl_b64 s[56:57], s[56:57], s60
    s_lshl_b32 s75, s67, 8
    s_add_u32 s75, s75, 0x1100000
    s_mov_b32 s77, 0x7000
    buffer_load_dwordx4 v[248:251], v230, s[28:31], 0 offen
    buffer_load_dwordx4 v[252:255], v230, s[28:31], s77 offen
    ds_read_b64_tr_b16 v[128:129], v246 offset:32768
    ds_read_b64_tr_b16 v[130:131], v246 offset:33792
    ds_read_b64_tr_b16 v[132:133], v238 offset:32768
    ds_read_b64_tr_b16 v[134:135], v238 offset:33792
    ds_read_b64_tr_b16 v[136:137], v246 offset:40960
    ds_read_b64_tr_b16 v[138:139], v246 offset:41984
    ds_read_b64_tr_b16 v[140:141], v238 offset:40960
    ds_read_b64_tr_b16 v[142:143], v238 offset:41984
    s_waitcnt lgkmcnt(4)
    s_add_u32 s59, s69, 0x34800
    s_add_u32 m0, s58, 0x8000
    s_nop 0
    buffer_load_dwordx4 v244, s[48:51], s59 offen lds
    s_add_u32 s59, s69, 0x36400
    s_add_u32 m0, s58, 0x8400
    s_nop 0
    s_nop 0
    buffer_load_dwordx4 v244, s[48:51], s59 offen lds
    ds_read_b64_tr_b16 v[144:145], v246 offset:49152
    ds_read_b64_tr_b16 v[146:147], v246 offset:50176
    ds_read_b64_tr_b16 v[148:149], v238 offset:49152
    ds_read_b64_tr_b16 v[150:151], v238 offset:50176
    s_waitcnt lgkmcnt(4)
    s_add_u32 s59, s69, 0x38000
    s_add_u32 m0, s58, 0xa000
    s_nop 0
    buffer_load_dwordx4 v244, s[48:51], s59 offen lds
    s_add_u32 s59, s69, 0x39c00
    s_add_u32 m0, s58, 0xa400
    s_nop 0
    s_nop 0
    buffer_load_dwordx4 v244, s[48:51], s59 offen lds
    ds_read_b64_tr_b16 v[152:153], v247 offset:0
    ds_read_b64_tr_b16 v[154:155], v247 offset:1024
    ds_read_b64_tr_b16 v[156:157], v239 offset:0
    ds_read_b64_tr_b16 v[158:159], v239 offset:1024
    s_waitcnt lgkmcnt(4)
    s_add_u32 s59, s69, 0x3b800
    s_add_u32 m0, s58, 0xc000
    s_nop 0
    buffer_load_dwordx4 v244, s[48:51], s59 offen lds
    s_add_u32 s59, s69, 0x3d400
    s_add_u32 m0, s58, 0xc400
    s_nop 0
    s_nop 0
    buffer_load_dwordx4 v244, s[48:51], s59 offen lds
    ds_read_b64_tr_b16 v[160:161], v247 offset:49152
    ds_read_b64_tr_b16 v[162:163], v247 offset:50176
    ds_read_b64_tr_b16 v[164:165], v239 offset:49152
    ds_read_b64_tr_b16 v[166:167], v239 offset:50176
    s_waitcnt lgkmcnt(4)
    s_add_u32 s59, s69, 0x3f000
    s_add_u32 m0, s58, 0xe000
    s_nop 0
    buffer_load_dwordx4 v244, s[48:51], s59 offen lds
    s_add_u32 s59, s69, 0x40c00
    s_add_u32 m0, s58, 0xe400
    s_nop 0
    s_nop 0
    buffer_load_dwordx4 v244, s[48:51], s59 offen lds
    ds_read_b64_tr_b16 v[168:169], v247 offset:8192
    ds_read_b64_tr_b16 v[170:171], v247 offset:9216
    ds_read_b64_tr_b16 v[172:173], v239 offset:8192
    ds_read_b64_tr_b16 v[174:175], v239 offset:9216
    s_waitcnt lgkmcnt(4)
    s_add_u32 s59, s69, 0x42800
    s_add_u32 m0, s58, 0x1a000
    s_nop 0
    buffer_load_dwordx4 v244, s[48:51], s59 offen lds
    s_add_u32 s59, s69, 0x44400
    s_add_u32 m0, s58, 0x1a400
    s_nop 0
    s_nop 0
    buffer_load_dwordx4 v244, s[48:51], s59 offen lds
    ds_read_b64_tr_b16 v[176:177], v247 offset:16384
    ds_read_b64_tr_b16 v[178:179], v247 offset:17408
    ds_read_b64_tr_b16 v[180:181], v239 offset:16384
    ds_read_b64_tr_b16 v[182:183], v239 offset:17408
    s_waitcnt lgkmcnt(4)
    s_add_u32 s59, s69, 0x46000
    s_add_u32 m0, s58, 0x10000
    s_nop 0
    buffer_load_dwordx4 v244, s[48:51], s59 offen lds
    s_add_u32 s59, s69, 0x47c00
    s_add_u32 m0, s58, 0x10400
    s_nop 0
    s_nop 0
    buffer_load_dwordx4 v244, s[48:51], s59 offen lds
    ds_read_b64_tr_b16 v[184:185], v247 offset:24576
    ds_read_b64_tr_b16 v[186:187], v247 offset:25600
    ds_read_b64_tr_b16 v[188:189], v239 offset:24576
    ds_read_b64_tr_b16 v[190:191], v239 offset:25600
    s_waitcnt lgkmcnt(4)
    s_add_u32 s59, s69, 0x49800
    s_add_u32 m0, s58, 0x12000
    s_nop 0
    buffer_load_dwordx4 v244, s[48:51], s59 offen lds
    s_add_u32 s59, s69, 0x4b400
    s_add_u32 m0, s58, 0x12400
    s_nop 0
    s_nop 0
    buffer_load_dwordx4 v244, s[48:51], s59 offen lds
    ds_read_b64_tr_b16 v[192:193], v247 offset:32768
    ds_read_b64_tr_b16 v[194:195], v247 offset:33792
    ds_read_b64_tr_b16 v[196:197], v239 offset:32768
    ds_read_b64_tr_b16 v[198:199], v239 offset:33792
    s_waitcnt lgkmcnt(4)
    s_add_u32 s59, s69, 0x4d000
    s_add_u32 m0, s58, 0x14000
    s_nop 0
    buffer_load_dwordx4 v244, s[48:51], s59 offen lds
    s_add_u32 s59, s69, 0x4ec00
    s_add_u32 m0, s58, 0x14400
    s_nop 0
    s_nop 0
    buffer_load_dwordx4 v244, s[48:51], s59 offen lds
    ds_read_b64_tr_b16 v[200:201], v247 offset:57344
    ds_read_b64_tr_b16 v[202:203], v247 offset:58368
    ds_read_b64_tr_b16 v[204:205], v239 offset:57344
    ds_read_b64_tr_b16 v[206:207], v239 offset:58368
    s_waitcnt lgkmcnt(4)
    s_add_u32 s59, s69, 0x50800
    s_add_u32 m0, s58, 0x16000
    s_nop 0
    buffer_load_dwordx4 v244, s[48:51], s59 offen lds
    s_add_u32 s59, s69, 0x52400
    s_add_u32 m0, s58, 0x16400
    s_nop 0
    s_nop 0
    buffer_load_dwordx4 v244, s[48:51], s59 offen lds
    ds_read_b64_tr_b16 v[208:209], v246 offset:0
    ds_read_b64_tr_b16 v[210:211], v246 offset:1024
    ds_read_b64_tr_b16 v[212:213], v238 offset:0
    ds_read_b64_tr_b16 v[214:215], v238 offset:1024
    s_waitcnt lgkmcnt(4)
    s_add_u32 s59, s69, 0x54000
    s_add_u32 m0, s58, 0x1c000
    s_nop 0
    buffer_load_dwordx4 v244, s[48:51], s59 offen lds
    s_add_u32 s59, s69, 0x55c00
    s_add_u32 m0, s58, 0x1c400
    s_nop 0
    s_nop 0
    buffer_load_dwordx4 v244, s[48:51], s59 offen lds
    ds_read_b64_tr_b16 v[216:217], v246 offset:8192
    ds_read_b64_tr_b16 v[218:219], v246 offset:9216
    ds_read_b64_tr_b16 v[220:221], v238 offset:8192
    ds_read_b64_tr_b16 v[222:223], v238 offset:9216
    s_waitcnt lgkmcnt(4)
    s_add_u32 s59, s69, 0x57800
    s_add_u32 m0, s58, 0
    s_nop 0
    s_nop 0
    buffer_load_dwordx4 v244, s[48:51], s59 offen lds
    s_add_u32 s59, s69, 0x59400
    s_add_u32 m0, s58, 0x400
    s_nop 0
    buffer_load_dwordx4 v244, s[48:51], s59 offen lds
    s_waitcnt lgkmcnt(0)
    s_add_u32 s59, s69, 0x5b000
    s_add_u32 m0, s58, 0x2000
    s_nop 0
    s_nop 0
    buffer_load_dwordx4 v244, s[48:51], s59 offen lds
    s_add_u32 s59, s69, 0x5cc00
    s_add_u32 m0, s58, 0x2400
    s_nop 0
    buffer_load_dwordx4 v244, s[48:51], s59 offen lds
    s_mov_b32 s61, 0
SP_H_F0:
    buffer_load_dword v228, v229, s[44:47], s75 offen sc1
    s_add_u32 s61, s61, 1
    s_cmp_gt_u32 s61, 0x20000
    s_cbranch_scc1 SP_H_F0_OK
    s_waitcnt vmcnt(0)
    v_cmp_ne_u32 vcc, 1, v228
    s_nop 4
    s_and_b64 vcc, vcc, s[56:57]
    s_cbranch_vccz SP_H_F0_OK
    s_sleep 4
    s_branch SP_H_F0
SP_H_F0_OK:
    s_lshl_b32 s75, s67, 7
    s_add_u32 s75, s75, 0x1103000
    v_lshlrev_b32_e64 v229, 2, v236
    buffer_load_dwordx4 v[8:11], v56, s[44:47], s70 offen offset:0 sc1
    buffer_load_dwordx4 v[12:15], v56, s[44:47], s71 offen offset:0 sc1
    buffer_load_dwordx4 v[16:19], v56, s[44:47], s70 offen offset:1024 sc1
    buffer_load_dwordx4 v[20:23], v56, s[44:47], s71 offen offset:1024 sc1
    buffer_load_dwordx4 v[24:27], v56, s[44:47], s70 offen offset:2048 sc1
    buffer_load_dwordx4 v[28:31], v56, s[44:47], s71 offen offset:2048 sc1
    buffer_load_dwordx4 v[32:35], v56, s[44:47], s70 offen offset:3072 sc1
    buffer_load_dwordx4 v[36:39], v56, s[44:47], s71 offen offset:3072 sc1
    s_waitcnt vmcnt(7)
    v_mfma_f32_32x32x16_bf16 v[64:79], v[128:131], v[8:11], 0
    v_mfma_f32_32x32x16_bf16 v[80:95], v[132:135], v[8:11], 0
    s_waitcnt vmcnt(6)
    v_mfma_f32_32x32x16_bf16 v[96:111], v[128:131], v[12:15], 0
    v_mfma_f32_32x32x16_bf16 v[112:127], v[132:135], v[12:15], 0
    buffer_load_dwordx4 v[8:11], v57, s[44:47], s70 offen offset:0 sc1
    buffer_load_dwordx4 v[12:15], v57, s[44:47], s71 offen offset:0 sc1
    buffer_load_dwordx4 v[128:131], v57, s[44:47], s70 offen offset:1024 sc1
    buffer_load_dwordx4 v[132:135], v57, s[44:47], s71 offen offset:1024 sc1
    s_waitcnt vmcnt(9)
    v_mfma_f32_32x32x16_bf16 v[64:79], v[136:139], v[16:19], v[64:79]
    v_mfma_f32_32x32x16_bf16 v[80:95], v[140:143], v[16:19], v[80:95]
    s_waitcnt vmcnt(8)
    v_mfma_f32_32x32x16_bf16 v[96:111], v[136:139], v[20:23], v[96:111]
    v_mfma_f32_32x32x16_bf16 v[112:127], v[140:143], v[20:23], v[112:127]
    buffer_load_dwordx4 v[16:19], v57, s[44:47], s70 offen offset:2048 sc1
    buffer_load_dwordx4 v[20:23], v57, s[44:47], s71 offen offset:2048 sc1
    buffer_load_dwordx4 v[136:139], v57, s[44:47], s70 offen offset:3072 sc1
    buffer_load_dwordx4 v[140:143], v57, s[44:47], s71 offen offset:3072 sc1
    s_waitcnt vmcnt(11)
    v_mfma_f32_32x32x16_bf16 v[64:79], v[144:147], v[24:27], v[64:79]
    v_mfma_f32_32x32x16_bf16 v[80:95], v[148:151], v[24:27], v[80:95]
    s_waitcnt vmcnt(10)
    v_mfma_f32_32x32x16_bf16 v[96:111], v[144:147], v[28:31], v[96:111]
    v_mfma_f32_32x32x16_bf16 v[112:127], v[148:151], v[28:31], v[112:127]
    buffer_load_dwordx4 v[24:27], v58, s[44:47], s70 offen offset:0 sc1
    buffer_load_dwordx4 v[28:31], v58, s[44:47], s71 offen offset:0 sc1
    buffer_load_dwordx4 v[144:147], v58, s[44:47], s70 offen offset:1024 sc1
    buffer_load_dwordx4 v[148:151], v58, s[44:47], s71 offen offset:1024 sc1
    s_waitcnt vmcnt(13)
    v_mfma_f32_32x32x16_bf16 v[64:79], v[152:155], v[32:35], v[64:79]
    v_mfma_f32_32x32x16_bf16 v[80:95], v[156:159], v[32:35], v[80:95]
    s_waitcnt vmcnt(12)
    v_mfma_f32_32x32x16_bf16 v[96:111], v[152:155], v[36:39], v[96:111]
    v_mfma_f32_32x32x16_bf16 v[112:127], v[156:159], v[36:39], v[112:127]
    buffer_load_dwordx4 v[32:35], v58, s[44:47], s70 offen offset:2048 sc1
    buffer_load_dwordx4 v[36:39], v58, s[44:47], s71 offen offset:2048 sc1
    buffer_load_dwordx4 v[152:155], v58, s[44:47], s70 offen offset:3072 sc1
    buffer_load_dwordx4 v[156:159], v58, s[44:47], s71 offen offset:3072 sc1
    s_waitcnt vmcnt(15)
    v_mfma_f32_32x32x16_bf16 v[64:79], v[160:163], v[8:11], v[64:79]
    v_mfma_f32_32x32x16_bf16 v[80:95], v[164:167], v[8:11], v[80:95]
    s_waitcnt vmcnt(14)
    v_mfma_f32_32x32x16_bf16 v[96:111], v[160:163], v[12:15], v[96:111]
    v_mfma_f32_32x32x16_bf16 v[112:127], v[164:167], v[12:15], v[112:127]
    buffer_load_dwordx4 v[8:11], v59, s[44:47], s70 offen offset:0 sc1
    buffer_load_dwordx4 v[12:15], v59, s[44:47], s71 offen offset:0 sc1
    s_waitcnt vmcnt(15)
    v_mfma_f32_32x32x16_bf16 v[64:79], v[168:171], v[128:131], v[64:79]
    v_mfma_f32_32x32x16_bf16 v[80:95], v[172:175], v[128:131], v[80:95]
    s_waitcnt vmcnt(14)
    v_mfma_f32_32x32x16_bf16 v[96:111], v[168:171], v[132:135], v[96:111]
    v_mfma_f32_32x32x16_bf16 v[112:127], v[172:175], v[132:135], v[112:127]
    buffer_load_dwordx4 v[160:163], v59, s[44:47], s70 offen offset:1024 sc1
    buffer_load_dwordx4 v[164:167], v59, s[44:47], s71 offen offset:1024 sc1
    s_waitcnt vmcnt(15)
    v_mfma_f32_32x32x16_bf16 v[64:79], v[176:179], v[16:19], v[64:79]
    v_mfma_f32_32x32x16_bf16 v[80:95], v[180:183], v[16:19], v[80:95]
    s_waitcnt vmcnt(14)
    v_mfma_f32_32x32x16_bf16 v[96:111], v[176:179], v[20:23], v[96:111]
    v_mfma_f32_32x32x16_bf16 v[112:127], v[180:183], v[20:23], v[112:127]
    buffer_load_dwordx4 v[128:131], v59, s[44:47], s70 offen offset:2048 sc1
    buffer_load_dwordx4 v[132:135], v59, s[44:47], s71 offen offset:2048 sc1
    s_waitcnt vmcnt(15)
    v_mfma_f32_32x32x16_bf16 v[64:79], v[184:187], v[136:139], v[64:79]
    v_mfma_f32_32x32x16_bf16 v[80:95], v[188:191], v[136:139], v[80:95]
    s_waitcnt vmcnt(14)
    v_mfma_f32_32x32x16_bf16 v[96:111], v[184:187], v[140:143], v[96:111]
    v_mfma_f32_32x32x16_bf16 v[112:127], v[188:191], v[140:143], v[112:127]
    buffer_load_dwordx4 v[168:171], v59, s[44:47], s70 offen offset:3072 sc1
    buffer_load_dwordx4 v[172:175], v59, s[44:47], s71 offen offset:3072 sc1
    s_waitcnt vmcnt(15)
    v_mfma_f32_32x32x16_bf16 v[64:79], v[192:195], v[24:27], v[64:79]
    v_mfma_f32_32x32x16_bf16 v[80:95], v[196:199], v[24:27], v[80:95]
    s_waitcnt vmcnt(14)
    v_mfma_f32_32x32x16_bf16 v[96:111], v[192:195], v[28:31], v[96:111]
    v_mfma_f32_32x32x16_bf16 v[112:127], v[196:199], v[28:31], v[112:127]
    buffer_load_dwordx4 v[16:19], v60, s[44:47], s70 offen offset:0 sc1
    buffer_load_dwordx4 v[20:23], v60, s[44:47], s71 offen offset:0 sc1
    s_waitcnt vmcnt(15)
    v_mfma_f32_32x32x16_bf16 v[64:79], v[200:203], v[144:147], v[64:79]
    v_mfma_f32_32x32x16_bf16 v[80:95], v[204:207], v[144:147], v[80:95]
    s_waitcnt vmcnt(14)
    v_mfma_f32_32x32x16_bf16 v[96:111], v[200:203], v[148:151], v[96:111]
    v_mfma_f32_32x32x16_bf16 v[112:127], v[204:207], v[148:151], v[112:127]
    buffer_load_dwordx4 v[176:179], v60, s[44:47], s70 offen offset:1024 sc1
    buffer_load_dwordx4 v[180:183], v60, s[44:47], s71 offen offset:1024 sc1
    s_waitcnt vmcnt(15)
    v_mfma_f32_32x32x16_bf16 v[64:79], v[208:211], v[32:35], v[64:79]
    v_mfma_f32_32x32x16_bf16 v[80:95], v[212:215], v[32:35], v[80:95]
    s_waitcnt vmcnt(14)
    v_mfma_f32_32x32x16_bf16 v[96:111], v[208:211], v[36:39], v[96:111]
    v_mfma_f32_32x32x16_bf16 v[112:127], v[212:215], v[36:39], v[112:127]
    buffer_load_dwordx4 v[136:139], v60, s[44:47], s70 offen offset:2048 sc1
    buffer_load_dwordx4 v[140:143], v60, s[44:47], s71 offen offset:2048 sc1
    ds_read_b64_tr_b16 v[40:41], v246 offset:16384
    ds_read_b64_tr_b16 v[42:43], v246 offset:17408
    ds_read_b64_tr_b16 v[44:45], v238 offset:16384
    ds_read_b64_tr_b16 v[46:47], v238 offset:17408
    s_waitcnt vmcnt(15)
    v_mfma_f32_32x32x16_bf16 v[64:79], v[216:219], v[152:155], v[64:79]
    v_mfma_f32_32x32x16_bf16 v[80:95], v[220:223], v[152:155], v[80:95]
    s_waitcnt vmcnt(14)
    v_mfma_f32_32x32x16_bf16 v[96:111], v[216:219], v[156:159], v[96:111]
    v_mfma_f32_32x32x16_bf16 v[112:127], v[220:223], v[156:159], v[112:127]
    buffer_load_dwordx4 v[184:187], v60, s[44:47], s70 offen offset:3072 sc1
    buffer_load_dwordx4 v[188:191], v60, s[44:47], s71 offen offset:3072 sc1
    ds_read_b64_tr_b16 v[48:49], v246 offset:24576
    ds_read_b64_tr_b16 v[50:51], v246 offset:25600
    ds_read_b64_tr_b16 v[52:53], v238 offset:24576
    ds_read_b64_tr_b16 v[54:55], v238 offset:25600
    s_waitcnt vmcnt(15) lgkmcnt(6)
    v_mfma_f32_32x32x16_bf16 v[64:79], v[40:43], v[8:11], v[64:79]
    s_waitcnt lgkmcnt(4)
    v_mfma_f32_32x32x16_bf16 v[80:95], v[44:47], v[8:11], v[80:95]
    s_waitcnt vmcnt(14)
    s_nop 0
    v_mfma_f32_32x32x16_bf16 v[96:111], v[40:43], v[12:15], v[96:111]
    v_mfma_f32_32x32x16_bf16 v[112:127], v[44:47], v[12:15], v[112:127]
    buffer_load_dwordx4 v[24:27], v61, s[44:47], s70 offen offset:0 sc1
    buffer_load_dwordx4 v[28:31], v61, s[44:47], s71 offen offset:0 sc1
    s_add_u32 s59, s69, 0x5e800
    s_add_u32 m0, s58, 0x4000
    s_nop 0
    s_nop 0
    buffer_load_dwordx4 v244, s[48:51], s59 offen lds
    s_add_u32 s59, s69, 0x60400
    s_add_u32 m0, s58, 0x4400
    s_nop 0
    s_nop 0
    buffer_load_dwordx4 v244, s[48:51], s59 offen lds
    ds_read_b64_tr_b16 v[40:41], v247 offset:40960
    ds_read_b64_tr_b16 v[42:43], v247 offset:41984
    ds_read_b64_tr_b16 v[44:45], v239 offset:40960
    ds_read_b64_tr_b16 v[46:47], v239 offset:41984
    s_waitcnt vmcnt(17) lgkmcnt(6)
    v_mfma_f32_32x32x16_bf16 v[64:79], v[48:51], v[160:163], v[64:79]
    s_waitcnt lgkmcnt(4)
    v_mfma_f32_32x32x16_bf16 v[80:95], v[52:55], v[160:163], v[80:95]
    s_waitcnt vmcnt(16)
    s_nop 0
    v_mfma_f32_32x32x16_bf16 v[96:111], v[48:51], v[164:167], v[96:111]
    v_mfma_f32_32x32x16_bf16 v[112:127], v[52:55], v[164:167], v[112:127]
    buffer_load_dwordx4 v[192:195], v61, s[44:47], s70 offen offset:1024 sc1
    buffer_load_dwordx4 v[196:199], v61, s[44:47], s71 offen offset:1024 sc1
    s_add_u32 s59, s66, 0
    s_add_u32 m0, s58, 0x6000
    s_nop 0
    buffer_load_dwordx4 v244, s[36:39], s59 offen lds
    s_add_u32 s59, s66, 0x1c00
    s_add_u32 m0, s58, 0x6400
    s_nop 0
    s_nop 0
    buffer_load_dwordx4 v244, s[36:39], s59 offen lds
    ds_read_b64_tr_b16 v[48:49], v246 offset:32768
    ds_read_b64_tr_b16 v[50:51], v246 offset:33792
    ds_read_b64_tr_b16 v[52:53], v238 offset:32768
    ds_read_b64_tr_b16 v[54:55], v238 offset:33792
    s_waitcnt vmcnt(19) lgkmcnt(6)
    v_mfma_f32_32x32x16_bf16 v[64:79], v[40:43], v[128:131], v[64:79]
    s_waitcnt lgkmcnt(4)
    v_mfma_f32_32x32x16_bf16 v[80:95], v[44:47], v[128:131], v[80:95]
    s_waitcnt vmcnt(18)
    s_nop 0
    v_mfma_f32_32x32x16_bf16 v[96:111], v[40:43], v[132:135], v[96:111]
    v_mfma_f32_32x32x16_bf16 v[112:127], v[44:47], v[132:135], v[112:127]
    buffer_load_dwordx4 v[144:147], v61, s[44:47], s70 offen offset:2048 sc1
    buffer_load_dwordx4 v[148:151], v61, s[44:47], s71 offen offset:2048 sc1
    s_add_u32 s59, s66, 0x3800
    s_add_u32 m0, s58, 0x18000
    s_nop 0
    s_nop 0
    buffer_load_dwordx4 v244, s[36:39], s59 offen lds
    s_add_u32 s59, s66, 0x5400
    s_add_u32 m0, s58, 0x18400
    s_nop 0
    s_nop 0
    buffer_load_dwordx4 v245, s[36:39], s59 offen lds
    ds_read_b64_tr_b16 v[40:41], v246 offset:40960
    ds_read_b64_tr_b16 v[42:43], v246 offset:41984
    ds_read_b64_tr_b16 v[44:45], v238 offset:40960
    ds_read_b64_tr_b16 v[46:47], v238 offset:41984
    s_waitcnt vmcnt(21) lgkmcnt(6)
    v_mfma_f32_32x32x16_bf16 v[64:79], v[48:51], v[168:171], v[64:79]
    s_waitcnt lgkmcnt(4)
    v_mfma_f32_32x32x16_bf16 v[80:95], v[52:55], v[168:171], v[80:95]
    s_waitcnt vmcnt(20)
    s_nop 0
    v_mfma_f32_32x32x16_bf16 v[96:111], v[48:51], v[172:175], v[96:111]
    v_mfma_f32_32x32x16_bf16 v[112:127], v[52:55], v[172:175], v[112:127]
    buffer_load_dwordx4 v[200:203], v61, s[44:47], s70 offen offset:3072 sc1
    buffer_load_dwordx4 v[204:207], v61, s[44:47], s71 offen offset:3072 sc1
    s_add_u32 s59, s66, 0x6200
    s_add_u32 m0, s58, 0x8000
    s_nop 0
    s_nop 0
    buffer_load_dwordx4 v244, s[36:39], s59 offen lds
    s_add_u32 s59, s66, 0x7e00
    s_add_u32 m0, s58, 0x8400
    s_nop 0
    s_nop 0
    buffer_load_dwordx4 v244, s[36:39], s59 offen lds
    ds_read_b64_tr_b16 v[48:49], v246 offset:49152
    ds_read_b64_tr_b16 v[50:51], v246 offset:50176
    ds_read_b64_tr_b16 v[52:53], v238 offset:49152
    ds_read_b64_tr_b16 v[54:55], v238 offset:50176
    s_waitcnt vmcnt(23) lgkmcnt(6)
    v_mfma_f32_32x32x16_bf16 v[64:79], v[40:43], v[16:19], v[64:79]
    s_waitcnt lgkmcnt(4)
    v_mfma_f32_32x32x16_bf16 v[80:95], v[44:47], v[16:19], v[80:95]
    s_waitcnt vmcnt(22)
    s_nop 0
    v_mfma_f32_32x32x16_bf16 v[96:111], v[40:43], v[20:23], v[96:111]
    v_mfma_f32_32x32x16_bf16 v[112:127], v[44:47], v[20:23], v[112:127]
    buffer_load_dwordx4 v[32:35], v62, s[44:47], s70 offen offset:0 sc1
    buffer_load_dwordx4 v[36:39], v62, s[44:47], s71 offen offset:0 sc1
    s_add_u32 s59, s66, 0x9a00
    s_add_u32 m0, s58, 0xa000
    s_nop 0
    s_nop 0
    buffer_load_dwordx4 v244, s[36:39], s59 offen lds
    s_add_u32 s59, s66, 0xb600
    s_add_u32 m0, s58, 0xa400
    s_nop 0
    s_nop 0
    buffer_load_dwordx4 v245, s[36:39], s59 offen lds
    ds_read_b64_tr_b16 v[40:41], v247 offset:0
    ds_read_b64_tr_b16 v[42:43], v247 offset:1024
    ds_read_b64_tr_b16 v[44:45], v239 offset:0
    ds_read_b64_tr_b16 v[46:47], v239 offset:1024
    s_waitcnt vmcnt(25) lgkmcnt(6)
    v_mfma_f32_32x32x16_bf16 v[64:79], v[48:51], v[176:179], v[64:79]
    s_waitcnt lgkmcnt(4)
    v_mfma_f32_32x32x16_bf16 v[80:95], v[52:55], v[176:179], v[80:95]
    s_waitcnt vmcnt(24)
    s_nop 0
    v_mfma_f32_32x32x16_bf16 v[96:111], v[48:51], v[180:183], v[96:111]
    v_mfma_f32_32x32x16_bf16 v[112:127], v[52:55], v[180:183], v[112:127]
    buffer_load_dwordx4 v[208:211], v62, s[44:47], s70 offen offset:1024 sc1
    buffer_load_dwordx4 v[212:215], v62, s[44:47], s71 offen offset:1024 sc1
    s_add_u32 s59, s66, 0xc400
    s_add_u32 m0, s58, 0xc000
    s_nop 0
    s_nop 0
    buffer_load_dwordx4 v244, s[36:39], s59 offen lds
    s_add_u32 s59, s66, 0xe000
    s_add_u32 m0, s58, 0xc400
    s_nop 0
    s_nop 0
    buffer_load_dwordx4 v244, s[36:39], s59 offen lds
    ds_read_b64_tr_b16 v[48:49], v247 offset:49152
    ds_read_b64_tr_b16 v[50:51], v247 offset:50176
    ds_read_b64_tr_b16 v[52:53], v239 offset:49152
    ds_read_b64_tr_b16 v[54:55], v239 offset:50176
    s_waitcnt vmcnt(27) lgkmcnt(6)
    v_mfma_f32_32x32x16_bf16 v[64:79], v[40:43], v[136:139], v[64:79]
    s_waitcnt lgkmcnt(4)
    v_mfma_f32_32x32x16_bf16 v[80:95], v[44:47], v[136:139], v[80:95]
    s_waitcnt vmcnt(26)
    s_nop 0
    v_mfma_f32_32x32x16_bf16 v[96:111], v[40:43], v[140:143], v[96:111]
    v_mfma_f32_32x32x16_bf16 v[112:127], v[44:47], v[140:143], v[112:127]
    buffer_load_dwordx4 v[152:155], v62, s[44:47], s70 offen offset:2048 sc1
    buffer_load_dwordx4 v[156:159], v62, s[44:47], s71 offen offset:2048 sc1
    s_add_u32 s59, s66, 0xfc00
    s_add_u32 m0, s58, 0xe000
    s_nop 0
    s_nop 0
    buffer_load_dwordx4 v244, s[36:39], s59 offen lds
    s_add_u32 s59, s66, 0x11800
    s_add_u32 m0, s58, 0xe400
    s_nop 0
    s_nop 0
    buffer_load_dwordx4 v245, s[36:39], s59 offen lds
    ds_read_b64_tr_b16 v[40:41], v247 offset:8192
    ds_read_b64_tr_b16 v[42:43], v247 offset:9216
    ds_read_b64_tr_b16 v[44:45], v239 offset:8192
    ds_read_b64_tr_b16 v[46:47], v239 offset:9216
    s_waitcnt vmcnt(29) lgkmcnt(6)
    v_mfma_f32_32x32x16_bf16 v[64:79], v[48:51], v[184:187], v[64:79]
    s_waitcnt lgkmcnt(4)
    v_mfma_f32_32x32x16_bf16 v[80:95], v[52:55], v[184:187], v[80:95]
    s_waitcnt vmcnt(28)
    s_nop 0
    v_mfma_f32_32x32x16_bf16 v[96:111], v[48:51], v[188:191], v[96:111]
    v_mfma_f32_32x32x16_bf16 v[112:127], v[52:55], v[188:191], v[112:127]
    buffer_load_dwordx4 v[216:219], v62, s[44:47], s70 offen offset:3072 sc1
    buffer_load_dwordx4 v[220:223], v62, s[44:47], s71 offen offset:3072 sc1
    s_add_u32 s59, s66, 0x12600
    s_add_u32 m0, s58, 0x1a000
    s_nop 0
    s_nop 0
    buffer_load_dwordx4 v244, s[36:39], s59 offen lds
    s_add_u32 s59, s66, 0x14200
    s_add_u32 m0, s58, 0x1a400
    s_nop 0
    s_nop 0
    buffer_load_dwordx4 v244, s[36:39], s59 offen lds
    ds_read_b64_tr_b16 v[48:49], v247 offset:16384
    ds_read_b64_tr_b16 v[50:51], v247 offset:17408
    ds_read_b64_tr_b16 v[52:53], v239 offset:16384
    ds_read_b64_tr_b16 v[54:55], v239 offset:17408
    s_waitcnt vmcnt(31) lgkmcnt(6)
    v_mfma_f32_32x32x16_bf16 v[64:79], v[40:43], v[24:27], v[64:79]
    s_waitcnt lgkmcnt(4)
    v_mfma_f32_32x32x16_bf16 v[80:95], v[44:47], v[24:27], v[80:95]
    s_waitcnt vmcnt(30)
    s_nop 0
    v_mfma_f32_32x32x16_bf16 v[96:111], v[40:43], v[28:31], v[96:111]
    v_mfma_f32_32x32x16_bf16 v[112:127], v[44:47], v[28:31], v[112:127]
    s_add_u32 s59, s66, 0x15e00
    s_add_u32 m0, s58, 0x10000
    s_nop 0
    s_nop 0
    buffer_load_dwordx4 v244, s[36:39], s59 offen lds
    s_add_u32 s59, s66, 0x17a00
    s_add_u32 m0, s58, 0x10400
    s_nop 0
    s_nop 0
    buffer_load_dwordx4 v245, s[36:39], s59 offen lds
    ds_read_b64_tr_b16 v[40:41], v247 offset:24576
    ds_read_b64_tr_b16 v[42:43], v247 offset:25600
    ds_read_b64_tr_b16 v[44:45], v239 offset:24576
    ds_read_b64_tr_b16 v[46:47], v239 offset:25600
    s_waitcnt vmcnt(29) lgkmcnt(6)
    v_mfma_f32_32x32x16_bf16 v[64:79], v[48:51], v[192:195], v[64:79]
    s_waitcnt lgkmcnt(4)
    v_mfma_f32_32x32x16_bf16 v[80:95], v[52:55], v[192:195], v[80:95]
    s_waitcnt vmcnt(28)
    s_nop 0
    v_mfma_f32_32x32x16_bf16 v[96:111], v[48:51], v[196:199], v[96:111]
    v_mfma_f32_32x32x16_bf16 v[112:127], v[52:55], v[196:199], v[112:127]
    ds_read_b64_tr_b16 v[48:49], v247 offset:32768
    ds_read_b64_tr_b16 v[50:51], v247 offset:33792
    ds_read_b64_tr_b16 v[52:53], v239 offset:32768
    ds_read_b64_tr_b16 v[54:55], v239 offset:33792
    s_waitcnt vmcnt(25) lgkmcnt(6)
    v_mfma_f32_32x32x16_bf16 v[64:79], v[40:43], v[144:147], v[64:79]
    s_waitcnt lgkmcnt(4)
    v_mfma_f32_32x32x16_bf16 v[80:95], v[44:47], v[144:147], v[80:95]
    s_waitcnt vmcnt(24)
    s_nop 0
    v_mfma_f32_32x32x16_bf16 v[96:111], v[40:43], v[148:151], v[96:111]
    v_mfma_f32_32x32x16_bf16 v[112:127], v[44:47], v[148:151], v[112:127]
    ds_read_b64_tr_b16 v[40:41], v247 offset:57344
    ds_read_b64_tr_b16 v[42:43], v247 offset:58368
    ds_read_b64_tr_b16 v[44:45], v239 offset:57344
    ds_read_b64_tr_b16 v[46:47], v239 offset:58368
    s_waitcnt vmcnt(21) lgkmcnt(6)
    v_mfma_f32_32x32x16_bf16 v[64:79], v[48:51], v[200:203], v[64:79]
    s_waitcnt lgkmcnt(4)
    v_mfma_f32_32x32x16_bf16 v[80:95], v[52:55], v[200:203], v[80:95]
    s_waitcnt vmcnt(20)
    s_nop 0
    v_mfma_f32_32x32x16_bf16 v[96:111], v[48:51], v[204:207], v[96:111]
    v_mfma_f32_32x32x16_bf16 v[112:127], v[52:55], v[204:207], v[112:127]
    ds_read_b64_tr_b16 v[48:49], v246 offset:0
    ds_read_b64_tr_b16 v[50:51], v246 offset:1024
    ds_read_b64_tr_b16 v[52:53], v238 offset:0
    ds_read_b64_tr_b16 v[54:55], v238 offset:1024
    s_waitcnt vmcnt(17) lgkmcnt(6)
    v_mfma_f32_32x32x16_bf16 v[64:79], v[40:43], v[32:35], v[64:79]
    s_waitcnt lgkmcnt(4)
    v_mfma_f32_32x32x16_bf16 v[80:95], v[44:47], v[32:35], v[80:95]
    s_waitcnt vmcnt(16)
    s_nop 0
    v_mfma_f32_32x32x16_bf16 v[96:111], v[40:43], v[36:39], v[96:111]
    v_mfma_f32_32x32x16_bf16 v[112:127], v[44:47], v[36:39], v[112:127]
    buffer_load_dword v228, v229, s[44:47], s75 offen sc1
    ds_read_b64_tr_b16 v[40:41], v246 offset:8192
    ds_read_b64_tr_b16 v[42:43], v246 offset:9216
    ds_read_b64_tr_b16 v[44:45], v238 offset:8192
    ds_read_b64_tr_b16 v[46:47], v238 offset:9216
    s_waitcnt vmcnt(14) lgkmcnt(6)
    v_mfma_f32_32x32x16_bf16 v[64:79], v[48:51], v[208:211], v[64:79]
    s_waitcnt lgkmcnt(4)
    v_mfma_f32_32x32x16_bf16 v[80:95], v[52:55], v[208:211], v[80:95]
    s_waitcnt vmcnt(13)
    s_nop 0
    v_mfma_f32_32x32x16_bf16 v[96:111], v[48:51], v[212:215], v[96:111]
    v_mfma_f32_32x32x16_bf16 v[112:127], v[52:55], v[212:215], v[112:127]
    ds_read_b64_tr_b16 v[48:49], v246 offset:16384
    ds_read_b64_tr_b16 v[50:51], v246 offset:17408
    ds_read_b64_tr_b16 v[52:53], v238 offset:16384
    ds_read_b64_tr_b16 v[54:55], v238 offset:17408
    s_waitcnt vmcnt(10) lgkmcnt(6)
    v_mfma_f32_32x32x16_bf16 v[64:79], v[40:43], v[152:155], v[64:79]
    s_waitcnt lgkmcnt(4)
    v_mfma_f32_32x32x16_bf16 v[80:95], v[44:47], v[152:155], v[80:95]
    s_waitcnt vmcnt(9)
    v_mfma_f32_32x32x16_bf16 v[96:111], v[40:43], v[156:159], v[96:111]
    v_mfma_f32_32x32x16_bf16 v[112:127], v[44:47], v[156:159], v[112:127]
    s_waitcnt vmcnt(0)
    v_mov_b32 v228, v228
    v_cmp_ne_u32 vcc, 1, v228
    s_nop 4
    s_cbranch_vccz SP_O_F0_OK
    s_mov_b32 s61, 0
SP_O_F0:
    buffer_load_dword v228, v229, s[44:47], s75 offen sc1
    s_add_u32 s61, s61, 1
    s_cmp_gt_u32 s61, 0x20000
    s_cbranch_scc1 SP_O_F0_OK
    s_waitcnt vmcnt(0)
    v_cmp_ne_u32 vcc, 1, v228
    s_nop 4
    s_cbranch_vccz SP_O_F0_OK
    s_sleep 8
    s_branch SP_O_F0
SP_O_F0_OK:
    s_nop 0
    buffer_load_dwordx4 v[8:11], v56, s[44:47], s73 offen offset:0 sc1
    buffer_load_dwordx4 v[12:15], v56, s[44:47], s74 offen offset:0 sc1
    buffer_load_dwordx4 v[160:163], v56, s[44:47], s73 offen offset:1024 sc1
    buffer_load_dwordx4 v[164:167], v56, s[44:47], s74 offen offset:1024 sc1
    buffer_load_dwordx4 v[128:131], v56, s[44:47], s73 offen offset:2048 sc1
    buffer_load_dwordx4 v[132:135], v56, s[44:47], s74 offen offset:2048 sc1
    buffer_load_dwordx4 v[168:171], v56, s[44:47], s73 offen offset:3072 sc1
    buffer_load_dwordx4 v[172:175], v56, s[44:47], s74 offen offset:3072 sc1
    buffer_load_dwordx4 v[16:19], v57, s[44:47], s73 offen offset:0 sc1
    buffer_load_dwordx4 v[20:23], v57, s[44:47], s74 offen offset:0 sc1
    buffer_load_dwordx4 v[176:179], v57, s[44:47], s73 offen offset:1024 sc1
    buffer_load_dwordx4 v[180:183], v57, s[44:47], s74 offen offset:1024 sc1
    buffer_load_dwordx4 v[136:139], v57, s[44:47], s73 offen offset:2048 sc1
    buffer_load_dwordx4 v[140:143], v57, s[44:47], s74 offen offset:2048 sc1
    buffer_load_dwordx4 v[184:187], v57, s[44:47], s73 offen offset:3072 sc1
    buffer_load_dwordx4 v[188:191], v57, s[44:47], s74 offen offset:3072 sc1
    ds_read_b64_tr_b16 v[40:41], v246 offset:24576
    ds_read_b64_tr_b16 v[42:43], v246 offset:25600
    ds_read_b64_tr_b16 v[44:45], v238 offset:24576
    ds_read_b64_tr_b16 v[46:47], v238 offset:25600
    s_waitcnt lgkmcnt(6)
    v_mfma_f32_32x32x16_bf16 v[64:79], v[48:51], v[216:219], v[64:79]
    s_waitcnt lgkmcnt(4)
    v_mfma_f32_32x32x16_bf16 v[80:95], v[52:55], v[216:219], v[80:95]
    v_mfma_f32_32x32x16_bf16 v[96:111], v[48:51], v[220:223], v[96:111]
    v_mfma_f32_32x32x16_bf16 v[112:127], v[52:55], v[220:223], v[112:127]
    ds_read_b64_tr_b16 v[48:49], v247 offset:40960
    ds_read_b64_tr_b16 v[50:51], v247 offset:41984
    ds_read_b64_tr_b16 v[52:53], v239 offset:40960
    ds_read_b64_tr_b16 v[54:55], v239 offset:41984
    s_waitcnt vmcnt(15) lgkmcnt(6)
    v_mfma_f32_32x32x16_bf16 v[64:79], v[40:43], v[8:11], v[64:79]
    s_waitcnt lgkmcnt(4)
    v_mfma_f32_32x32x16_bf16 v[80:95], v[44:47], v[8:11], v[80:95]
    s_waitcnt vmcnt(14)
    s_nop 0
    v_mfma_f32_32x32x16_bf16 v[96:111], v[40:43], v[12:15], v[96:111]
    v_mfma_f32_32x32x16_bf16 v[112:127], v[44:47], v[12:15], v[112:127]
    ds_read_b64_tr_b16 v[40:41], v246 offset:32768
    ds_read_b64_tr_b16 v[42:43], v246 offset:33792
    ds_read_b64_tr_b16 v[44:45], v238 offset:32768
    ds_read_b64_tr_b16 v[46:47], v238 offset:33792
    s_waitcnt vmcnt(13) lgkmcnt(6)
    v_mfma_f32_32x32x16_bf16 v[64:79], v[48:51], v[160:163], v[64:79]
    s_waitcnt lgkmcnt(4)
    v_mfma_f32_32x32x16_bf16 v[80:95], v[52:55], v[160:163], v[80:95]
    s_waitcnt vmcnt(12)
    s_nop 0
    v_mfma_f32_32x32x16_bf16 v[96:111], v[48:51], v[164:167], v[96:111]
    v_mfma_f32_32x32x16_bf16 v[112:127], v[52:55], v[164:167], v[112:127]
    ds_read_b64_tr_b16 v[48:49], v246 offset:40960
    ds_read_b64_tr_b16 v[50:51], v246 offset:41984
    ds_read_b64_tr_b16 v[52:53], v238 offset:40960
    ds_read_b64_tr_b16 v[54:55], v238 offset:41984
    s_waitcnt vmcnt(11) lgkmcnt(6)
    v_mfma_f32_32x32x16_bf16 v[64:79], v[40:43], v[128:131], v[64:79]
    s_waitcnt lgkmcnt(4)
    v_mfma_f32_32x32x16_bf16 v[80:95], v[44:47], v[128:131], v[80:95]
    s_waitcnt vmcnt(10)
    s_nop 0
    v_mfma_f32_32x32x16_bf16 v[96:111], v[40:43], v[132:135], v[96:111]
    v_mfma_f32_32x32x16_bf16 v[112:127], v[44:47], v[132:135], v[112:127]
    ds_read_b64_tr_b16 v[40:41], v246 offset:49152
    ds_read_b64_tr_b16 v[42:43], v246 offset:50176
    ds_read_b64_tr_b16 v[44:45], v238 offset:49152
    ds_read_b64_tr_b16 v[46:47], v238 offset:50176
    s_waitcnt vmcnt(9) lgkmcnt(6)
    v_mfma_f32_32x32x16_bf16 v[64:79], v[48:51], v[168:171], v[64:79]
    s_waitcnt lgkmcnt(4)
    v_mfma_f32_32x32x16_bf16 v[80:95], v[52:55], v[168:171], v[80:95]
    s_waitcnt vmcnt(8)
    s_nop 0
    v_mfma_f32_32x32x16_bf16 v[96:111], v[48:51], v[172:175], v[96:111]
    v_mfma_f32_32x32x16_bf16 v[112:127], v[52:55], v[172:175], v[112:127]
    ds_read_b64_tr_b16 v[48:49], v247 offset:0
    ds_read_b64_tr_b16 v[50:51], v247 offset:1024
    ds_read_b64_tr_b16 v[52:53], v239 offset:0
    ds_read_b64_tr_b16 v[54:55], v239 offset:1024
    s_waitcnt vmcnt(7) lgkmcnt(6)
    v_mfma_f32_32x32x16_bf16 v[64:79], v[40:43], v[16:19], v[64:79]
    s_waitcnt lgkmcnt(4)
    v_mfma_f32_32x32x16_bf16 v[80:95], v[44:47], v[16:19], v[80:95]
    s_waitcnt vmcnt(6)
    s_nop 0
    v_mfma_f32_32x32x16_bf16 v[96:111], v[40:43], v[20:23], v[96:111]
    v_mfma_f32_32x32x16_bf16 v[112:127], v[44:47], v[20:23], v[112:127]
    ds_read_b64_tr_b16 v[40:41], v247 offset:49152
    ds_read_b64_tr_b16 v[42:43], v247 offset:50176
    ds_read_b64_tr_b16 v[44:45], v239 offset:49152
    ds_read_b64_tr_b16 v[46:47], v239 offset:50176
    s_waitcnt vmcnt(5) lgkmcnt(6)
    v_mfma_f32_32x32x16_bf16 v[64:79], v[48:51], v[176:179], v[64:79]
    s_waitcnt lgkmcnt(4)
    v_mfma_f32_32x32x16_bf16 v[80:95], v[52:55], v[176:179], v[80:95]
    s_waitcnt vmcnt(4)
    s_nop 0
    v_mfma_f32_32x32x16_bf16 v[96:111], v[48:51], v[180:183], v[96:111]
    v_mfma_f32_32x32x16_bf16 v[112:127], v[52:55], v[180:183], v[112:127]
    ds_read_b64_tr_b16 v[48:49], v247 offset:8192
    ds_read_b64_tr_b16 v[50:51], v247 offset:9216
    ds_read_b64_tr_b16 v[52:53], v239 offset:8192
    ds_read_b64_tr_b16 v[54:55], v239 offset:9216
    s_waitcnt vmcnt(3) lgkmcnt(6)
    v_mfma_f32_32x32x16_bf16 v[64:79], v[40:43], v[136:139], v[64:79]
    s_waitcnt lgkmcnt(4)
    v_mfma_f32_32x32x16_bf16 v[80:95], v[44:47], v[136:139], v[80:95]
    s_waitcnt vmcnt(2)
    v_mfma_f32_32x32x16_bf16 v[96:111], v[40:43], v[140:143], v[96:111]
    v_mfma_f32_32x32x16_bf16 v[112:127], v[44:47], v[140:143], v[112:127]
    s_waitcnt vmcnt(1) lgkmcnt(2)
    v_mfma_f32_32x32x16_bf16 v[64:79], v[48:51], v[184:187], v[64:79]
    s_waitcnt lgkmcnt(0)
    v_mfma_f32_32x32x16_bf16 v[80:95], v[52:55], v[184:187], v[80:95]
    s_waitcnt vmcnt(0)
    v_mfma_f32_32x32x16_bf16 v[96:111], v[48:51], v[188:191], v[96:111]
    v_mfma_f32_32x32x16_bf16 v[112:127], v[52:55], v[188:191], v[112:127]
    s_barrier
    s_nop 5
    ds_write_b128 v232, v[64:67] offset:0
    ds_write_b128 v232, v[68:71] offset:32
    ds_write_b128 v232, v[72:75] offset:64
    ds_write_b128 v232, v[76:79] offset:96
    ds_write_b128 v232, v[80:83] offset:128
    ds_write_b128 v232, v[84:87] offset:160
    ds_write_b128 v232, v[88:91] offset:192
    ds_write_b128 v232, v[92:95] offset:224
    ds_write_b128 v232, v[96:99] offset:8704
    ds_write_b128 v232, v[100:103] offset:8736
    ds_write_b128 v232, v[104:107] offset:8768
    ds_write_b128 v232, v[108:111] offset:8800
    ds_write_b128 v232, v[112:115] offset:8832
    ds_write_b128 v232, v[116:119] offset:8864
    ds_write_b128 v232, v[120:123] offset:8896
    ds_write_b128 v232, v[124:127] offset:8928
    s_waitcnt lgkmcnt(0)
    s_barrier
    ds_read_b128 v[64:67], v231 offset:0
    ds_read_b128 v[68:71], v231 offset:16
    ds_read_b128 v[72:75], v231 offset:17408
    ds_read_b128 v[76:79], v231 offset:17424
    ds_read_b128 v[80:83], v231 offset:34816
    ds_read_b128 v[84:87], v231 offset:34832
    ds_read_b128 v[88:91], v231 offset:52224
    ds_read_b128 v[92:95], v231 offset:52240
    ds_read_b128 v[96:99], v231 offset:8704
    ds_read_b128 v[100:103], v231 offset:8720
    ds_read_b128 v[104:107], v231 offset:26112
    ds_read_b128 v[108:111], v231 offset:26128
    ds_read_b128 v[112:115], v231 offset:43520
    ds_read_b128 v[116:119], v231 offset:43536
    ds_read_b128 v[120:123], v231 offset:60928
    ds_read_b128 v[124:127], v231 offset:60944
    s_waitcnt lgkmcnt(13)
    v_add_f32 v64, v64, v72
    v_add_f32 v65, v65, v73
    v_add_f32 v66, v66, v74
    v_add_f32 v67, v67, v75
    s_waitcnt lgkmcnt(12)
    v_add_f32 v68, v68, v76
    v_add_f32 v69, v69, v77
    v_add_f32 v70, v70, v78
    v_add_f32 v71, v71, v79
    s_waitcnt lgkmcnt(9)
    v_add_f32 v80, v80, v88
    v_add_f32 v81, v81, v89
    v_add_f32 v82, v82, v90
    v_add_f32 v83, v83, v91
    s_waitcnt lgkmcnt(8)
    v_add_f32 v84, v84, v92
    v_add_f32 v85, v85, v93
    v_add_f32 v86, v86, v94
    v_add_f32 v87, v87, v95
    v_lshlrev_b32_e64 v8, 16, v248
    v_and_b32 v9, 0xffff0000, v248
    v_lshlrev_b32_e64 v10, 16, v249
    v_and_b32 v11, 0xffff0000, v249
    v_lshlrev_b32_e64 v12, 16, v250
    v_and_b32 v13, 0xffff0000, v250
    v_lshlrev_b32_e64 v14, 16, v251
    v_and_b32 v15, 0xffff0000, v251
    v_add_f32 v64, v64, v80
    v_add_f32 v65, v65, v81
    v_add_f32 v66, v66, v82
    v_add_f32 v67, v67, v83
    v_add_f32 v68, v68, v84
    v_add_f32 v69, v69, v85
    v_add_f32 v70, v70, v86
    v_add_f32 v71, v71, v87
    v_add_f32 v64, v64, v8
    v_add_f32 v65, v65, v9
    v_add_f32 v66, v66, v10
    v_add_f32 v67, v67, v11
    v_add_f32 v68, v68, v12
    v_add_f32 v69, v69, v13
    v_add_f32 v70, v70, v14
    v_add_f32 v71, v71, v15
    v_cvt_pk_bf16_f32 v16, v64, v65
    v_cvt_pk_bf16_f32 v17, v66, v67
    v_cvt_pk_bf16_f32 v18, v68, v69
    v_cvt_pk_bf16_f32 v19, v70, v71
    buffer_store_dwordx4 v[16:19], v230, s[40:43], 0 offen sc1
    s_waitcnt lgkmcnt(5)
    v_add_f32 v96, v96, v104
    v_add_f32 v97, v97, v105
    v_add_f32 v98, v98, v106
    v_add_f32 v99, v99, v107
    s_waitcnt lgkmcnt(4)
    v_add_f32 v100, v100, v108
    v_add_f32 v101, v101, v109
    v_add_f32 v102, v102, v110
    v_add_f32 v103, v103, v111
    s_waitcnt lgkmcnt(1)
    v_add_f32 v112, v112, v120
    v_add_f32 v113, v113, v121
    v_add_f32 v114, v114, v122
    v_add_f32 v115, v115, v123
    s_waitcnt lgkmcnt(0)
    v_add_f32 v116, v116, v124
    v_add_f32 v117, v117, v125
    v_add_f32 v118, v118, v126
    v_add_f32 v119, v119, v127
    v_lshlrev_b32_e64 v8, 16, v252
    v_and_b32 v9, 0xffff0000, v252
    v_lshlrev_b32_e64 v10, 16, v253
    v_and_b32 v11, 0xffff0000, v253
    v_lshlrev_b32_e64 v12, 16, v254
    v_and_b32 v13, 0xffff0000, v254
    v_lshlrev_b32_e64 v14, 16, v255
    v_and_b32 v15, 0xffff0000, v255
    v_add_f32 v96, v96, v112
    v_add_f32 v97, v97, v113
    v_add_f32 v98, v98, v114
    v_add_f32 v99, v99, v115
    v_add_f32 v100, v100, v116
    v_add_f32 v101, v101, v117
    v_add_f32 v102, v102, v118
    v_add_f32 v103, v103, v119
    v_add_f32 v96, v96, v8
    v_add_f32 v97, v97, v9
    v_add_f32 v98, v98, v10
    v_add_f32 v99, v99, v11
    v_add_f32 v100, v100, v12
    v_add_f32 v101, v101, v13
    v_add_f32 v102, v102, v14
    v_add_f32 v103, v103, v15
    v_cvt_pk_bf16_f32 v20, v96, v97
    v_cvt_pk_bf16_f32 v21, v98, v99
    v_cvt_pk_bf16_f32 v22, v100, v101
    v_cvt_pk_bf16_f32 v23, v102, v103
    buffer_store_dwordx4 v[20:23], v230, s[40:43], s77 offen sc1
P2_END_F0:
    s_endpgm
K1_F1:
    v_bfe_u32 v3, v0, 4, 1
    v_bfe_u32 v4, v0, 2, 2
    v_and_b32 v5, 3, v0
    v_lshl_add_u32 v6, v237, 3, v4
    v_lshlrev_b32_e64 v5, 3, v5
    v_lshl_add_u32 v1, v3, 5, v5
    v_lshlrev_b32 v7, 6, v4
    s_lshr_b32 s60, s3, 1
    s_and_b32 s60, s60, 1
    s_add_u32 s61, s60, 6
    s_lshl_b32 s62, s61, 5
    v_xor_b32 v2, s62, v1
    v_xor_b32_e64 v2, v2, v7
    v_lshl_add_u32 v2, v3, 13, v2
    v_lshl_add_u32 v216, v6, 8, v2
    v_add_u32 v217, 0xc000, v216
    v_bfe_u32 v7, v0, 3, 1
    v_lshlrev_b32 v7, 6, v7
    v_xor_b32 v2, v1, v7
    v_lshl_add_u32 v2, v6, 7, v2
    v_add_u32 v218, 0x18000, v2
    v_xor_b32 v220, 64, v218
    s_and_b32 s62, s3, 1
    s_lshl_b32 s62, s62, 1
    s_lshl_b32 s63, s26, 2
    s_add_u32 s62, s62, s63
    s_mul_i32 s70, s62, 0x24000
    s_lshl_b32 s63, s27, 3
    s_add_u32 s63, s63, s61
    s_lshl_b32 s63, s63, 10
    s_add_u32 s70, s70, s63
    s_mul_i32 s63, s60, 0x1080
    v_add_u32 v238, 0x1080, v223
    v_subrev_u32 v238, s63, v238
    v_add_u32 v223, s63, v223
    v_mov_b32 v243, v238
    s_mul_i32 s63, s60, 0x24000
    s_add_u32 s77, s70, 0x24000
    s_sub_u32 s77, s77, s63
    s_add_u32 s70, s70, s63
    s_mov_b32 s59, s77
    v_lshlrev_b32 v200, 16, v16
    v_and_b32 v201, 0xffff0000, v16
    v_lshlrev_b32_e64 v202, 16, v17
    v_and_b32 v203, 0xffff0000, v17
    v_lshlrev_b32_e64 v204, 16, v18
    v_and_b32 v205, 0xffff0000, v18
    v_lshlrev_b32_e64 v206, 16, v19
    v_and_b32 v207, 0xffff0000, v19
    v_fma_f32 v200, v200, v228, v230
    v_fma_f32 v201, v201, v228, v230
    v_fma_f32 v202, v202, v228, v230
    v_fma_f32 v203, v203, v228, v230
    v_fma_f32 v204, v204, v228, v230
    v_fma_f32 v205, v205, v228, v230
    v_fma_f32 v206, v206, v228, v230
    v_fma_f32 v207, v207, v228, v230
    v_cvt_pk_bf16_f32 v16, v200, v201
    v_cvt_pk_bf16_f32 v17, v202, v203
    v_cvt_pk_bf16_f32 v18, v204, v205
    v_cvt_pk_bf16_f32 v19, v206, v207
    s_waitcnt vmcnt(3) lgkmcnt(0)
    s_barrier
    ds_read_b128 v[184:187], v223 offset:0
    ds_read_b64_tr_b16 v[160:161], v216 offset:0
    ds_read_b64_tr_b16 v[162:163], v216 offset:1024
    ds_read_b128 v[188:191], v243 offset:0
    ds_read_b64_tr_b16 v[164:165], v218 offset:0
    ds_read_b64_tr_b16 v[166:167], v218 offset:512
    ds_read_b64_tr_b16 v[168:169], v220 offset:0
    ds_read_b64_tr_b16 v[170:171], v220 offset:512
    s_add_u32 m0, s66, 0xc000
    s_nop 0
    buffer_load_dwordx4 v225, s[36:39], s65 offen lds
    ds_write_b128 v222, v[16:19] offset:16896
    v_lshlrev_b32 v200, 16, v20
    v_and_b32 v201, 0xffff0000, v20
    v_lshlrev_b32_e64 v202, 16, v21
    v_and_b32 v203, 0xffff0000, v21
    s_add_u32 m0, s66, 0xe000
    s_nop 0
    buffer_load_dwordx4 v226, s[40:43], s65 offen lds
    v_lshlrev_b32 v204, 16, v22
    v_and_b32 v205, 0xffff0000, v22
    v_lshlrev_b32_e64 v206, 16, v23
    v_and_b32 v207, 0xffff0000, v23
    v_fma_f32 v200, v200, v229, v231
    s_add_u32 s65, s65, s75
    s_cmp_eq_u32 s65, s76
    s_cselect_b32 s65, 0, s65
    s_add_u32 m0, s66, 0x10000
    s_nop 0
    buffer_load_dwordx4 v225, s[36:39], s65 offen lds
    v_fma_f32 v201, v201, v229, v231
    v_fma_f32 v202, v202, v229, v231
    v_fma_f32 v203, v203, v229, v231
    v_fma_f32 v204, v204, v229, v231
    v_fma_f32 v205, v205, v229, v231
    s_add_u32 m0, s66, 0x12000
    s_nop 0
    buffer_load_dwordx4 v226, s[40:43], s65 offen lds
    s_add_u32 s65, s65, s75
    v_fma_f32 v206, v206, v229, v231
    v_fma_f32 v207, v207, v229, v231
    v_cvt_pk_bf16_f32 v20, v200, v201
    v_cvt_pk_bf16_f32 v21, v202, v203
    v_cvt_pk_bf16_f32 v22, v204, v205
    v_cvt_pk_bf16_f32 v23, v206, v207
    ds_write_b128 v222, v[20:23] offset:17024
    s_mov_b32 s52, s22
    s_nop 0
    s_and_b32 s53, s23, 0xffff
    s_mov_b32 s54, 0x100
    s_mov_b32 s55, 0x20000
    v_mov_b32 v240, 0x7fff0000
    v_cmp_eq_u32 vcc, 0, v0
    s_nop 1
    v_cndmask_b32 v235, v240, 0, vcc
    s_lshl_b32 s60, s27, 2
    s_add_u32 s60, s60, s3
    s_sub_u32 s60, s60, 4
    s_lshl_b32 s61, s60, 11
    s_add_u32 s61, s61, 0x1000000
    s_lshl_b32 s62, s60, 8
    s_add_u32 s62, s62, 0x1100000
    s_lshl_b32 s74, s60, 2
    s_lshl_b32 s73, s27, 13
    s_add_u32 s73, s73, 0x1000000
    s_cmp_eq_u32 s26, s27
    s_cselect_b32 s62, s62, 0x7fff0000
    s_cselect_b32 s61, s61, 0x7fff0000
    s_cselect_b32 s74, s74, 0x7fff0000
    v_mov_b32 v128, 0
    v_mov_b32 v129, 0
    v_mov_b32 v130, 0
    v_mov_b32 v131, 0
    buffer_store_dwordx4 v[128:131], v227, s[44:47], s61 offen offset:0 sc1
    buffer_store_dwordx4 v[128:131], v227, s[44:47], s61 offen offset:1024 sc1
    v_cmp_gt_u32 vcc, 16, v0
    s_nop 1
    v_cndmask_b32 v238, v240, v227, vcc
    buffer_store_dwordx4 v[128:131], v238, s[44:47], s62 offen sc1
    s_waitcnt lgkmcnt(7)
    v_mfma_f32_32x32x16_bf16 v[64:79], v[160:163], v[184:187], 0
    ds_read_b128 v[192:195], v223 offset:1056
    ds_read_b64_tr_b16 v[172:173], v216 offset:4096
    ds_read_b64_tr_b16 v[174:175], v216 offset:5120
    s_waitcnt lgkmcnt(9)
    s_nop 0
    v_mfma_f32_32x32x16_bf16 v[80:95], v[160:163], v[188:191], 0
    ds_read_b128 v[196:199], v243 offset:1056
    ds_read_b64_tr_b16 v[176:177], v218 offset:2048
    ds_read_b64_tr_b16 v[178:179], v218 offset:2560
    s_waitcnt lgkmcnt(10)
    s_nop 0
    v_mfma_f32_32x32x16_bf16 v[96:111], v[164:167], v[184:187], 0
    ds_read_b64_tr_b16 v[180:181], v220 offset:2048
    ds_read_b64_tr_b16 v[182:183], v220 offset:2560
    s_waitcnt lgkmcnt(10)
    v_mfma_f32_32x32x16_bf16 v[112:127], v[184:187], v[168:171], 0
    s_waitcnt lgkmcnt(5)
    v_mfma_f32_32x32x16_bf16 v[64:79], v[172:175], v[192:195], v[64:79]
    ds_read_b128 v[184:187], v223 offset:2112
    ds_read_b64_tr_b16 v[160:161], v216 offset:16384
    ds_read_b64_tr_b16 v[162:163], v216 offset:17408
    s_waitcnt lgkmcnt(7)
    s_nop 0
    v_mfma_f32_32x32x16_bf16 v[80:95], v[172:175], v[196:199], v[80:95]
    ds_read_b128 v[188:191], v243 offset:2112
    ds_read_b64_tr_b16 v[164:165], v218 offset:4096
    ds_read_b64_tr_b16 v[166:167], v218 offset:4608
    s_waitcnt lgkmcnt(8)
    s_nop 0
    v_mfma_f32_32x32x16_bf16 v[96:111], v[176:179], v[192:195], v[96:111]
    ds_read_b64_tr_b16 v[168:169], v220 offset:4096
    ds_read_b64_tr_b16 v[170:171], v220 offset:4608
    s_waitcnt lgkmcnt(8)
    v_mfma_f32_32x32x16_bf16 v[112:127], v[192:195], v[180:183], v[112:127]
    s_waitcnt vmcnt(7)
    s_barrier
    s_add_u32 m0, s66, 0x14000
    s_nop 0
    buffer_load_dwordx4 v225, s[36:39], s65 offen lds
    v_lshlrev_b32_e64 v200, 16, v24
    v_and_b32 v201, 0xffff0000, v24
    v_lshlrev_b32_e64 v202, 16, v25
    v_and_b32 v203, 0xffff0000, v25
    s_add_u32 m0, s66, 0x16000
    s_nop 0
    buffer_load_dwordx4 v226, s[40:43], s65 offen lds
    v_lshlrev_b32 v204, 16, v26
    v_and_b32 v205, 0xffff0000, v26
    v_lshlrev_b32_e64 v206, 16, v27
    v_and_b32 v207, 0xffff0000, v27
    s_add_u32 s65, s65, s75
    s_cmp_eq_u32 s65, s76
    s_cselect_b32 s65, 0, s65
    s_add_u32 m0, s66, 0
    s_nop 0
    s_nop 0
    buffer_load_dwordx4 v225, s[36:39], s65 offen lds
    v_fma_f32 v200, v200, v228, v230
    v_fma_f32 v201, v201, v228, v230
    v_fma_f32 v202, v202, v228, v230
    v_fma_f32 v203, v203, v228, v230
    s_add_u32 m0, s66, 0x2000
    s_nop 0
    s_nop 0
    buffer_load_dwordx4 v226, s[40:43], s65 offen lds
    v_fma_f32 v204, v204, v228, v230
    v_fma_f32 v205, v205, v228, v230
    v_fma_f32 v206, v206, v228, v230
    v_fma_f32 v207, v207, v228, v230
    s_add_u32 s65, s65, s75
    s_add_u32 m0, s66, 0x1c000
    s_nop 0
    buffer_load_dwordx4 v224, s[32:35], s64 offen lds
    s_add_u32 s64, s64, 0x2a000
    s_cmp_eq_u32 s64, 0x126000
    s_cselect_b32 s64, 0, s64
    s_nop 0
    v_cvt_pk_bf16_f32 v24, v200, v201
    v_cvt_pk_bf16_f32 v25, v202, v203
    v_cvt_pk_bf16_f32 v26, v204, v205
    v_cvt_pk_bf16_f32 v27, v206, v207
    s_waitcnt lgkmcnt(5)
    s_nop 0
    v_mfma_f32_32x32x16_bf16 v[64:79], v[160:163], v[184:187], v[64:79]
    ds_read_b128 v[192:195], v223 offset:3168
    ds_read_b64_tr_b16 v[172:173], v216 offset:20480
    ds_read_b64_tr_b16 v[174:175], v216 offset:21504
    s_waitcnt lgkmcnt(7)
    s_nop 0
    v_mfma_f32_32x32x16_bf16 v[80:95], v[160:163], v[188:191], v[80:95]
    ds_read_b128 v[196:199], v243 offset:3168
    ds_read_b64_tr_b16 v[176:177], v218 offset:6144
    ds_read_b64_tr_b16 v[178:179], v218 offset:6656
    s_waitcnt lgkmcnt(8)
    s_nop 0
    v_mfma_f32_32x32x16_bf16 v[96:111], v[164:167], v[184:187], v[96:111]
    ds_read_b64_tr_b16 v[180:181], v220 offset:6144
    ds_read_b64_tr_b16 v[182:183], v220 offset:6656
    s_waitcnt lgkmcnt(8)
    v_mfma_f32_32x32x16_bf16 v[112:127], v[184:187], v[168:171], v[112:127]
    s_waitcnt lgkmcnt(5)
    v_mfma_f32_32x32x16_bf16 v[64:79], v[172:175], v[192:195], v[64:79]
    ds_read_b128 v[184:187], v223 offset:16896
    ds_read_b64_tr_b16 v[160:161], v216 offset:32768
    ds_read_b64_tr_b16 v[162:163], v216 offset:33792
    s_waitcnt lgkmcnt(7)
    s_nop 0
    v_mfma_f32_32x32x16_bf16 v[80:95], v[172:175], v[196:199], v[80:95]
    ds_read_b128 v[188:191], v243 offset:16896
    ds_read_b64_tr_b16 v[164:165], v218 offset:8192
    ds_read_b64_tr_b16 v[166:167], v218 offset:8704
    s_waitcnt lgkmcnt(8)
    s_nop 0
    v_mfma_f32_32x32x16_bf16 v[96:111], v[176:179], v[192:195], v[96:111]
    ds_read_b64_tr_b16 v[168:169], v220 offset:8192
    ds_read_b64_tr_b16 v[170:171], v220 offset:8704
    s_waitcnt lgkmcnt(8)
    v_mfma_f32_32x32x16_bf16 v[112:127], v[192:195], v[180:183], v[112:127]
    s_waitcnt vmcnt(10)
    s_barrier
    s_add_u32 m0, s66, 0x4000
    s_nop 0
    buffer_load_dwordx4 v225, s[36:39], s65 offen lds
    ds_write_b128 v222, v[24:27] offset:0
    v_lshlrev_b32_e64 v200, 16, v28
    v_and_b32 v201, 0xffff0000, v28
    v_lshlrev_b32_e64 v202, 16, v29
    v_and_b32 v203, 0xffff0000, v29
    v_lshlrev_b32_e64 v204, 16, v30
    v_and_b32 v205, 0xffff0000, v30
    v_lshlrev_b32_e64 v206, 16, v31
    v_and_b32 v207, 0xffff0000, v31
    v_fma_f32 v200, v200, v229, v231
    v_fma_f32 v201, v201, v229, v231
    s_add_u32 m0, s66, 0x6000
    s_nop 0
    buffer_load_dwordx4 v226, s[40:43], s65 offen lds
    s_add_u32 s65, s65, s75
    s_cmp_eq_u32 s65, s76
    s_cselect_b32 s65, 0, s65
    v_fma_f32 v202, v202, v229, v231
    v_fma_f32 v203, v203, v229, v231
    v_fma_f32 v204, v204, v229, v231
    v_fma_f32 v205, v205, v229, v231
    v_fma_f32 v206, v206, v229, v231
    v_fma_f32 v207, v207, v229, v231
    v_cvt_pk_bf16_f32 v28, v200, v201
    v_cvt_pk_bf16_f32 v29, v202, v203
    v_cvt_pk_bf16_f32 v30, v204, v205
    v_cvt_pk_bf16_f32 v31, v206, v207
    ds_write_b128 v222, v[28:31] offset:128
    s_waitcnt lgkmcnt(7)
    s_nop 0
    v_mfma_f32_32x32x16_bf16 v[64:79], v[160:163], v[184:187], v[64:79]
    ds_read_b128 v[192:195], v223 offset:17952
    ds_read_b64_tr_b16 v[172:173], v216 offset:36864
    ds_read_b64_tr_b16 v[174:175], v216 offset:37888
    s_waitcnt lgkmcnt(9)
    s_nop 0
    v_mfma_f32_32x32x16_bf16 v[80:95], v[160:163], v[188:191], v[80:95]
    ds_read_b128 v[196:199], v243 offset:17952
    ds_read_b64_tr_b16 v[176:177], v218 offset:10240
    ds_read_b64_tr_b16 v[178:179], v218 offset:10752
    s_waitcnt lgkmcnt(10)
    s_nop 0
    v_mfma_f32_32x32x16_bf16 v[96:111], v[164:167], v[184:187], v[96:111]
    ds_read_b64_tr_b16 v[180:181], v220 offset:10240
    ds_read_b64_tr_b16 v[182:183], v220 offset:10752
    s_waitcnt lgkmcnt(10)
    v_mfma_f32_32x32x16_bf16 v[112:127], v[184:187], v[168:171], v[112:127]
    s_waitcnt lgkmcnt(5)
    v_mfma_f32_32x32x16_bf16 v[64:79], v[172:175], v[192:195], v[64:79]
    ds_read_b128 v[184:187], v223 offset:19008
    ds_read_b64_tr_b16 v[160:161], v217 offset:0
    ds_read_b64_tr_b16 v[162:163], v217 offset:1024
    s_waitcnt lgkmcnt(7)
    s_nop 0
    v_mfma_f32_32x32x16_bf16 v[80:95], v[172:175], v[196:199], v[80:95]
    ds_read_b128 v[188:191], v243 offset:19008
    ds_read_b64_tr_b16 v[164:165], v218 offset:12288
    ds_read_b64_tr_b16 v[166:167], v218 offset:12800
    s_waitcnt lgkmcnt(8)
    s_nop 0
    v_mfma_f32_32x32x16_bf16 v[96:111], v[176:179], v[192:195], v[96:111]
    ds_read_b64_tr_b16 v[168:169], v220 offset:12288
    ds_read_b64_tr_b16 v[170:171], v220 offset:12800
    s_waitcnt lgkmcnt(8)
    v_mfma_f32_32x32x16_bf16 v[112:127], v[192:195], v[180:183], v[112:127]
    s_waitcnt vmcnt(2)
    s_barrier
    s_add_u32 m0, s66, 0x8000
    s_nop 0
    buffer_load_dwordx4 v225, s[36:39], s65 offen lds
    v_lshlrev_b32_e64 v200, 16, v32
    v_and_b32 v201, 0xffff0000, v32
    v_lshlrev_b32_e64 v202, 16, v33
    v_and_b32 v203, 0xffff0000, v33
    v_lshlrev_b32_e64 v204, 16, v34
    v_and_b32 v205, 0xffff0000, v34
    s_add_u32 m0, s66, 0xa000
    s_nop 0
    buffer_load_dwordx4 v226, s[40:43], s65 offen lds
    v_lshlrev_b32 v206, 16, v35
    v_and_b32 v207, 0xffff0000, v35
    v_fma_f32 v200, v200, v228, v230
    v_fma_f32 v201, v201, v228, v230
    v_fma_f32 v202, v202, v228, v230
    v_fma_f32 v203, v203, v228, v230
    s_add_u32 s65, s65, s75
    s_add_u32 m0, s66, 0x18000
    s_nop 0
    buffer_load_dwordx4 v224, s[32:35], s64 offen lds
    s_add_u32 s64, s64, 0x2a000
    s_cmp_eq_u32 s64, 0x126000
    s_cselect_b32 s64, 0, s64
    s_nop 0
    v_fma_f32 v204, v204, v228, v230
    v_fma_f32 v205, v205, v228, v230
    v_fma_f32 v206, v206, v228, v230
    v_fma_f32 v207, v207, v228, v230
    v_cvt_pk_bf16_f32 v32, v200, v201
    v_cvt_pk_bf16_f32 v33, v202, v203
    v_cvt_pk_bf16_f32 v34, v204, v205
    v_cvt_pk_bf16_f32 v35, v206, v207
    s_lshl_b32 s60, s2, 3
    s_add_u32 s60, s60, s3
    s_lshl_b32 s60, s60, 10
    s_nop 0
    s_sub_u32 s61, s60, 0x188000
    s_mov_b32 s62, 0x62000
    s_cmp_lt_u32 s60, 0x188000
    s_cselect_b32 s28, s18, s10
    s_cselect_b32 s29, s19, s11
    s_cselect_b32 s30, 0x188000, s62
    s_cselect_b32 s60, s60, s61
    s_and_b32 s29, s29, 0xffff
    buffer_load_dwordx4 v[8:11], v227, s[28:31], s60 offen
    s_waitcnt lgkmcnt(5)
    v_mfma_f32_32x32x16_bf16 v[64:79], v[160:163], v[184:187], v[64:79]
    ds_read_b128 v[192:195], v223 offset:20064
    ds_read_b64_tr_b16 v[172:173], v217 offset:4096
    ds_read_b64_tr_b16 v[174:175], v217 offset:5120
    s_waitcnt lgkmcnt(7)
    s_nop 0
    v_mfma_f32_32x32x16_bf16 v[80:95], v[160:163], v[188:191], v[80:95]
    ds_read_b128 v[196:199], v243 offset:20064
    ds_read_b64_tr_b16 v[176:177], v218 offset:14336
    ds_read_b64_tr_b16 v[178:179], v218 offset:14848
    s_waitcnt lgkmcnt(8)
    s_nop 0
    v_mfma_f32_32x32x16_bf16 v[96:111], v[164:167], v[184:187], v[96:111]
    ds_read_b64_tr_b16 v[180:181], v220 offset:14336
    ds_read_b64_tr_b16 v[182:183], v220 offset:14848
    s_waitcnt lgkmcnt(8)
    v_mfma_f32_32x32x16_bf16 v[112:127], v[184:187], v[168:171], v[112:127]
    s_waitcnt lgkmcnt(5)
    v_mfma_f32_32x32x16_bf16 v[64:79], v[172:175], v[192:195], v[64:79]
    ds_read_b128 v[184:187], v223 offset:0
    ds_read_b64_tr_b16 v[160:161], v217 offset:16384
    ds_read_b64_tr_b16 v[162:163], v217 offset:17408
    s_waitcnt lgkmcnt(7)
    s_nop 0
    v_mfma_f32_32x32x16_bf16 v[80:95], v[172:175], v[196:199], v[80:95]
    ds_read_b128 v[188:191], v243 offset:0
    ds_read_b64_tr_b16 v[164:165], v218 offset:16384
    ds_read_b64_tr_b16 v[166:167], v218 offset:16896
    s_waitcnt lgkmcnt(8)
    s_nop 0
    v_mfma_f32_32x32x16_bf16 v[96:111], v[176:179], v[192:195], v[96:111]
    ds_read_b64_tr_b16 v[168:169], v220 offset:16384
    ds_read_b64_tr_b16 v[170:171], v220 offset:16896
    s_waitcnt lgkmcnt(8)
    v_mfma_f32_32x32x16_bf16 v[112:127], v[192:195], v[180:183], v[112:127]
    s_barrier
    s_add_u32 m0, s66, 0xc000
    s_nop 0
    buffer_load_dwordx4 v225, s[36:39], s65 offen lds
    ds_write_b128 v222, v[32:35] offset:16896
    v_lshlrev_b32 v200, 16, v36
    v_and_b32 v201, 0xffff0000, v36
    v_lshlrev_b32_e64 v202, 16, v37
    v_and_b32 v203, 0xffff0000, v37
    v_lshlrev_b32_e64 v204, 16, v38
    v_and_b32 v205, 0xffff0000, v38
    v_lshlrev_b32_e64 v206, 16, v39
    v_and_b32 v207, 0xffff0000, v39
    v_fma_f32 v200, v200, v229, v231
    v_fma_f32 v201, v201, v229, v231
    s_add_u32 m0, s66, 0xe000
    s_nop 0
    buffer_load_dwordx4 v226, s[40:43], s65 offen lds
    s_add_u32 s65, s65, s75
    s_cmp_eq_u32 s65, s76
    s_cselect_b32 s65, 0, s65
    v_fma_f32 v202, v202, v229, v231
    v_fma_f32 v203, v203, v229, v231
    v_fma_f32 v204, v204, v229, v231
    v_fma_f32 v205, v205, v229, v231
    v_fma_f32 v206, v206, v229, v231
    v_fma_f32 v207, v207, v229, v231
    v_cvt_pk_bf16_f32 v36, v200, v201
    v_cvt_pk_bf16_f32 v37, v202, v203
    v_cvt_pk_bf16_f32 v38, v204, v205
    v_cvt_pk_bf16_f32 v39, v206, v207
    ds_write_b128 v222, v[36:39] offset:17024
    s_waitcnt lgkmcnt(7)
    s_nop 0
    v_mfma_f32_32x32x16_bf16 v[64:79], v[160:163], v[184:187], v[64:79]
    ds_read_b128 v[192:195], v223 offset:1056
    ds_read_b64_tr_b16 v[172:173], v217 offset:20480
    ds_read_b64_tr_b16 v[174:175], v217 offset:21504
    s_waitcnt lgkmcnt(9)
    s_nop 0
    v_mfma_f32_32x32x16_bf16 v[80:95], v[160:163], v[188:191], v[80:95]
    ds_read_b128 v[196:199], v243 offset:1056
    ds_read_b64_tr_b16 v[176:177], v218 offset:18432
    ds_read_b64_tr_b16 v[178:179], v218 offset:18944
    s_waitcnt lgkmcnt(10)
    s_nop 0
    v_mfma_f32_32x32x16_bf16 v[96:111], v[164:167], v[184:187], v[96:111]
    ds_read_b64_tr_b16 v[180:181], v220 offset:18432
    ds_read_b64_tr_b16 v[182:183], v220 offset:18944
    s_waitcnt lgkmcnt(10)
    v_mfma_f32_32x32x16_bf16 v[112:127], v[184:187], v[168:171], v[112:127]
    s_waitcnt lgkmcnt(5)
    v_mfma_f32_32x32x16_bf16 v[64:79], v[172:175], v[192:195], v[64:79]
    ds_read_b128 v[184:187], v223 offset:2112
    ds_read_b64_tr_b16 v[160:161], v217 offset:32768
    ds_read_b64_tr_b16 v[162:163], v217 offset:33792
    s_waitcnt lgkmcnt(7)
    s_nop 0
    v_mfma_f32_32x32x16_bf16 v[80:95], v[172:175], v[196:199], v[80:95]
    ds_read_b128 v[188:191], v243 offset:2112
    ds_read_b64_tr_b16 v[164:165], v218 offset:20480
    ds_read_b64_tr_b16 v[166:167], v218 offset:20992
    s_waitcnt lgkmcnt(8)
    s_nop 0
    v_mfma_f32_32x32x16_bf16 v[96:111], v[176:179], v[192:195], v[96:111]
    ds_read_b64_tr_b16 v[168:169], v220 offset:20480
    ds_read_b64_tr_b16 v[170:171], v220 offset:20992
    s_waitcnt lgkmcnt(8)
    v_mfma_f32_32x32x16_bf16 v[112:127], v[192:195], v[180:183], v[112:127]
    s_waitcnt vmcnt(3)
    s_barrier
    s_add_u32 m0, s66, 0x10000
    s_nop 0
    buffer_load_dwordx4 v225, s[36:39], s65 offen lds
    v_lshlrev_b32_e64 v200, 16, v40
    v_and_b32 v201, 0xffff0000, v40
    v_lshlrev_b32_e64 v202, 16, v41
    v_and_b32 v203, 0xffff0000, v41
    v_lshlrev_b32_e64 v204, 16, v42
    v_and_b32 v205, 0xffff0000, v42
    s_add_u32 m0, s66, 0x12000
    s_nop 0
    buffer_load_dwordx4 v226, s[40:43], s65 offen lds
    v_lshlrev_b32 v206, 16, v43
    v_and_b32 v207, 0xffff0000, v43
    v_fma_f32 v200, v200, v228, v230
    v_fma_f32 v201, v201, v228, v230
    v_fma_f32 v202, v202, v228, v230
    v_fma_f32 v203, v203, v228, v230
    s_add_u32 s65, s65, s75
    s_add_u32 m0, s66, 0x1a000
    s_nop 0
    buffer_load_dwordx4 v224, s[32:35], s64 offen lds
    s_add_u32 s64, s64, 0x2a000
    s_cmp_eq_u32 s64, 0x126000
    s_cselect_b32 s64, 0, s64
    s_nop 0
    v_fma_f32 v204, v204, v228, v230
    v_fma_f32 v205, v205, v228, v230
    v_fma_f32 v206, v206, v228, v230
    v_fma_f32 v207, v207, v228, v230
    v_cvt_pk_bf16_f32 v40, v200, v201
    v_cvt_pk_bf16_f32 v41, v202, v203
    v_cvt_pk_bf16_f32 v42, v204, v205
    v_cvt_pk_bf16_f32 v43, v206, v207
    v_mov_b32_e64 v234, 1
    buffer_store_dword v234, v235, s[52:55], s74 offen sc1
    s_waitcnt lgkmcnt(5)
    s_nop 0
    v_mfma_f32_32x32x16_bf16 v[64:79], v[160:163], v[184:187], v[64:79]
    ds_read_b128 v[192:195], v223 offset:3168
    ds_read_b64_tr_b16 v[172:173], v217 offset:36864
    ds_read_b64_tr_b16 v[174:175], v217 offset:37888
    s_waitcnt lgkmcnt(7)
    s_nop 0
    v_mfma_f32_32x32x16_bf16 v[80:95], v[160:163], v[188:191], v[80:95]
    ds_read_b128 v[196:199], v243 offset:3168
    ds_read_b64_tr_b16 v[176:177], v218 offset:22528
    ds_read_b64_tr_b16 v[178:179], v218 offset:23040
    s_waitcnt lgkmcnt(8)
    s_nop 0
    v_mfma_f32_32x32x16_bf16 v[96:111], v[164:167], v[184:187], v[96:111]
    ds_read_b64_tr_b16 v[180:181], v220 offset:22528
    ds_read_b64_tr_b16 v[182:183], v220 offset:23040
    s_waitcnt lgkmcnt(8)
    v_mfma_f32_32x32x16_bf16 v[112:127], v[184:187], v[168:171], v[112:127]
    s_waitcnt lgkmcnt(5)
    v_mfma_f32_32x32x16_bf16 v[64:79], v[172:175], v[192:195], v[64:79]
    ds_read_b128 v[184:187], v223 offset:16896
    ds_read_b64_tr_b16 v[160:161], v216 offset:0
    ds_read_b64_tr_b16 v[162:163], v216 offset:1024
    s_waitcnt lgkmcnt(7)
    s_nop 0
    v_mfma_f32_32x32x16_bf16 v[80:95], v[172:175], v[196:199], v[80:95]
    ds_read_b128 v[188:191], v243 offset:16896
    ds_read_b64_tr_b16 v[164:165], v218 offset:0
    ds_read_b64_tr_b16 v[166:167], v218 offset:512
    s_waitcnt lgkmcnt(8)
    s_nop 0
    v_mfma_f32_32x32x16_bf16 v[96:111], v[176:179], v[192:195], v[96:111]
    ds_read_b64_tr_b16 v[168:169], v220 offset:0
    ds_read_b64_tr_b16 v[170:171], v220 offset:512
    s_waitcnt lgkmcnt(8)
    v_mfma_f32_32x32x16_bf16 v[112:127], v[192:195], v[180:183], v[112:127]
    s_barrier
    s_add_u32 m0, s66, 0x14000
    s_nop 0
    buffer_load_dwordx4 v225, s[36:39], s65 offen lds
    ds_write_b128 v222, v[40:43] offset:0
    v_lshlrev_b32 v200, 16, v44
    v_and_b32 v201, 0xffff0000, v44
    v_lshlrev_b32_e64 v202, 16, v45
    v_and_b32 v203, 0xffff0000, v45
    v_lshlrev_b32_e64 v204, 16, v46
    v_and_b32 v205, 0xffff0000, v46
    v_lshlrev_b32_e64 v206, 16, v47
    v_and_b32 v207, 0xffff0000, v47
    v_fma_f32 v200, v200, v229, v231
    v_fma_f32 v201, v201, v229, v231
    s_add_u32 m0, s66, 0x16000
    s_nop 0
    buffer_load_dwordx4 v226, s[40:43], s65 offen lds
    s_add_u32 s65, s65, s75
    s_cmp_eq_u32 s65, s76
    s_cselect_b32 s65, 0, s65
    v_fma_f32 v202, v202, v229, v231
    v_fma_f32 v203, v203, v229, v231
    v_fma_f32 v204, v204, v229, v231
    v_fma_f32 v205, v205, v229, v231
    v_fma_f32 v206, v206, v229, v231
    v_fma_f32 v207, v207, v229, v231
    v_cvt_pk_bf16_f32 v44, v200, v201
    v_cvt_pk_bf16_f32 v45, v202, v203
    v_cvt_pk_bf16_f32 v46, v204, v205
    v_cvt_pk_bf16_f32 v47, v206, v207
    ds_write_b128 v222, v[44:47] offset:128
    s_waitcnt lgkmcnt(7)
    s_nop 0
    v_mfma_f32_32x32x16_bf16 v[64:79], v[160:163], v[184:187], v[64:79]
    ds_read_b128 v[192:195], v223 offset:17952
    ds_read_b64_tr_b16 v[172:173], v216 offset:4096
    ds_read_b64_tr_b16 v[174:175], v216 offset:5120
    s_waitcnt lgkmcnt(9)
    s_nop 0
    v_mfma_f32_32x32x16_bf16 v[80:95], v[160:163], v[188:191], v[80:95]
    ds_read_b128 v[196:199], v243 offset:17952
    ds_read_b64_tr_b16 v[176:177], v218 offset:2048
    ds_read_b64_tr_b16 v[178:179], v218 offset:2560
    s_waitcnt lgkmcnt(10)
    s_nop 0
    v_mfma_f32_32x32x16_bf16 v[96:111], v[164:167], v[184:187], v[96:111]
    ds_read_b64_tr_b16 v[180:181], v220 offset:2048
    ds_read_b64_tr_b16 v[182:183], v220 offset:2560
    s_waitcnt lgkmcnt(10)
    v_mfma_f32_32x32x16_bf16 v[112:127], v[184:187], v[168:171], v[112:127]
    s_waitcnt lgkmcnt(5)
    v_mfma_f32_32x32x16_bf16 v[64:79], v[172:175], v[192:195], v[64:79]
    ds_read_b128 v[184:187], v223 offset:19008
    ds_read_b64_tr_b16 v[160:161], v216 offset:16384
    ds_read_b64_tr_b16 v[162:163], v216 offset:17408
    s_waitcnt lgkmcnt(7)
    s_nop 0
    v_mfma_f32_32x32x16_bf16 v[80:95], v[172:175], v[196:199], v[80:95]
    ds_read_b128 v[188:191], v243 offset:19008
    ds_read_b64_tr_b16 v[164:165], v218 offset:4096
    ds_read_b64_tr_b16 v[166:167], v218 offset:4608
    s_waitcnt lgkmcnt(8)
    s_nop 0
    v_mfma_f32_32x32x16_bf16 v[96:111], v[176:179], v[192:195], v[96:111]
    ds_read_b64_tr_b16 v[168:169], v220 offset:4096
    ds_read_b64_tr_b16 v[170:171], v220 offset:4608
    s_waitcnt lgkmcnt(8)
    v_mfma_f32_32x32x16_bf16 v[112:127], v[192:195], v[180:183], v[112:127]
    s_waitcnt vmcnt(3)
    s_barrier
    s_add_u32 m0, s66, 0
    s_nop 0
    buffer_load_dwordx4 v225, s[36:39], s65 offen lds
    v_lshlrev_b32 v200, 16, v48
    v_and_b32 v201, 0xffff0000, v48
    v_lshlrev_b32_e64 v202, 16, v49
    v_and_b32 v203, 0xffff0000, v49
    v_lshlrev_b32_e64 v204, 16, v50
    v_and_b32 v205, 0xffff0000, v50
    s_add_u32 m0, s66, 0x2000
    s_nop 0
    buffer_load_dwordx4 v226, s[40:43], s65 offen lds
    v_lshlrev_b32 v206, 16, v51
    v_and_b32 v207, 0xffff0000, v51
    v_fma_f32 v200, v200, v228, v230
    v_fma_f32 v201, v201, v228, v230
    v_fma_f32 v202, v202, v228, v230
    v_fma_f32 v203, v203, v228, v230
    s_add_u32 s65, s65, s75
    s_add_u32 m0, s66, 0x1c000
    s_nop 0
    buffer_load_dwordx4 v224, s[32:35], s64 offen lds
    s_add_u32 s64, s64, 0x2a000
    s_cmp_eq_u32 s64, 0x126000
    s_cselect_b32 s64, 0, s64
    s_nop 0
    v_fma_f32 v204, v204, v228, v230
    v_fma_f32 v205, v205, v228, v230
    v_fma_f32 v206, v206, v228, v230
    v_fma_f32 v207, v207, v228, v230
    v_cvt_pk_bf16_f32 v48, v200, v201
    v_cvt_pk_bf16_f32 v49, v202, v203
    v_cvt_pk_bf16_f32 v50, v204, v205
    v_cvt_pk_bf16_f32 v51, v206, v207
    s_waitcnt lgkmcnt(5)
    s_nop 0
    v_mfma_f32_32x32x16_bf16 v[64:79], v[160:163], v[184:187], v[64:79]
    ds_read_b128 v[192:195], v223 offset:20064
    ds_read_b64_tr_b16 v[172:173], v216 offset:20480
    ds_read_b64_tr_b16 v[174:175], v216 offset:21504
    s_waitcnt lgkmcnt(7)
    s_nop 0
    v_mfma_f32_32x32x16_bf16 v[80:95], v[160:163], v[188:191], v[80:95]
    ds_read_b128 v[196:199], v243 offset:20064
    ds_read_b64_tr_b16 v[176:177], v218 offset:6144
    ds_read_b64_tr_b16 v[178:179], v218 offset:6656
    s_waitcnt lgkmcnt(8)
    s_nop 0
    v_mfma_f32_32x32x16_bf16 v[96:111], v[164:167], v[184:187], v[96:111]
    ds_read_b64_tr_b16 v[180:181], v220 offset:6144
    ds_read_b64_tr_b16 v[182:183], v220 offset:6656
    s_waitcnt lgkmcnt(8)
    v_mfma_f32_32x32x16_bf16 v[112:127], v[184:187], v[168:171], v[112:127]
    s_waitcnt lgkmcnt(5)
    v_mfma_f32_32x32x16_bf16 v[64:79], v[172:175], v[192:195], v[64:79]
    ds_read_b128 v[184:187], v223 offset:0
    ds_read_b64_tr_b16 v[160:161], v216 offset:32768
    ds_read_b64_tr_b16 v[162:163], v216 offset:33792
    s_waitcnt lgkmcnt(7)
    s_nop 0
    v_mfma_f32_32x32x16_bf16 v[80:95], v[172:175], v[196:199], v[80:95]
    ds_read_b128 v[188:191], v243 offset:0
    ds_read_b64_tr_b16 v[164:165], v218 offset:8192
    ds_read_b64_tr_b16 v[166:167], v218 offset:8704
    s_waitcnt lgkmcnt(8)
    s_nop 0
    v_mfma_f32_32x32x16_bf16 v[96:111], v[176:179], v[192:195], v[96:111]
    ds_read_b64_tr_b16 v[168:169], v220 offset:8192
    ds_read_b64_tr_b16 v[170:171], v220 offset:8704
    s_waitcnt lgkmcnt(8)
    v_mfma_f32_32x32x16_bf16 v[112:127], v[192:195], v[180:183], v[112:127]
    s_barrier
    s_add_u32 m0, s66, 0x4000
    s_nop 0
    buffer_load_dwordx4 v225, s[36:39], s65 offen lds
    ds_write_b128 v222, v[48:51] offset:16896
    v_lshlrev_b32 v200, 16, v52
    v_and_b32 v201, 0xffff0000, v52
    v_lshlrev_b32_e64 v202, 16, v53
    v_and_b32 v203, 0xffff0000, v53
    v_lshlrev_b32_e64 v204, 16, v54
    v_and_b32 v205, 0xffff0000, v54
    v_lshlrev_b32_e64 v206, 16, v55
    v_and_b32 v207, 0xffff0000, v55
    v_fma_f32 v200, v200, v229, v231
    v_fma_f32 v201, v201, v229, v231
    s_add_u32 m0, s66, 0x6000
    s_nop 0
    s_nop 0
    buffer_load_dwordx4 v226, s[40:43], s65 offen lds
    v_fma_f32 v202, v202, v229, v231
    v_fma_f32 v203, v203, v229, v231
    v_fma_f32 v204, v204, v229, v231
    v_fma_f32 v205, v205, v229, v231
    v_fma_f32 v206, v206, v229, v231
    v_fma_f32 v207, v207, v229, v231
    v_cvt_pk_bf16_f32 v52, v200, v201
    v_cvt_pk_bf16_f32 v53, v202, v203
    v_cvt_pk_bf16_f32 v54, v204, v205
    v_cvt_pk_bf16_f32 v55, v206, v207
    ds_write_b128 v222, v[52:55] offset:17024
    s_waitcnt lgkmcnt(7)
    s_nop 0
    v_mfma_f32_32x32x16_bf16 v[64:79], v[160:163], v[184:187], v[64:79]
    ds_read_b128 v[192:195], v223 offset:1056
    ds_read_b64_tr_b16 v[172:173], v216 offset:36864
    ds_read_b64_tr_b16 v[174:175], v216 offset:37888
    s_waitcnt lgkmcnt(9)
    s_nop 0
    v_mfma_f32_32x32x16_bf16 v[80:95], v[160:163], v[188:191], v[80:95]
    ds_read_b128 v[196:199], v243 offset:1056
    ds_read_b64_tr_b16 v[176:177], v218 offset:10240
    ds_read_b64_tr_b16 v[178:179], v218 offset:10752
    s_waitcnt lgkmcnt(10)
    s_nop 0
    v_mfma_f32_32x32x16_bf16 v[96:111], v[164:167], v[184:187], v[96:111]
    ds_read_b64_tr_b16 v[180:181], v220 offset:10240
    ds_read_b64_tr_b16 v[182:183], v220 offset:10752
    s_waitcnt lgkmcnt(10)
    v_mfma_f32_32x32x16_bf16 v[112:127], v[184:187], v[168:171], v[112:127]
    s_waitcnt lgkmcnt(5)
    v_mfma_f32_32x32x16_bf16 v[64:79], v[172:175], v[192:195], v[64:79]
    ds_read_b128 v[184:187], v223 offset:2112
    ds_read_b64_tr_b16 v[160:161], v217 offset:0
    ds_read_b64_tr_b16 v[162:163], v217 offset:1024
    s_waitcnt lgkmcnt(7)
    s_nop 0
    v_mfma_f32_32x32x16_bf16 v[80:95], v[172:175], v[196:199], v[80:95]
    ds_read_b128 v[188:191], v243 offset:2112
    ds_read_b64_tr_b16 v[164:165], v218 offset:12288
    ds_read_b64_tr_b16 v[166:167], v218 offset:12800
    s_waitcnt lgkmcnt(8)
    s_nop 0
    v_mfma_f32_32x32x16_bf16 v[96:111], v[176:179], v[192:195], v[96:111]
    ds_read_b64_tr_b16 v[168:169], v220 offset:12288
    ds_read_b64_tr_b16 v[170:171], v220 offset:12800
    s_waitcnt lgkmcnt(8)
    v_mfma_f32_32x32x16_bf16 v[112:127], v[192:195], v[180:183], v[112:127]
    s_waitcnt vmcnt(2)
    s_barrier
    s_add_u32 m0, s66, 0x18000
    s_nop 0
    buffer_load_dwordx4 v224, s[32:35], s64 offen lds
    v_lshlrev_b32_e64 v200, 16, v56
    v_and_b32 v201, 0xffff0000, v56
    v_lshlrev_b32_e64 v202, 16, v57
    v_and_b32 v203, 0xffff0000, v57
    v_lshlrev_b32_e64 v204, 16, v58
    v_and_b32 v205, 0xffff0000, v58
    v_lshlrev_b32_e64 v206, 16, v59
    v_and_b32 v207, 0xffff0000, v59
    v_fma_f32 v200, v200, v228, v230
    v_fma_f32 v201, v201, v228, v230
    v_fma_f32 v202, v202, v228, v230
    v_fma_f32 v203, v203, v228, v230
    v_fma_f32 v204, v204, v228, v230
    v_fma_f32 v205, v205, v228, v230
    v_fma_f32 v206, v206, v228, v230
    v_fma_f32 v207, v207, v228, v230
    v_cvt_pk_bf16_f32 v56, v200, v201
    v_cvt_pk_bf16_f32 v57, v202, v203
    v_cvt_pk_bf16_f32 v58, v204, v205
    v_cvt_pk_bf16_f32 v59, v206, v207
    s_waitcnt lgkmcnt(5)
    s_nop 0
    v_mfma_f32_32x32x16_bf16 v[64:79], v[160:163], v[184:187], v[64:79]
    ds_read_b128 v[192:195], v223 offset:3168
    ds_read_b64_tr_b16 v[172:173], v217 offset:4096
    ds_read_b64_tr_b16 v[174:175], v217 offset:5120
    s_waitcnt lgkmcnt(7)
    s_nop 0
    v_mfma_f32_32x32x16_bf16 v[80:95], v[160:163], v[188:191], v[80:95]
    ds_read_b128 v[196:199], v243 offset:3168
    ds_read_b64_tr_b16 v[176:177], v218 offset:14336
    ds_read_b64_tr_b16 v[178:179], v218 offset:14848
    s_waitcnt lgkmcnt(8)
    s_nop 0
    v_mfma_f32_32x32x16_bf16 v[96:111], v[164:167], v[184:187], v[96:111]
    ds_read_b64_tr_b16 v[180:181], v220 offset:14336
    ds_read_b64_tr_b16 v[182:183], v220 offset:14848
    s_waitcnt lgkmcnt(8)
    v_mfma_f32_32x32x16_bf16 v[112:127], v[184:187], v[168:171], v[112:127]
    s_waitcnt lgkmcnt(5)
    v_mfma_f32_32x32x16_bf16 v[64:79], v[172:175], v[192:195], v[64:79]
    ds_read_b128 v[184:187], v223 offset:16896
    ds_read_b64_tr_b16 v[160:161], v217 offset:16384
    ds_read_b64_tr_b16 v[162:163], v217 offset:17408
    s_waitcnt lgkmcnt(7)
    s_nop 0
    v_mfma_f32_32x32x16_bf16 v[80:95], v[172:175], v[196:199], v[80:95]
    ds_read_b128 v[188:191], v243 offset:16896
    ds_read_b64_tr_b16 v[164:165], v218 offset:16384
    ds_read_b64_tr_b16 v[166:167], v218 offset:16896
    s_waitcnt lgkmcnt(8)
    s_nop 0
    v_mfma_f32_32x32x16_bf16 v[96:111], v[176:179], v[192:195], v[96:111]
    ds_read_b64_tr_b16 v[168:169], v220 offset:16384
    ds_read_b64_tr_b16 v[170:171], v220 offset:16896
    s_waitcnt lgkmcnt(8)
    v_mfma_f32_32x32x16_bf16 v[112:127], v[192:195], v[180:183], v[112:127]
    s_barrier
    ds_write_b128 v222, v[56:59] offset:0
    v_lshlrev_b32_e64 v200, 16, v60
    v_and_b32 v201, 0xffff0000, v60
    v_lshlrev_b32_e64 v202, 16, v61
    v_and_b32 v203, 0xffff0000, v61
    v_lshlrev_b32_e64 v204, 16, v62
    v_and_b32 v205, 0xffff0000, v62
    v_lshlrev_b32_e64 v206, 16, v63
    v_and_b32 v207, 0xffff0000, v63
    v_fma_f32 v200, v200, v229, v231
    v_fma_f32 v201, v201, v229, v231
    v_fma_f32 v202, v202, v229, v231
    v_fma_f32 v203, v203, v229, v231
    v_fma_f32 v204, v204, v229, v231
    v_fma_f32 v205, v205, v229, v231
    v_fma_f32 v206, v206, v229, v231
    v_fma_f32 v207, v207, v229, v231
    v_cvt_pk_bf16_f32 v60, v200, v201
    v_cvt_pk_bf16_f32 v61, v202, v203
    v_cvt_pk_bf16_f32 v62, v204, v205
    v_cvt_pk_bf16_f32 v63, v206, v207
    ds_write_b128 v222, v[60:63] offset:128
    s_mov_b32 s48, s8
    s_nop 0
    s_and_b32 s49, s9, 0xffff
    s_mov_b32 s50, 0x6200
    s_mov_b32 s51, 0x20000
    s_mov_b32 s67, 0x3fb8aa3b
    v_and_b32 v236, 31, v0
    v_lshrrev_b32 v237, 5, v0
    v_mov_b32 v240, 0x7fff0000
    v_subrev_u32 v238, 24, v236
    v_cmp_lt_u32 vcc, 27, v236
    s_nop 1
    v_cndmask_b32 v238, v236, v238, vcc
    v_lshlrev_b32_e64 v238, 1, v238
    v_mul_u32_u24 v239, 0xe0, v237
    v_add_u32_e64 v238, v238, v239
    s_mul_i32 s60, s27, 0x620
    v_add_u32 v238, s60, v238
    v_cmp_eq_u32 vcc, 1, v237
    s_nop 1
    v_cndmask_b32 v239, v238, v240, vcc
    buffer_load_ushort v16, v238, s[48:51], 0 offen offset:0
    buffer_load_ushort v17, v238, s[48:51], 0 offen offset:56
    buffer_load_ushort v18, v238, s[48:51], 0 offen offset:112
    buffer_load_ushort v19, v238, s[48:51], 0 offen offset:168
    buffer_load_ushort v20, v238, s[48:51], 0 offen offset:448
    buffer_load_ushort v21, v238, s[48:51], 0 offen offset:504
    buffer_load_ushort v22, v238, s[48:51], 0 offen offset:560
    buffer_load_ushort v23, v238, s[48:51], 0 offen offset:616
    buffer_load_ushort v24, v238, s[48:51], 0 offen offset:896
    buffer_load_ushort v25, v238, s[48:51], 0 offen offset:952
    buffer_load_ushort v26, v238, s[48:51], 0 offen offset:1008
    buffer_load_ushort v27, v238, s[48:51], 0 offen offset:1064
    buffer_load_ushort v28, v239, s[48:51], 0 offen offset:1344
    buffer_load_ushort v29, v239, s[48:51], 0 offen offset:1400
    buffer_load_ushort v30, v239, s[48:51], 0 offen offset:1456
    buffer_load_ushort v31, v239, s[48:51], 0 offen offset:1512
    v_cmp_eq_u32 vcc, 0, v237
    s_nop 1
    v_cndmask_b32 v232, 0, 1.0, vcc
    s_waitcnt lgkmcnt(7)
    s_nop 0
    v_mfma_f32_32x32x16_bf16 v[64:79], v[160:163], v[184:187], v[64:79]
    ds_read_b128 v[192:195], v223 offset:17952
    ds_read_b64_tr_b16 v[172:173], v217 offset:20480
    ds_read_b64_tr_b16 v[174:175], v217 offset:21504
    s_waitcnt lgkmcnt(9)
    s_nop 0
    v_mfma_f32_32x32x16_bf16 v[80:95], v[160:163], v[188:191], v[80:95]
    ds_read_b128 v[196:199], v243 offset:17952
    ds_read_b64_tr_b16 v[176:177], v218 offset:18432
    ds_read_b64_tr_b16 v[178:179], v218 offset:18944
    s_waitcnt lgkmcnt(10)
    s_nop 0
    v_mfma_f32_32x32x16_bf16 v[96:111], v[164:167], v[184:187], v[96:111]
    ds_read_b64_tr_b16 v[180:181], v220 offset:18432
    ds_read_b64_tr_b16 v[182:183], v220 offset:18944
    s_waitcnt lgkmcnt(10)
    v_mfma_f32_32x32x16_bf16 v[112:127], v[184:187], v[168:171], v[112:127]
    s_waitcnt lgkmcnt(5)
    v_mfma_f32_32x32x16_bf16 v[64:79], v[172:175], v[192:195], v[64:79]
    ds_read_b128 v[184:187], v223 offset:19008
    ds_read_b64_tr_b16 v[160:161], v217 offset:32768
    ds_read_b64_tr_b16 v[162:163], v217 offset:33792
    s_waitcnt lgkmcnt(7)
    s_nop 0
    v_mfma_f32_32x32x16_bf16 v[80:95], v[172:175], v[196:199], v[80:95]
    ds_read_b128 v[188:191], v243 offset:19008
    ds_read_b64_tr_b16 v[164:165], v218 offset:20480
    ds_read_b64_tr_b16 v[166:167], v218 offset:20992
    s_waitcnt lgkmcnt(8)
    s_nop 0
    v_mfma_f32_32x32x16_bf16 v[96:111], v[176:179], v[192:195], v[96:111]
    ds_read_b64_tr_b16 v[168:169], v220 offset:20480
    ds_read_b64_tr_b16 v[170:171], v220 offset:20992
    s_waitcnt lgkmcnt(8)
    v_mfma_f32_32x32x16_bf16 v[112:127], v[192:195], v[180:183], v[112:127]
    s_waitcnt vmcnt(16)
    s_barrier
    s_mov_b32 s52, s22
    s_and_b32 s53, s23, 0xffff
    s_mov_b32 s54, 0x100
    s_mov_b32 s55, 0x20000
    v_lshlrev_b32_e64 v235, 2, v0
    buffer_load_dword v234, v235, s[52:55], 0 offen sc1
    s_waitcnt lgkmcnt(5)
    s_nop 0
    v_mfma_f32_32x32x16_bf16 v[64:79], v[160:163], v[184:187], v[64:79]
    ds_read_b128 v[192:195], v223 offset:20064
    ds_read_b64_tr_b16 v[172:173], v217 offset:36864
    ds_read_b64_tr_b16 v[174:175], v217 offset:37888
    s_waitcnt lgkmcnt(7)
    s_nop 0
    v_mfma_f32_32x32x16_bf16 v[80:95], v[160:163], v[188:191], v[80:95]
    ds_read_b128 v[196:199], v243 offset:20064
    ds_read_b64_tr_b16 v[176:177], v218 offset:22528
    ds_read_b64_tr_b16 v[178:179], v218 offset:23040
    s_waitcnt lgkmcnt(8)
    s_nop 0
    v_mfma_f32_32x32x16_bf16 v[96:111], v[164:167], v[184:187], v[96:111]
    ds_read_b64_tr_b16 v[180:181], v220 offset:22528
    ds_read_b64_tr_b16 v[182:183], v220 offset:23040
    s_waitcnt lgkmcnt(8)
    v_mfma_f32_32x32x16_bf16 v[112:127], v[184:187], v[168:171], v[112:127]
    s_waitcnt lgkmcnt(5)
    v_mfma_f32_32x32x16_bf16 v[64:79], v[172:175], v[192:195], v[64:79]
    ds_read_b128 v[184:187], v223 offset:0
    ds_read_b64_tr_b16 v[160:161], v216 offset:0
    ds_read_b64_tr_b16 v[162:163], v216 offset:1024
    s_waitcnt lgkmcnt(7)
    s_nop 0
    v_mfma_f32_32x32x16_bf16 v[80:95], v[172:175], v[196:199], v[80:95]
    ds_read_b128 v[188:191], v243 offset:0
    ds_read_b64_tr_b16 v[164:165], v218 offset:0
    ds_read_b64_tr_b16 v[166:167], v218 offset:512
    s_waitcnt lgkmcnt(8)
    s_nop 0
    v_mfma_f32_32x32x16_bf16 v[96:111], v[176:179], v[192:195], v[96:111]
    ds_read_b64_tr_b16 v[168:169], v220 offset:0
    ds_read_b64_tr_b16 v[170:171], v220 offset:512
    s_waitcnt lgkmcnt(8)
    v_mfma_f32_32x32x16_bf16 v[112:127], v[192:195], v[180:183], v[112:127]
    s_barrier
    v_cmp_eq_u32 s[68:69], 28, v236
    v_lshlrev_b32 v238, 2, v237
    v_sub_u32 v238, v236, v238
    v_and_b32 v239, 1, v238
    v_lshlrev_b32 v239, 4, v239
    v_mov_b32 v240, 0x3f80
    v_lshlrev_b32 v239, v239, v240
    v_lshrrev_b32 v238, 1, v238
    v_cmp_eq_u32 vcc, 0, v238
    s_nop 1
    v_cndmask_b32 v32, 0, v239, vcc
    v_cmp_eq_u32 vcc, 1, v238
    s_nop 1
    v_cndmask_b32 v33, 0, v239, vcc
    v_cmp_eq_u32 vcc, 4, v238
    s_nop 1
    v_cndmask_b32 v34, 0, v239, vcc
    v_cmp_eq_u32 vcc, 5, v238
    s_nop 1
    v_cndmask_b32 v35, 0, v239, vcc
    v_cmp_eq_u32 vcc, 8, v238
    s_nop 1
    v_cndmask_b32 v36, 0, v239, vcc
    v_cmp_eq_u32 vcc, 9, v238
    s_nop 1
    v_cndmask_b32 v37, 0, v239, vcc
    v_cmp_eq_u32 vcc, 12, v238
    s_nop 1
    v_cndmask_b32 v38, 0, v239, vcc
    v_cmp_eq_u32 vcc, 13, v238
    s_nop 1
    v_cndmask_b32 v39, 0, v239, vcc
    v_mov_b32_e64 v208, 0
    v_mov_b32 v209, 0x26000
    ds_write_b32 v209, v208
    s_waitcnt lgkmcnt(6)
    s_nop 0
    v_mfma_f32_32x32x16_bf16 v[64:79], v[160:163], v[184:187], v[64:79]
    ds_read_b128 v[192:195], v223 offset:1056
    ds_read_b64_tr_b16 v[172:173], v216 offset:4096
    ds_read_b64_tr_b16 v[174:175], v216 offset:5120
    s_waitcnt lgkmcnt(8)
    s_nop 0
    v_mfma_f32_32x32x16_bf16 v[80:95], v[160:163], v[188:191], v[80:95]
    ds_read_b128 v[196:199], v243 offset:1056
    ds_read_b64_tr_b16 v[176:177], v218 offset:2048
    ds_read_b64_tr_b16 v[178:179], v218 offset:2560
    s_waitcnt lgkmcnt(9)
    s_nop 0
    v_mfma_f32_32x32x16_bf16 v[96:111], v[164:167], v[184:187], v[96:111]
    ds_read_b64_tr_b16 v[180:181], v220 offset:2048
    ds_read_b64_tr_b16 v[182:183], v220 offset:2560
    s_waitcnt lgkmcnt(9)
    v_mfma_f32_32x32x16_bf16 v[112:127], v[184:187], v[168:171], v[112:127]
    s_waitcnt lgkmcnt(5)
    v_mfma_f32_32x32x16_bf16 v[64:79], v[172:175], v[192:195], v[64:79]
    ds_read_b128 v[184:187], v223 offset:2112
    ds_read_b64_tr_b16 v[160:161], v216 offset:16384
    ds_read_b64_tr_b16 v[162:163], v216 offset:17408
    s_waitcnt lgkmcnt(7)
    s_nop 0
    v_mfma_f32_32x32x16_bf16 v[80:95], v[172:175], v[196:199], v[80:95]
    ds_read_b128 v[188:191], v243 offset:2112
    ds_read_b64_tr_b16 v[164:165], v218 offset:4096
    ds_read_b64_tr_b16 v[166:167], v218 offset:4608
    s_waitcnt lgkmcnt(8)
    s_nop 0
    v_mfma_f32_32x32x16_bf16 v[96:111], v[176:179], v[192:195], v[96:111]
    ds_read_b64_tr_b16 v[168:169], v220 offset:4096
    ds_read_b64_tr_b16 v[170:171], v220 offset:4608
    s_waitcnt lgkmcnt(8)
    v_mfma_f32_32x32x16_bf16 v[112:127], v[192:195], v[180:183], v[112:127]
    s_barrier
    s_waitcnt vmcnt(15)
    v_lshl_or_b32 v244, v17, 16, v16
    s_waitcnt vmcnt(13)
    v_lshl_or_b32 v245, v19, 16, v18
    s_waitcnt vmcnt(11)
    v_lshl_or_b32 v246, v21, 16, v20
    s_waitcnt vmcnt(9)
    v_lshl_or_b32 v247, v23, 16, v22
    s_waitcnt vmcnt(7)
    v_lshl_or_b32 v248, v25, 16, v24
    s_waitcnt vmcnt(5)
    v_lshl_or_b32 v249, v27, 16, v26
    s_waitcnt vmcnt(3)
    v_lshl_or_b32 v250, v29, 16, v28
    s_waitcnt vmcnt(1)
    v_lshl_or_b32 v251, v31, 16, v30
    s_waitcnt lgkmcnt(5)
    s_nop 0
    v_mfma_f32_32x32x16_bf16 v[64:79], v[160:163], v[184:187], v[64:79]
    ds_read_b128 v[192:195], v223 offset:3168
    ds_read_b64_tr_b16 v[172:173], v216 offset:20480
    ds_read_b64_tr_b16 v[174:175], v216 offset:21504
    s_waitcnt lgkmcnt(7)
    s_nop 0
    v_mfma_f32_32x32x16_bf16 v[80:95], v[160:163], v[188:191], v[80:95]
    ds_read_b128 v[196:199], v243 offset:3168
    ds_read_b64_tr_b16 v[176:177], v218 offset:6144
    ds_read_b64_tr_b16 v[178:179], v218 offset:6656
    s_waitcnt lgkmcnt(8)
    s_nop 0
    v_mfma_f32_32x32x16_bf16 v[96:111], v[164:167], v[184:187], v[96:111]
    ds_read_b64_tr_b16 v[180:181], v220 offset:6144
    ds_read_b64_tr_b16 v[182:183], v220 offset:6656
    s_waitcnt lgkmcnt(8)
    v_mfma_f32_32x32x16_bf16 v[112:127], v[184:187], v[168:171], v[112:127]
    s_waitcnt lgkmcnt(5)
    v_mfma_f32_32x32x16_bf16 v[64:79], v[172:175], v[192:195], v[64:79]
    s_waitcnt lgkmcnt(4)
    v_mfma_f32_32x32x16_bf16 v[80:95], v[172:175], v[196:199], v[80:95]
    s_waitcnt lgkmcnt(2)
    v_mfma_f32_32x32x16_bf16 v[96:111], v[176:179], v[192:195], v[96:111]
    s_waitcnt lgkmcnt(0)
    v_mfma_f32_32x32x16_bf16 v[112:127], v[192:195], v[180:183], v[112:127]
    s_barrier
    s_waitcnt vmcnt(0)
    v_mov_b32 v234, v234
    v_cmp_ne_u32 vcc, 1, v234
    s_nop 4
    s_cbranch_vccz SP_Z_F1_OK
    s_mov_b32 s61, 0
SP_Z_F1:
    buffer_load_dword v234, v235, s[52:55], 0 offen sc1
    s_add_u32 s61, s61, 1
    s_cmp_gt_u32 s61, 0x20000
    s_cbranch_scc1 SP_Z_F1_OK
    s_waitcnt vmcnt(0)
    v_cmp_ne_u32 vcc, 1, v234
    s_nop 4
    s_cbranch_vccz SP_Z_F1_OK
    s_sleep 4
    s_branch SP_Z_F1
SP_Z_F1_OK:
    v_mov_b32 v56, 0xbdd2d3e8
    v_mov_b32 v57, 0xc0135761
    v_mov_b32_e64 v241, 1
    v_mov_b32 v240, 0x7fff0000
    v_cmp_eq_u32 vcc, 0, v0
    s_nop 1
    v_cndmask_b32 v242, v240, 0, vcc
    s_setprio 3
    s_nop 0
    v_pk_mul_f32 v[40:41], v[64:65], v[64:65]
    v_pk_mul_f32 v[42:43], v[66:67], v[66:67]
    v_pk_mul_f32 v[44:45], v[68:69], v[68:69]
    v_pk_mul_f32 v[46:47], v[70:71], v[70:71]
    v_pk_fma_f32 v[40:41], v[40:41], v[56:57], v[56:57] op_sel:[0,0,1] op_sel_hi:[1,0,1]
    v_pk_fma_f32 v[42:43], v[42:43], v[56:57], v[56:57] op_sel:[0,0,1] op_sel_hi:[1,0,1]
    v_pk_fma_f32 v[44:45], v[44:45], v[56:57], v[56:57] op_sel:[0,0,1] op_sel_hi:[1,0,1]
    v_pk_fma_f32 v[46:47], v[46:47], v[56:57], v[56:57] op_sel:[0,0,1] op_sel_hi:[1,0,1]
    v_pk_mul_f32 v[40:41], v[40:41], v[64:65]
    v_pk_mul_f32 v[42:43], v[42:43], v[66:67]
    v_pk_mul_f32 v[44:45], v[44:45], v[68:69]
    v_pk_mul_f32 v[46:47], v[46:47], v[70:71]
    v_exp_f32 v40, v40
    v_exp_f32 v41, v41
    v_pk_mul_f32 v[72:73], v[64:65], v[72:73]
    v_exp_f32 v42, v42
    v_exp_f32 v43, v43
    v_pk_mul_f32 v[74:75], v[66:67], v[74:75]
    v_exp_f32 v44, v44
    v_exp_f32 v45, v45
    v_pk_mul_f32 v[76:77], v[68:69], v[76:77]
    v_exp_f32 v46, v46
    v_exp_f32 v47, v47
    v_pk_mul_f32 v[78:79], v[70:71], v[78:79]
    v_pk_add_f32 v[40:41], v[40:41], 1.0 op_sel_hi:[1,0]
    v_pk_add_f32 v[42:43], v[42:43], 1.0 op_sel_hi:[1,0]
    v_pk_add_f32 v[44:45], v[44:45], 1.0 op_sel_hi:[1,0]
    v_pk_add_f32 v[46:47], v[46:47], 1.0 op_sel_hi:[1,0]
    v_rcp_f32 v40, v40
    v_rcp_f32 v41, v41
    v_rcp_f32 v42, v42
    v_rcp_f32 v43, v43
    v_rcp_f32 v44, v44
    v_rcp_f32 v45, v45
    v_rcp_f32 v46, v46
    v_rcp_f32 v47, v47
    v_pk_mul_f32 v[40:41], v[40:41], v[72:73]
    v_pk_mul_f32 v[42:43], v[42:43], v[74:75]
    v_pk_mul_f32 v[44:45], v[44:45], v[76:77]
    v_pk_mul_f32 v[46:47], v[46:47], v[78:79]
    v_cvt_pk_bf16_f32 v160, v40, v41
    v_cvt_pk_bf16_f32 v161, v42, v43
    v_cvt_pk_bf16_f32 v162, v44, v45
    v_cvt_pk_bf16_f32 v163, v46, v47
    buffer_store_dwordx4 v[160:163], v227, s[44:47], s70 offen offset:0 sc1
    v_pk_mul_f32 v[48:49], v[80:81], v[80:81]
    v_pk_mul_f32 v[50:51], v[82:83], v[82:83]
    v_pk_mul_f32 v[52:53], v[84:85], v[84:85]
    v_pk_mul_f32 v[54:55], v[86:87], v[86:87]
    v_pk_fma_f32 v[48:49], v[48:49], v[56:57], v[56:57] op_sel:[0,0,1] op_sel_hi:[1,0,1]
    v_pk_fma_f32 v[50:51], v[50:51], v[56:57], v[56:57] op_sel:[0,0,1] op_sel_hi:[1,0,1]
    v_pk_fma_f32 v[52:53], v[52:53], v[56:57], v[56:57] op_sel:[0,0,1] op_sel_hi:[1,0,1]
    v_pk_fma_f32 v[54:55], v[54:55], v[56:57], v[56:57] op_sel:[0,0,1] op_sel_hi:[1,0,1]
    v_pk_mul_f32 v[48:49], v[48:49], v[80:81]
    v_pk_mul_f32 v[50:51], v[50:51], v[82:83]
    v_pk_mul_f32 v[52:53], v[52:53], v[84:85]
    v_pk_mul_f32 v[54:55], v[54:55], v[86:87]
    v_exp_f32 v48, v48
    v_exp_f32 v49, v49
    v_pk_mul_f32 v[88:89], v[80:81], v[88:89]
    v_exp_f32 v50, v50
    v_exp_f32 v51, v51
    v_pk_mul_f32 v[90:91], v[82:83], v[90:91]
    v_exp_f32 v52, v52
    v_exp_f32 v53, v53
    v_pk_mul_f32 v[92:93], v[84:85], v[92:93]
    v_exp_f32 v54, v54
    v_exp_f32 v55, v55
    v_pk_mul_f32 v[94:95], v[86:87], v[94:95]
    v_pk_add_f32 v[48:49], v[48:49], 1.0 op_sel_hi:[1,0]
    v_pk_add_f32 v[50:51], v[50:51], 1.0 op_sel_hi:[1,0]
    v_pk_add_f32 v[52:53], v[52:53], 1.0 op_sel_hi:[1,0]
    v_pk_add_f32 v[54:55], v[54:55], 1.0 op_sel_hi:[1,0]
    v_rcp_f32 v48, v48
    v_rcp_f32 v49, v49
    v_rcp_f32 v50, v50
    v_rcp_f32 v51, v51
    v_rcp_f32 v52, v52
    v_rcp_f32 v53, v53
    v_rcp_f32 v54, v54
    v_rcp_f32 v55, v55
    v_pk_mul_f32 v[48:49], v[48:49], v[88:89]
    v_pk_mul_f32 v[50:51], v[50:51], v[90:91]
    v_pk_mul_f32 v[52:53], v[52:53], v[92:93]
    v_pk_mul_f32 v[54:55], v[54:55], v[94:95]
    v_cvt_pk_bf16_f32 v164, v48, v49
    v_cvt_pk_bf16_f32 v165, v50, v51
    v_cvt_pk_bf16_f32 v166, v52, v53
    v_cvt_pk_bf16_f32 v167, v54, v55
    buffer_store_dwordx4 v[164:167], v227, s[44:47], s59 offen offset:0 sc1
    s_setprio 0
    s_nop 0
    v_cvt_pk_bf16_f32 v200, v96, v97
    v_cvt_pk_bf16_f32 v201, v98, v99
    v_cvt_pk_bf16_f32 v202, v100, v101
    v_cvt_pk_bf16_f32 v203, v102, v103
    v_cvt_pk_bf16_f32 v204, v104, v105
    v_cvt_pk_bf16_f32 v205, v106, v107
    v_cvt_pk_bf16_f32 v206, v108, v109
    v_cvt_pk_bf16_f32 v207, v110, v111
    v_mfma_f32_32x32x16_bf16 v[128:143], v[244:247], v[200:203], 0
    s_nop 0
    s_nop 0
    v_mfma_f32_32x32x16_bf16 v[128:143], v[248:251], v[204:207], v[128:143]
    v_mov_b32 v238, 0x3f803f80
    v_cvt_pk_bf16_f32 v144, v112, v113
    v_cvt_pk_bf16_f32 v145, v114, v115
    v_cvt_pk_bf16_f32 v146, v116, v117
    v_cvt_pk_bf16_f32 v147, v118, v119
    v_cvt_pk_bf16_f32 v148, v120, v121
    v_cvt_pk_bf16_f32 v149, v122, v123
    v_cvt_pk_bf16_f32 v150, v124, v125
    v_cvt_pk_bf16_f32 v151, v126, v127
    v_cndmask_b32 v144, v144, v238, s[68:69]
    v_cndmask_b32 v145, v145, v238, s[68:69]
    v_cndmask_b32 v146, v146, v238, s[68:69]
    v_cndmask_b32 v147, v147, v238, s[68:69]
    v_cndmask_b32 v148, v148, v238, s[68:69]
    v_cndmask_b32 v149, v149, v238, s[68:69]
    v_cndmask_b32 v150, v150, v238, s[68:69]
    v_cndmask_b32 v151, v151, v238, s[68:69]
    s_lshl_b32 s60, s26, 1
    s_and_b32 s61, s3, 1
    s_add_u32 s60, s60, s61
    s_lshl_b32 s60, s60, 8
    s_lshl_b32 s61, s27, 2
    s_lshr_b32 s62, s3, 1
    s_add_u32 s61, s61, s62
    s_lshl_b32 s61, s61, 2
    s_add_u32 s60, s60, s61
    s_add_u32 s60, s60, 0x1100000
    s_waitcnt vmcnt(0)
    buffer_store_dword v241, v242, s[44:47], s60 offen sc1
    v_max3_f32 v208, v128, v129, v130
    v_min3_f32 v209, v128, v129, v130
    v_max3_f32 v208, v208, v131, v132
    v_min3_f32 v209, v209, v131, v132
    v_max3_f32 v208, v208, v133, v134
    v_min3_f32 v209, v209, v133, v134
    v_max3_f32 v208, v208, v135, v136
    v_min3_f32 v209, v209, v135, v136
    v_max3_f32 v208, v208, v137, v138
    v_min3_f32 v209, v209, v137, v138
    v_max3_f32 v208, v208, v139, v140
    v_min3_f32 v209, v209, v139, v140
    v_max3_f32 v208, v208, v141, v142
    v_min3_f32 v209, v209, v141, v142
    v_max_f32 v208, v208, v143
    v_min_f32 v209, v209, v143
    v_mov_b32 v210, v208
    v_mov_b32 v211, v209
    s_nop 0
    v_permlane32_swap_b32 v208, v210
    v_permlane32_swap_b32 v209, v211
    v_max_f32 v208, v208, v210
    v_min_f32 v209, v209, v211
    v_mul_f32 v208, s67, v208
    v_mul_f32 v209, s67, v209
    v_mov_b32 v210, s67
    v_pk_fma_f32 v[96:97], v[128:129], v[210:211], v[208:209] op_sel:[0,0,1] op_sel_hi:[1,0,1] neg_lo:[1,0,0] neg_hi:[1,0,0]
    v_pk_fma_f32 v[98:99], v[130:131], v[210:211], v[208:209] op_sel:[0,0,1] op_sel_hi:[1,0,1] neg_lo:[1,0,0] neg_hi:[1,0,0]
    v_pk_fma_f32 v[100:101], v[132:133], v[210:211], v[208:209] op_sel:[0,0,1] op_sel_hi:[1,0,1] neg_lo:[1,0,0] neg_hi:[1,0,0]
    v_pk_fma_f32 v[102:103], v[134:135], v[210:211], v[208:209] op_sel:[0,0,1] op_sel_hi:[1,0,1] neg_lo:[1,0,0] neg_hi:[1,0,0]
    v_pk_fma_f32 v[104:105], v[136:137], v[210:211], v[208:209] op_sel:[0,0,1] op_sel_hi:[1,0,1] neg_lo:[1,0,0] neg_hi:[1,0,0]
    v_pk_fma_f32 v[106:107], v[138:139], v[210:211], v[208:209] op_sel:[0,0,1] op_sel_hi:[1,0,1] neg_lo:[1,0,0] neg_hi:[1,0,0]
    v_pk_fma_f32 v[108:109], v[140:141], v[210:211], v[208:209] op_sel:[0,0,1] op_sel_hi:[1,0,1] neg_lo:[1,0,0] neg_hi:[1,0,0]
    v_pk_fma_f32 v[110:111], v[142:143], v[210:211], v[208:209] op_sel:[0,0,1] op_sel_hi:[1,0,1] neg_lo:[1,0,0] neg_hi:[1,0,0]
    v_pk_fma_f32 v[128:129], v[128:129], v[210:211], v[208:209] op_sel_hi:[1,0,0] neg_lo:[0,0,1] neg_hi:[0,0,1]
    v_pk_fma_f32 v[130:131], v[130:131], v[210:211], v[208:209] op_sel_hi:[1,0,0] neg_lo:[0,0,1] neg_hi:[0,0,1]
    v_pk_fma_f32 v[132:133], v[132:133], v[210:211], v[208:209] op_sel_hi:[1,0,0] neg_lo:[0,0,1] neg_hi:[0,0,1]
    v_pk_fma_f32 v[134:135], v[134:135], v[210:211], v[208:209] op_sel_hi:[1,0,0] neg_lo:[0,0,1] neg_hi:[0,0,1]
    v_pk_fma_f32 v[136:137], v[136:137], v[210:211], v[208:209] op_sel_hi:[1,0,0] neg_lo:[0,0,1] neg_hi:[0,0,1]
    v_pk_fma_f32 v[138:139], v[138:139], v[210:211], v[208:209] op_sel_hi:[1,0,0] neg_lo:[0,0,1] neg_hi:[0,0,1]
    v_pk_fma_f32 v[140:141], v[140:141], v[210:211], v[208:209] op_sel_hi:[1,0,0] neg_lo:[0,0,1] neg_hi:[0,0,1]
    v_pk_fma_f32 v[142:143], v[142:143], v[210:211], v[208:209] op_sel_hi:[1,0,0] neg_lo:[0,0,1] neg_hi:[0,0,1]
    v_exp_f32 v96, v96
    v_exp_f32 v97, v97
    v_exp_f32 v98, v98
    v_exp_f32 v99, v99
    v_exp_f32 v100, v100
    v_exp_f32 v101, v101
    v_exp_f32 v102, v102
    v_exp_f32 v103, v103
    v_exp_f32 v104, v104
    v_exp_f32 v105, v105
    v_exp_f32 v106, v106
    v_exp_f32 v107, v107
    v_exp_f32 v108, v108
    v_exp_f32 v109, v109
    v_exp_f32 v110, v110
    v_exp_f32 v111, v111
    v_exp_f32 v128, v128
    v_exp_f32 v129, v129
    v_exp_f32 v130, v130
    v_exp_f32 v131, v131
    v_exp_f32 v132, v132
    v_exp_f32 v133, v133
    v_exp_f32 v134, v134
    v_exp_f32 v135, v135
    v_exp_f32 v136, v136
    v_exp_f32 v137, v137
    v_exp_f32 v138, v138
    v_exp_f32 v139, v139
    v_exp_f32 v140, v140
    v_exp_f32 v141, v141
    v_exp_f32 v142, v142
    v_exp_f32 v143, v143
    v_add_f32 v213, v96, v97
    v_add_f32 v215, v98, v99
    v_add_f32 v212, v128, v129
    v_add_f32 v214, v130, v131
    v_add_f32 v213, v213, v100
    v_add_f32 v215, v215, v101
    v_add_f32 v212, v212, v132
    v_add_f32 v214, v214, v133
    v_add_f32 v213, v213, v102
    v_add_f32 v215, v215, v103
    v_add_f32 v212, v212, v134
    v_add_f32 v214, v214, v135
    v_add_f32 v213, v213, v104
    v_add_f32 v215, v215, v105
    v_add_f32 v212, v212, v136
    v_add_f32 v214, v214, v137
    v_add_f32 v213, v213, v106
    v_add_f32 v215, v215, v107
    v_add_f32 v212, v212, v138
    v_add_f32 v214, v214, v139
    v_fmac_f32 v213, v108, v232
    v_fmac_f32 v215, v109, v232
    v_fmac_f32 v212, v140, v232
    v_fmac_f32 v214, v141, v232
    v_fmac_f32 v213, v110, v232
    v_fmac_f32 v215, v111, v232
    v_fmac_f32 v212, v142, v232
    v_fmac_f32 v214, v143, v232
    v_add_f32 v212, v212, v214
    v_add_f32 v213, v213, v215
    v_mov_b32 v210, v212
    v_mov_b32 v211, v213
    s_nop 0
    v_permlane32_swap_b32 v212, v210
    v_permlane32_swap_b32 v213, v211
    v_add_f32 v212, v212, v210
    v_add_f32 v213, v213, v211
    v_rcp_f32 v212, v212
    v_rcp_f32 v213, v213
    s_nop 0
    v_pk_mul_f32 v[128:129], v[128:129], v[212:213] op_sel_hi:[1,0]
    v_pk_mul_f32 v[130:131], v[130:131], v[212:213] op_sel_hi:[1,0]
    v_pk_mul_f32 v[132:133], v[132:133], v[212:213] op_sel_hi:[1,0]
    v_pk_mul_f32 v[134:135], v[134:135], v[212:213] op_sel_hi:[1,0]
    v_pk_mul_f32 v[136:137], v[136:137], v[212:213] op_sel_hi:[1,0]
    v_pk_mul_f32 v[138:139], v[138:139], v[212:213] op_sel_hi:[1,0]
    v_pk_mul_f32 v[140:141], v[140:141], v[212:213] op_sel_hi:[1,0]
    v_pk_mul_f32 v[142:143], v[142:143], v[212:213] op_sel_hi:[1,0]
    v_pk_mul_f32 v[96:97], v[96:97], v[212:213] op_sel:[0,1] op_sel_hi:[1,1]
    v_pk_mul_f32 v[98:99], v[98:99], v[212:213] op_sel:[0,1] op_sel_hi:[1,1]
    v_pk_mul_f32 v[100:101], v[100:101], v[212:213] op_sel:[0,1] op_sel_hi:[1,1]
    v_pk_mul_f32 v[102:103], v[102:103], v[212:213] op_sel:[0,1] op_sel_hi:[1,1]
    v_pk_mul_f32 v[104:105], v[104:105], v[212:213] op_sel:[0,1] op_sel_hi:[1,1]
    v_pk_mul_f32 v[106:107], v[106:107], v[212:213] op_sel:[0,1] op_sel_hi:[1,1]
    v_pk_mul_f32 v[108:109], v[108:109], v[212:213] op_sel:[0,1] op_sel_hi:[1,1]
    v_pk_mul_f32 v[110:111], v[110:111], v[212:213] op_sel:[0,1] op_sel_hi:[1,1]
    v_cvt_pk_bf16_f32 v200, v128, v129
    v_cvt_pk_bf16_f32 v201, v130, v131
    v_cvt_pk_bf16_f32 v202, v132, v133
    v_cvt_pk_bf16_f32 v203, v134, v135
    v_cvt_pk_bf16_f32 v204, v136, v137
    v_cvt_pk_bf16_f32 v205, v138, v139
    v_cvt_pk_bf16_f32 v206, v140, v141
    v_cvt_pk_bf16_f32 v207, v142, v143
    v_cvt_pk_bf16_f32 v152, v96, v97
    v_cvt_pk_bf16_f32 v153, v98, v99
    v_cvt_pk_bf16_f32 v154, v100, v101
    v_cvt_pk_bf16_f32 v155, v102, v103
    v_cvt_pk_bf16_f32 v156, v104, v105
    v_cvt_pk_bf16_f32 v157, v106, v107
    v_cvt_pk_bf16_f32 v158, v108, v109
    v_cvt_pk_bf16_f32 v159, v110, v111
    v_mfma_f32_32x32x16_bf16 v[96:111], v[200:203], v[32:35], 0
    v_mfma_f32_32x32x16_bf16 v[96:111], v[204:207], v[36:39], v[96:111]
    v_mfma_f32_32x32x16_bf16 v[128:143], v[152:155], v[32:35], 0
    v_mfma_f32_32x32x16_bf16 v[128:143], v[156:159], v[36:39], v[128:143]
    s_setprio 3
    v_lshlrev_b32 v239, 2, v0
    s_nop 7
    s_nop 0
    v_cvt_pk_bf16_f32 v200, v96, v97
    v_cvt_pk_bf16_f32 v201, v98, v99
    v_cvt_pk_bf16_f32 v202, v100, v101
    v_cvt_pk_bf16_f32 v203, v102, v103
    v_cvt_pk_bf16_f32 v204, v104, v105
    v_cvt_pk_bf16_f32 v205, v106, v107
    v_cvt_pk_bf16_f32 v206, v108, v109
    v_cvt_pk_bf16_f32 v207, v110, v111
    v_cvt_pk_bf16_f32 v208, v128, v129
    v_cvt_pk_bf16_f32 v209, v130, v131
    v_cvt_pk_bf16_f32 v210, v132, v133
    v_cvt_pk_bf16_f32 v211, v134, v135
    v_cvt_pk_bf16_f32 v212, v136, v137
    v_cvt_pk_bf16_f32 v213, v138, v139
    v_cvt_pk_bf16_f32 v214, v140, v141
    v_cvt_pk_bf16_f32 v215, v142, v143
    v_mfma_f32_32x32x16_bf16 v[96:111], v[200:203], v[144:147], 0
    v_mfma_f32_32x32x16_bf16 v[96:111], v[204:207], v[148:151], v[96:111]
    v_mfma_f32_32x32x16_bf16 v[128:143], v[208:211], v[144:147], 0
    v_mfma_f32_32x32x16_bf16 v[128:143], v[212:215], v[148:151], v[128:143]
    s_lshl_b32 s60, s3, 13
    s_add_u32 s60, s60, 0x16000
    v_add_u32 v238, s60, v227
    v_mov_b32 v1, 0x26000
    v_mov_b32 v2, 1
    s_nop 4
    ds_write_b128 v238, v[96:99] offset:0
    ds_write_b128 v238, v[100:103] offset:1024
    ds_write_b128 v238, v[104:107] offset:2048
    ds_write_b128 v238, v[108:111] offset:3072
    ds_write_b128 v238, v[128:131] offset:4096
    ds_write_b128 v238, v[132:135] offset:5120
    ds_write_b128 v238, v[136:139] offset:6144
    ds_write_b128 v238, v[140:143] offset:7168
    s_waitcnt lgkmcnt(0)
    s_mov_b64 exec, 1
    ds_add_u32 v1, v2
    s_mov_b64 exec, -1
    s_mov_b32 s61, 0
K1_F_LSPIN:
    ds_read_b32 v3, v1
    s_add_u32 s61, s61, 1
    s_lshr_b32 s62, s61, 18
    s_waitcnt lgkmcnt(0)
    s_nop 1
    v_readfirstlane_b32 s60, v3
    s_nop 3
    s_or_b32 s60, s60, s62
    s_cmp_lt_u32 s60, 4
    s_cbranch_scc1 K1_F_LSPIN
    s_lshl_b32 s60, s3, 11
    s_sub_u32 s60, s60, 0x2000
    s_add_u32 s77, s73, s60
    s_add_u32 s60, s60, 0x1e000
    v_add_u32 v1, s60, v239
    ds_read2st64_b32 v[128:129], v1 offset0:0 offset1:32
    ds_read2st64_b32 v[130:131], v1 offset0:64 offset1:96
    ds_read2st64_b32 v[132:133], v1 offset0:1 offset1:33
    ds_read2st64_b32 v[134:135], v1 offset0:65 offset1:97
    ds_read2st64_b32 v[136:137], v1 offset0:2 offset1:34
    ds_read2st64_b32 v[138:139], v1 offset0:66 offset1:98
    ds_read2st64_b32 v[140:141], v1 offset0:3 offset1:35
    ds_read2st64_b32 v[142:143], v1 offset0:67 offset1:99
    ds_read2st64_b32 v[144:145], v1 offset0:4 offset1:36
    ds_read2st64_b32 v[146:147], v1 offset0:68 offset1:100
    ds_read2st64_b32 v[148:149], v1 offset0:5 offset1:37
    ds_read2st64_b32 v[150:151], v1 offset0:69 offset1:101
    ds_read2st64_b32 v[152:153], v1 offset0:6 offset1:38
    ds_read2st64_b32 v[154:155], v1 offset0:70 offset1:102
    ds_read2st64_b32 v[156:157], v1 offset0:7 offset1:39
    ds_read2st64_b32 v[158:159], v1 offset0:71 offset1:103
    s_waitcnt lgkmcnt(15)
    v_add_f32 v128, v128, v129
    s_waitcnt lgkmcnt(14)
    v_add_f32 v130, v130, v131
    v_add_f32_e64 v128, v128, v130
    buffer_atomic_add_f32 v128, v239, s[44:47], s77 offen offset:0
    s_waitcnt lgkmcnt(13)
    v_add_f32 v132, v132, v133
    s_waitcnt lgkmcnt(12)
    v_add_f32 v134, v134, v135
    v_add_f32_e64 v132, v132, v134
    buffer_atomic_add_f32 v132, v239, s[44:47], s77 offen offset:256
    s_waitcnt lgkmcnt(11)
    v_add_f32 v136, v136, v137
    s_waitcnt lgkmcnt(10)
    v_add_f32 v138, v138, v139
    v_add_f32_e64 v136, v136, v138
    buffer_atomic_add_f32 v136, v239, s[44:47], s77 offen offset:512
    s_waitcnt lgkmcnt(9)
    v_add_f32 v140, v140, v141
    s_waitcnt lgkmcnt(8)
    v_add_f32 v142, v142, v143
    v_add_f32_e64 v140, v140, v142
    buffer_atomic_add_f32 v140, v239, s[44:47], s77 offen offset:768
    s_waitcnt lgkmcnt(7)
    v_add_f32 v144, v144, v145
    s_waitcnt lgkmcnt(6)
    v_add_f32 v146, v146, v147
    v_add_f32_e64 v144, v144, v146
    buffer_atomic_add_f32 v144, v239, s[44:47], s77 offen offset:1024
    s_waitcnt lgkmcnt(5)
    v_add_f32 v148, v148, v149
    s_waitcnt lgkmcnt(4)
    v_add_f32 v150, v150, v151
    v_add_f32_e64 v148, v148, v150
    buffer_atomic_add_f32 v148, v239, s[44:47], s77 offen offset:1280
    s_waitcnt lgkmcnt(3)
    v_add_f32 v152, v152, v153
    s_waitcnt lgkmcnt(2)
    v_add_f32 v154, v154, v155
    v_add_f32_e64 v152, v152, v154
    buffer_atomic_add_f32 v152, v239, s[44:47], s77 offen offset:1536
    s_waitcnt lgkmcnt(1)
    v_add_f32 v156, v156, v157
    s_waitcnt lgkmcnt(0)
    v_add_f32 v158, v158, v159
    v_add_f32_e64 v156, v156, v158
    buffer_atomic_add_f32 v156, v239, s[44:47], s77 offen offset:1792
    s_lshl_b32 s65, s26, 2
    s_add_u32 s65, s65, s3
    s_sub_u32 s65, s65, 4
    s_lshl_b32 s64, s27, 8
    s_add_u32 s64, s64, 0x1102000
    s_lshl_b32 s60, s65, 2
    s_add_u32 s60, s60, s64
    s_waitcnt vmcnt(0)
    buffer_store_dword v241, v242, s[44:47], s60 offen sc1
    s_lshr_b32 s66, s65, 1
    s_lshl_b32 s66, s66, 8
    s_lshr_b32 s60, s27, 3
    s_lshl_b32 s60, s60, 4
    s_add_u32 s66, s66, s60
    s_add_u32 s66, s66, 0x11000e0
    v_and_b32 v1, 12, v239
    s_mov_b32 s61, 0
SP_Q_F1:
    buffer_load_dword v2, v1, s[44:47], s66 offen sc1
    s_add_u32 s61, s61, 1
    s_cmp_gt_u32 s61, 0x20000
    s_cbranch_scc1 SP_Q_F1_OK
    s_waitcnt vmcnt(0)
    v_cmp_ne_u32 vcc, 1, v2
    s_nop 4
    s_cbranch_vccz SP_Q_F1_OK
    s_sleep 8
    s_branch SP_Q_F1
SP_Q_F1_OK:
    s_lshl_b32 s60, s65, 15
    s_lshl_b32 s61, s27, 11
    s_add_u32 s60, s60, s61
    s_nop 0
    s_add_u32 s60, s60, 0xc00000
    buffer_load_dwordx4 v[8:11], v227, s[44:47], s60 offen offset:0 sc1
    buffer_load_dwordx4 v[12:15], v227, s[44:47], s60 offen offset:1024 sc1
    s_waitcnt vmcnt(1)
    v_mfma_f32_32x32x16_bf16 v[96:111], v[244:247], v[8:11], 0
    s_waitcnt vmcnt(0)
    v_mfma_f32_32x32x16_bf16 v[96:111], v[248:251], v[12:15], v[96:111]
    s_nop 11
    s_nop 0
    v_max3_f32 v16, v96, v97, v98
    v_min3_f32 v17, v96, v97, v98
    v_max3_f32 v16, v16, v99, v100
    v_min3_f32 v17, v17, v99, v100
    v_max3_f32 v16, v16, v101, v102
    v_min3_f32 v17, v17, v101, v102
    v_max3_f32 v16, v16, v103, v104
    v_min3_f32 v17, v17, v103, v104
    v_max3_f32 v16, v16, v105, v106
    v_min3_f32 v17, v17, v105, v106
    v_max3_f32 v16, v16, v107, v108
    v_min3_f32 v17, v17, v107, v108
    v_max3_f32 v16, v16, v109, v110
    v_min3_f32 v17, v17, v109, v110
    v_max_f32 v16, v16, v111
    v_min_f32 v17, v17, v111
    v_mov_b32 v18, v16
    v_mov_b32 v19, v17
    s_nop 0
    v_permlane32_swap_b32 v16, v18
    v_permlane32_swap_b32 v17, v19
    v_max_f32 v16, v16, v18
    v_min_f32 v17, v17, v19
    v_mul_f32 v16, s67, v16
    v_mul_f32_e64 v17, s67, v17
    v_fma_f32 v112, -v96, s67, v17
    v_fma_f32 v113, -v97, s67, v17
    v_fma_f32 v114, -v98, s67, v17
    v_fma_f32 v115, -v99, s67, v17
    v_fma_f32 v116, -v100, s67, v17
    v_fma_f32 v117, -v101, s67, v17
    v_fma_f32 v118, -v102, s67, v17
    v_fma_f32 v119, -v103, s67, v17
    v_fma_f32 v120, -v104, s67, v17
    v_fma_f32 v121, -v105, s67, v17
    v_fma_f32 v122, -v106, s67, v17
    v_fma_f32 v123, -v107, s67, v17
    v_fma_f32 v124, -v108, s67, v17
    v_fma_f32 v125, -v109, s67, v17
    v_fma_f32 v126, -v110, s67, v17
    v_fma_f32 v127, -v111, s67, v17
    v_fma_f32 v96, v96, s67, -v16
    v_fma_f32 v97, v97, s67, -v16
    v_fma_f32 v98, v98, s67, -v16
    v_fma_f32 v99, v99, s67, -v16
    v_fma_f32 v100, v100, s67, -v16
    v_fma_f32 v101, v101, s67, -v16
    v_fma_f32 v102, v102, s67, -v16
    v_fma_f32 v103, v103, s67, -v16
    v_fma_f32 v104, v104, s67, -v16
    v_fma_f32 v105, v105, s67, -v16
    v_fma_f32 v106, v106, s67, -v16
    v_fma_f32 v107, v107, s67, -v16
    v_fma_f32 v108, v108, s67, -v16
    v_fma_f32 v109, v109, s67, -v16
    v_fma_f32 v110, v110, s67, -v16
    v_fma_f32 v111, v111, s67, -v16
    v_exp_f32 v112, v112
    v_exp_f32 v113, v113
    v_exp_f32 v114, v114
    v_exp_f32 v115, v115
    v_exp_f32 v116, v116
    v_exp_f32 v117, v117
    v_exp_f32 v118, v118
    v_exp_f32 v119, v119
    v_exp_f32 v120, v120
    v_exp_f32 v121, v121
    v_exp_f32 v122, v122
    v_exp_f32 v123, v123
    v_exp_f32 v124, v124
    v_exp_f32 v125, v125
    v_exp_f32 v126, v126
    v_exp_f32 v127, v127
    v_exp_f32 v96, v96
    v_exp_f32 v97, v97
    v_exp_f32 v98, v98
    v_exp_f32 v99, v99
    v_exp_f32 v100, v100
    v_exp_f32 v101, v101
    v_exp_f32 v102, v102
    v_exp_f32 v103, v103
    v_exp_f32 v104, v104
    v_exp_f32 v105, v105
    v_exp_f32 v106, v106
    v_exp_f32 v107, v107
    v_exp_f32 v108, v108
    v_exp_f32 v109, v109
    v_exp_f32 v110, v110
    v_exp_f32 v111, v111
    v_add_f32 v21, v112, v113
    v_add_f32 v23, v114, v115
    v_add_f32 v20, v96, v97
    v_add_f32 v22, v98, v99
    v_add_f32 v21, v21, v116
    v_add_f32 v23, v23, v117
    v_add_f32 v20, v20, v100
    v_add_f32 v22, v22, v101
    v_add_f32 v21, v21, v118
    v_add_f32 v23, v23, v119
    v_add_f32 v20, v20, v102
    v_add_f32 v22, v22, v103
    v_add_f32 v21, v21, v120
    v_add_f32 v23, v23, v121
    v_add_f32 v20, v20, v104
    v_add_f32 v22, v22, v105
    v_add_f32 v21, v21, v122
    v_add_f32 v23, v23, v123
    v_add_f32 v20, v20, v106
    v_add_f32 v22, v22, v107
    v_fmac_f32 v21, v124, v232
    v_fmac_f32 v23, v125, v232
    v_fmac_f32 v20, v108, v232
    v_fmac_f32 v22, v109, v232
    v_fmac_f32 v21, v126, v232
    v_fmac_f32 v23, v127, v232
    v_fmac_f32 v20, v110, v232
    v_fmac_f32 v22, v111, v232
    v_add_f32 v20, v20, v22
    v_add_f32 v21, v21, v23
    v_mov_b32 v18, v20
    v_mov_b32 v19, v21
    s_nop 0
    v_permlane32_swap_b32 v20, v18
    v_permlane32_swap_b32 v21, v19
    v_add_f32 v20, v20, v18
    v_add_f32 v21, v21, v19
    v_rcp_f32 v20, v20
    v_rcp_f32 v21, v21
    v_mul_f32 v96, v96, v20
    v_mul_f32 v97, v97, v20
    v_mul_f32 v98, v98, v20
    v_mul_f32 v99, v99, v20
    v_mul_f32 v100, v100, v20
    v_mul_f32 v101, v101, v20
    v_mul_f32 v102, v102, v20
    v_mul_f32 v103, v103, v20
    v_mul_f32 v104, v104, v20
    v_mul_f32 v105, v105, v20
    v_mul_f32 v106, v106, v20
    v_mul_f32 v107, v107, v20
    v_mul_f32 v108, v108, v20
    v_mul_f32 v109, v109, v20
    v_mul_f32 v110, v110, v20
    v_mul_f32 v111, v111, v20
    v_mul_f32 v112, v112, v21
    v_mul_f32 v113, v113, v21
    v_mul_f32 v114, v114, v21
    v_mul_f32 v115, v115, v21
    v_mul_f32 v116, v116, v21
    v_mul_f32 v117, v117, v21
    v_mul_f32 v118, v118, v21
    v_mul_f32 v119, v119, v21
    v_mul_f32 v120, v120, v21
    v_mul_f32 v121, v121, v21
    v_mul_f32 v122, v122, v21
    v_mul_f32 v123, v123, v21
    v_mul_f32 v124, v124, v21
    v_mul_f32 v125, v125, v21
    v_mul_f32 v126, v126, v21
    v_mul_f32_e64 v127, v127, v21
    v_cvt_pk_bf16_f32 v24, v96, v97
    v_cvt_pk_bf16_f32 v25, v98, v99
    v_cvt_pk_bf16_f32 v26, v100, v101
    v_cvt_pk_bf16_f32 v27, v102, v103
    v_cvt_pk_bf16_f32 v28, v104, v105
    v_cvt_pk_bf16_f32 v29, v106, v107
    v_cvt_pk_bf16_f32 v30, v108, v109
    v_cvt_pk_bf16_f32 v31, v110, v111
    v_cvt_pk_bf16_f32 v32, v112, v113
    v_cvt_pk_bf16_f32 v33, v114, v115
    v_cvt_pk_bf16_f32 v34, v116, v117
    v_cvt_pk_bf16_f32 v35, v118, v119
    v_cvt_pk_bf16_f32 v36, v120, v121
    v_cvt_pk_bf16_f32 v37, v122, v123
    v_cvt_pk_bf16_f32 v38, v124, v125
    v_cvt_pk_bf16_f32 v39, v126, v127
    s_mov_b32 s61, 0
SP_K_F1:
    buffer_load_dword v2, v239, s[44:47], s64 offen sc1
    s_add_u32 s61, s61, 1
    s_cmp_gt_u32 s61, 0x20000
    s_cbranch_scc1 SP_K_F1_OK
    s_waitcnt vmcnt(0)
    v_cmp_ne_u32 vcc, 1, v2
    s_nop 4
    s_cbranch_vccz SP_K_F1_OK
    s_sleep 8
    s_branch SP_K_F1
SP_K_F1_OK:
    s_nop 0
    s_add_u32 s61, s73, 0x1000
    buffer_load_dwordx4 v[64:67], v227, s[44:47], s73 offen offset:0 sc1
    buffer_load_dwordx4 v[68:71], v227, s[44:47], s73 offen offset:1024 sc1
    buffer_load_dwordx4 v[72:75], v227, s[44:47], s73 offen offset:2048 sc1
    buffer_load_dwordx4 v[76:79], v227, s[44:47], s73 offen offset:3072 sc1
    buffer_load_dwordx4 v[80:83], v227, s[44:47], s61 offen offset:0 sc1
    buffer_load_dwordx4 v[84:87], v227, s[44:47], s61 offen offset:1024 sc1
    buffer_load_dwordx4 v[88:91], v227, s[44:47], s61 offen offset:2048 sc1
    buffer_load_dwordx4 v[92:95], v227, s[44:47], s61 offen offset:3072 sc1
    s_waitcnt vmcnt(4)
    v_mul_f32 v76, v76, v232
    v_mul_f32 v77, v77, v232
    v_mul_f32 v78, v78, v232
    v_mul_f32 v79, v79, v232
    s_waitcnt vmcnt(0)
    v_mul_f32 v92, v92, v232
    v_mul_f32 v93, v93, v232
    v_mul_f32 v94, v94, v232
    v_mul_f32 v95, v95, v232
    v_cvt_pk_bf16_f32 v40, v64, v65
    v_cvt_pk_bf16_f32 v41, v66, v67
    v_cvt_pk_bf16_f32 v42, v68, v69
    v_cvt_pk_bf16_f32 v43, v70, v71
    v_cvt_pk_bf16_f32 v44, v72, v73
    v_cvt_pk_bf16_f32 v45, v74, v75
    v_cvt_pk_bf16_f32 v46, v76, v77
    v_cvt_pk_bf16_f32 v47, v78, v79
    v_cvt_pk_bf16_f32 v48, v80, v81
    v_cvt_pk_bf16_f32 v49, v82, v83
    v_cvt_pk_bf16_f32 v50, v84, v85
    v_cvt_pk_bf16_f32 v51, v86, v87
    v_cvt_pk_bf16_f32 v52, v88, v89
    v_cvt_pk_bf16_f32 v53, v90, v91
    v_cvt_pk_bf16_f32 v54, v92, v93
    v_cvt_pk_bf16_f32 v55, v94, v95
    v_mfma_f32_32x32x16_bf16 v[96:111], v[40:43], v[24:27], 0
    v_mfma_f32_32x32x16_bf16 v[96:111], v[44:47], v[28:31], v[96:111]
    v_mfma_f32_32x32x16_bf16 v[96:111], v[48:51], v[32:35], v[96:111]
    v_mfma_f32_32x32x16_bf16 v[96:111], v[52:55], v[36:39], v[96:111]
    s_mul_i32 s60, s65, 0x24000
    s_lshl_b32 s62, s27, 11
    s_add_u32 s60, s60, s62
    s_add_u32 s60, s60, 0x1c000
    s_lshl_b32 s61, s65, 6
    s_lshl_b32 s62, s27, 2
    s_add_u32 s61, s61, s62
    s_add_u32 s61, s61, 0x1103000
    s_nop 3
    v_mov_b32 v16, v108
    v_mov_b32 v17, v108
    s_nop 1
    v_permlane32_swap_b32 v16, v17
    v_add_f32 v17, 0x358637bd, v17
    v_rcp_f32 v17, v17
    s_nop 0
    v_mul_f32 v96, v96, v17
    v_mul_f32 v97, v97, v17
    v_mul_f32 v98, v98, v17
    v_mul_f32 v99, v99, v17
    v_mul_f32 v100, v100, v17
    v_mul_f32 v101, v101, v17
    v_mul_f32 v102, v102, v17
    v_mul_f32 v103, v103, v17
    v_mul_f32 v104, v104, v17
    v_mul_f32 v105, v105, v17
    v_mul_f32 v106, v106, v17
    v_mul_f32 v107, v107, v17
    v_mul_f32 v108, v108, v17
    v_mul_f32 v109, v109, v17
    v_mul_f32 v110, v110, v17
    v_mul_f32 v111, v111, v17
    v_cvt_pk_bf16_f32 v8, v96, v97
    v_cvt_pk_bf16_f32 v9, v98, v99
    v_cvt_pk_bf16_f32 v10, v100, v101
    v_cvt_pk_bf16_f32 v11, v102, v103
    v_cvt_pk_bf16_f32 v12, v104, v105
    v_cvt_pk_bf16_f32 v13, v106, v107
    v_cvt_pk_bf16_f32 v14, v108, v109
    v_cvt_pk_bf16_f32 v15, v110, v111
    buffer_store_dwordx4 v[8:11], v227, s[44:47], s60 offen offset:0 sc1
    buffer_store_dwordx4 v[12:15], v227, s[44:47], s60 offen offset:1024 sc1
    s_waitcnt vmcnt(0)
    buffer_store_dword v241, v242, s[44:47], s61 offen sc1
    s_endpgm
K1_Q:
    s_cmp_ge_u32 s3, 4
    s_cbranch_scc1 K1_Q1
    v_bfe_u32 v3, v0, 4, 1
    v_bfe_u32 v4, v0, 2, 2
    v_and_b32_e64 v5, 3, v0
    v_lshl_add_u32 v6, v237, 3, v4
    v_lshlrev_b32_e64 v5, 3, v5
    v_lshl_add_u32 v1, v3, 5, v5
    v_lshlrev_b32 v7, 6, v4
    s_lshr_b32 s60, s3, 1
    s_and_b32 s60, s60, 1
    s_mul_i32 s61, s60, 3
    s_and_b32 s62, s61, 3
    s_mul_i32 s62, s62, 56
    s_lshr_b32 s63, s61, 2
    s_lshl_b32 s63, s63, 13
    v_add_u32 v2, s62, v1
    v_xor_b32 v2, v2, v7
    v_add_u32_e64 v2, s63, v2
    v_lshl_add_u32 v216, v6, 8, v2
    v_add_u32 v217, 0xc000, v216
    s_add_u32 s61, s61, 1
    s_and_b32 s62, s61, 3
    s_mul_i32 s62, s62, 56
    s_lshr_b32 s63, s61, 2
    s_lshl_b32 s63, s63, 13
    v_add_u32 v2, s62, v1
    v_xor_b32 v2, v2, v7
    v_add_u32 v2, s63, v2
    v_lshl_add_u32 v218, v6, 8, v2
    v_add_u32 v219, 0xc000, v218
    s_add_u32 s61, s61, 1
    s_and_b32 s62, s61, 3
    s_mul_i32 s62, s62, 56
    s_lshr_b32 s63, s61, 2
    s_lshl_b32 s63, s63, 13
    v_add_u32 v2, s62, v1
    v_xor_b32 v2, v2, v7
    v_add_u32 v2, s63, v2
    v_lshl_add_u32 v220, v6, 8, v2
    v_add_u32 v221, 0xc000, v220
    s_and_b32 s62, s3, 1
    s_lshl_b32 s62, s62, 1
    s_lshl_b32 s63, s26, 2
    s_add_u32 s62, s62, s63
    s_sub_u32 s61, s61, 2
    s_lshl_b32 s70, s62, 15
    s_sub_u32 s63, s27, 14
    s_lshl_b32 s63, s63, 3
    s_add_u32 s63, s63, s61
    s_lshl_b32 s63, s63, 11
    s_add_u32 s70, s70, s63
    s_add_u32 s70, s70, 0xc00000
    v_lshlrev_b32 v200, 16, v16
    v_and_b32 v201, 0xffff0000, v16
    v_lshlrev_b32_e64 v202, 16, v17
    v_and_b32 v203, 0xffff0000, v17
    v_lshlrev_b32_e64 v204, 16, v18
    v_and_b32 v205, 0xffff0000, v18
    v_lshlrev_b32_e64 v206, 16, v19
    v_and_b32 v207, 0xffff0000, v19
    v_fma_f32 v200, v200, v228, v230
    v_fma_f32 v201, v201, v228, v230
    v_fma_f32 v202, v202, v228, v230
    v_fma_f32 v203, v203, v228, v230
    v_fma_f32 v204, v204, v228, v230
    v_fma_f32 v205, v205, v228, v230
    v_fma_f32 v206, v206, v228, v230
    v_fma_f32 v207, v207, v228, v230
    v_cvt_pk_bf16_f32 v16, v200, v201
    v_cvt_pk_bf16_f32 v17, v202, v203
    v_cvt_pk_bf16_f32 v18, v204, v205
    v_cvt_pk_bf16_f32 v19, v206, v207
    s_waitcnt vmcnt(3) lgkmcnt(0)
    s_barrier
    ds_read_b128 v[184:187], v223 offset:0
    ds_read_b64_tr_b16 v[160:161], v216 offset:0
    ds_read_b64_tr_b16 v[162:163], v216 offset:1024
    ds_read_b128 v[188:191], v223 offset:4224
    ds_read_b64_tr_b16 v[164:165], v218 offset:0
    ds_read_b64_tr_b16 v[166:167], v218 offset:1024
    ds_read_b64_tr_b16 v[168:169], v220 offset:0
    ds_read_b64_tr_b16 v[170:171], v220 offset:1024
    s_waitcnt lgkmcnt(5)
    s_nop 0
    v_mfma_f32_32x32x16_bf16 v[64:79], v[160:163], v[184:187], 0
    ds_read_b128 v[192:195], v223 offset:1056
    ds_read_b64_tr_b16 v[172:173], v216 offset:4096
    s_waitcnt lgkmcnt(6)
    s_nop 0
    v_mfma_f32_32x32x16_bf16 v[80:95], v[160:163], v[188:191], 0
    ds_read_b64_tr_b16 v[174:175], v216 offset:5120
    ds_read_b128 v[196:199], v223 offset:5280
    s_waitcnt lgkmcnt(6)
    s_nop 0
    v_mfma_f32_32x32x16_bf16 v[96:111], v[164:167], v[184:187], 0
    ds_read_b64_tr_b16 v[176:177], v218 offset:4096
    ds_read_b64_tr_b16 v[178:179], v218 offset:5120
    v_mfma_f32_32x32x16_bf16 v[112:127], v[164:167], v[188:191], 0
    ds_read_b64_tr_b16 v[180:181], v220 offset:4096
    ds_read_b64_tr_b16 v[182:183], v220 offset:5120
    s_waitcnt lgkmcnt(8)
    v_mfma_f32_32x32x16_bf16 v[128:143], v[168:171], v[184:187], 0
    v_mfma_f32_32x32x16_bf16 v[144:159], v[168:171], v[188:191], 0
    s_waitcnt lgkmcnt(5)
    v_mfma_f32_32x32x16_bf16 v[64:79], v[172:175], v[192:195], v[64:79]
    ds_read_b128 v[184:187], v223 offset:2112
    ds_read_b64_tr_b16 v[160:161], v216 offset:16384
    s_waitcnt lgkmcnt(6)
    s_nop 0
    v_mfma_f32_32x32x16_bf16 v[80:95], v[172:175], v[196:199], v[80:95]
    ds_read_b64_tr_b16 v[162:163], v216 offset:17408
    ds_read_b128 v[188:191], v223 offset:6336
    s_waitcnt lgkmcnt(6)
    s_nop 0
    v_mfma_f32_32x32x16_bf16 v[96:111], v[176:179], v[192:195], v[96:111]
    ds_read_b64_tr_b16 v[164:165], v218 offset:16384
    ds_read_b64_tr_b16 v[166:167], v218 offset:17408
    v_mfma_f32_32x32x16_bf16 v[112:127], v[176:179], v[196:199], v[112:127]
    ds_read_b64_tr_b16 v[168:169], v220 offset:16384
    ds_read_b64_tr_b16 v[170:171], v220 offset:17408
    s_waitcnt lgkmcnt(8)
    s_nop 0
    v_mfma_f32_32x32x16_bf16 v[128:143], v[180:183], v[192:195], v[128:143]
    v_mfma_f32_32x32x16_bf16 v[144:159], v[180:183], v[196:199], v[144:159]
    s_add_u32 m0, s66, 0xc000
    s_nop 0
    buffer_load_dwordx4 v225, s[36:39], s65 offen lds
    ds_write_b128 v222, v[16:19] offset:16896
    v_lshlrev_b32 v200, 16, v20
    v_and_b32 v201, 0xffff0000, v20
    v_lshlrev_b32_e64 v202, 16, v21
    v_and_b32 v203, 0xffff0000, v21
    s_add_u32 m0, s66, 0xe000
    s_nop 0
    buffer_load_dwordx4 v226, s[40:43], s65 offen lds
    v_lshlrev_b32 v204, 16, v22
    v_and_b32 v205, 0xffff0000, v22
    v_lshlrev_b32_e64 v206, 16, v23
    v_and_b32 v207, 0xffff0000, v23
    v_fma_f32 v200, v200, v229, v231
    s_add_u32 s65, s65, s75
    s_cmp_eq_u32 s65, s76
    s_cselect_b32 s65, 0, s65
    s_add_u32 m0, s66, 0x10000
    s_nop 0
    buffer_load_dwordx4 v225, s[36:39], s65 offen lds
    v_fma_f32 v201, v201, v229, v231
    v_fma_f32 v202, v202, v229, v231
    v_fma_f32 v203, v203, v229, v231
    v_fma_f32 v204, v204, v229, v231
    v_fma_f32 v205, v205, v229, v231
    s_add_u32 m0, s66, 0x12000
    s_nop 0
    buffer_load_dwordx4 v226, s[40:43], s65 offen lds
    s_add_u32 s65, s65, s75
    v_fma_f32 v206, v206, v229, v231
    v_fma_f32 v207, v207, v229, v231
    v_cvt_pk_bf16_f32 v20, v200, v201
    v_cvt_pk_bf16_f32 v21, v202, v203
    v_cvt_pk_bf16_f32 v22, v204, v205
    v_cvt_pk_bf16_f32 v23, v206, v207
    ds_write_b128 v222, v[20:23] offset:17024
    s_waitcnt vmcnt(4) lgkmcnt(0)
    s_barrier
    v_mfma_f32_32x32x16_bf16 v[64:79], v[160:163], v[184:187], v[64:79]
    ds_read_b128 v[192:195], v223 offset:3168
    ds_read_b64_tr_b16 v[172:173], v216 offset:20480
    v_mfma_f32_32x32x16_bf16 v[80:95], v[160:163], v[188:191], v[80:95]
    ds_read_b64_tr_b16 v[174:175], v216 offset:21504
    ds_read_b128 v[196:199], v223 offset:7392
    v_mfma_f32_32x32x16_bf16 v[96:111], v[164:167], v[184:187], v[96:111]
    ds_read_b64_tr_b16 v[176:177], v218 offset:20480
    ds_read_b64_tr_b16 v[178:179], v218 offset:21504
    v_mfma_f32_32x32x16_bf16 v[112:127], v[164:167], v[188:191], v[112:127]
    ds_read_b64_tr_b16 v[180:181], v220 offset:20480
    ds_read_b64_tr_b16 v[182:183], v220 offset:21504
    v_mfma_f32_32x32x16_bf16 v[128:143], v[168:171], v[184:187], v[128:143]
    v_mfma_f32_32x32x16_bf16 v[144:159], v[168:171], v[188:191], v[144:159]
    s_waitcnt lgkmcnt(5)
    s_nop 0
    v_mfma_f32_32x32x16_bf16 v[64:79], v[172:175], v[192:195], v[64:79]
    ds_read_b128 v[184:187], v223 offset:16896
    ds_read_b64_tr_b16 v[160:161], v216 offset:32768
    s_waitcnt lgkmcnt(6)
    s_nop 0
    v_mfma_f32_32x32x16_bf16 v[80:95], v[172:175], v[196:199], v[80:95]
    ds_read_b64_tr_b16 v[162:163], v216 offset:33792
    ds_read_b128 v[188:191], v223 offset:21120
    s_waitcnt lgkmcnt(6)
    s_nop 0
    v_mfma_f32_32x32x16_bf16 v[96:111], v[176:179], v[192:195], v[96:111]
    ds_read_b64_tr_b16 v[164:165], v218 offset:32768
    ds_read_b64_tr_b16 v[166:167], v218 offset:33792
    v_mfma_f32_32x32x16_bf16 v[112:127], v[176:179], v[196:199], v[112:127]
    ds_read_b64_tr_b16 v[168:169], v220 offset:32768
    ds_read_b64_tr_b16 v[170:171], v220 offset:33792
    s_waitcnt lgkmcnt(8)
    s_nop 0
    v_mfma_f32_32x32x16_bf16 v[128:143], v[180:183], v[192:195], v[128:143]
    v_mfma_f32_32x32x16_bf16 v[144:159], v[180:183], v[196:199], v[144:159]
    s_add_u32 m0, s66, 0x14000
    s_nop 0
    buffer_load_dwordx4 v225, s[36:39], s65 offen lds
    v_lshlrev_b32 v200, 16, v24
    v_and_b32 v201, 0xffff0000, v24
    v_lshlrev_b32_e64 v202, 16, v25
    v_and_b32 v203, 0xffff0000, v25
    s_add_u32 m0, s66, 0x16000
    s_nop 0
    buffer_load_dwordx4 v226, s[40:43], s65 offen lds
    v_lshlrev_b32 v204, 16, v26
    v_and_b32 v205, 0xffff0000, v26
    v_lshlrev_b32_e64 v206, 16, v27
    v_and_b32 v207, 0xffff0000, v27
    s_add_u32 s65, s65, s75
    s_cmp_eq_u32 s65, s76
    s_cselect_b32 s65, 0, s65
    s_add_u32 m0, s66, 0
    s_nop 0
    s_nop 0
    buffer_load_dwordx4 v225, s[36:39], s65 offen lds
    v_fma_f32 v200, v200, v228, v230
    v_fma_f32 v201, v201, v228, v230
    v_fma_f32 v202, v202, v228, v230
    v_fma_f32 v203, v203, v228, v230
    s_add_u32 m0, s66, 0x2000
    s_nop 0
    s_nop 0
    buffer_load_dwordx4 v226, s[40:43], s65 offen lds
    v_fma_f32 v204, v204, v228, v230
    v_fma_f32 v205, v205, v228, v230
    v_fma_f32 v206, v206, v228, v230
    v_fma_f32 v207, v207, v228, v230
    s_add_u32 s65, s65, s75
    s_add_u32 m0, s66, 0x1c000
    s_nop 0
    buffer_load_dwordx4 v224, s[32:35], s64 offen lds
    s_add_u32 s64, s64, 0x2a000
    s_cmp_eq_u32 s64, 0x126000
    s_cselect_b32 s64, 0, s64
    s_nop 0
    v_cvt_pk_bf16_f32 v24, v200, v201
    v_cvt_pk_bf16_f32 v25, v202, v203
    v_cvt_pk_bf16_f32 v26, v204, v205
    v_cvt_pk_bf16_f32 v27, v206, v207
    s_waitcnt vmcnt(7)
    s_barrier
    s_waitcnt lgkmcnt(5)
    s_nop 0
    v_mfma_f32_32x32x16_bf16 v[64:79], v[160:163], v[184:187], v[64:79]
    ds_read_b128 v[192:195], v223 offset:17952
    ds_read_b64_tr_b16 v[172:173], v216 offset:36864
    s_waitcnt lgkmcnt(6)
    s_nop 0
    v_mfma_f32_32x32x16_bf16 v[80:95], v[160:163], v[188:191], v[80:95]
    ds_read_b64_tr_b16 v[174:175], v216 offset:37888
    ds_read_b128 v[196:199], v223 offset:22176
    s_waitcnt lgkmcnt(6)
    s_nop 0
    v_mfma_f32_32x32x16_bf16 v[96:111], v[164:167], v[184:187], v[96:111]
    ds_read_b64_tr_b16 v[176:177], v218 offset:36864
    ds_read_b64_tr_b16 v[178:179], v218 offset:37888
    v_mfma_f32_32x32x16_bf16 v[112:127], v[164:167], v[188:191], v[112:127]
    ds_read_b64_tr_b16 v[180:181], v220 offset:36864
    ds_read_b64_tr_b16 v[182:183], v220 offset:37888
    s_waitcnt lgkmcnt(8)
    v_mfma_f32_32x32x16_bf16 v[128:143], v[168:171], v[184:187], v[128:143]
    v_mfma_f32_32x32x16_bf16 v[144:159], v[168:171], v[188:191], v[144:159]
    s_waitcnt lgkmcnt(5)
    v_mfma_f32_32x32x16_bf16 v[64:79], v[172:175], v[192:195], v[64:79]
    ds_read_b128 v[184:187], v223 offset:19008
    ds_read_b64_tr_b16 v[160:161], v217 offset:0
    s_waitcnt lgkmcnt(6)
    s_nop 0
    v_mfma_f32_32x32x16_bf16 v[80:95], v[172:175], v[196:199], v[80:95]
    ds_read_b64_tr_b16 v[162:163], v217 offset:1024
    ds_read_b128 v[188:191], v223 offset:23232
    s_waitcnt lgkmcnt(6)
    s_nop 0
    v_mfma_f32_32x32x16_bf16 v[96:111], v[176:179], v[192:195], v[96:111]
    ds_read_b64_tr_b16 v[164:165], v219 offset:0
    ds_read_b64_tr_b16 v[166:167], v219 offset:1024
    v_mfma_f32_32x32x16_bf16 v[112:127], v[176:179], v[196:199], v[112:127]
    ds_read_b64_tr_b16 v[168:169], v221 offset:0
    ds_read_b64_tr_b16 v[170:171], v221 offset:1024
    s_waitcnt lgkmcnt(8)
    s_nop 0
    v_mfma_f32_32x32x16_bf16 v[128:143], v[180:183], v[192:195], v[128:143]
    v_mfma_f32_32x32x16_bf16 v[144:159], v[180:183], v[196:199], v[144:159]
    s_add_u32 m0, s66, 0x4000
    s_nop 0
    buffer_load_dwordx4 v225, s[36:39], s65 offen lds
    ds_write_b128 v222, v[24:27] offset:0
    v_lshlrev_b32 v200, 16, v28
    v_and_b32 v201, 0xffff0000, v28
    v_lshlrev_b32_e64 v202, 16, v29
    v_and_b32 v203, 0xffff0000, v29
    v_lshlrev_b32_e64 v204, 16, v30
    v_and_b32 v205, 0xffff0000, v30
    v_lshlrev_b32_e64 v206, 16, v31
    v_and_b32 v207, 0xffff0000, v31
    v_fma_f32 v200, v200, v229, v231
    v_fma_f32 v201, v201, v229, v231
    s_add_u32 m0, s66, 0x6000
    s_nop 0
    buffer_load_dwordx4 v226, s[40:43], s65 offen lds
    s_add_u32 s65, s65, s75
    s_cmp_eq_u32 s65, s76
    s_cselect_b32 s65, 0, s65
    v_fma_f32 v202, v202, v229, v231
    v_fma_f32 v203, v203, v229, v231
    v_fma_f32 v204, v204, v229, v231
    v_fma_f32 v205, v205, v229, v231
    v_fma_f32 v206, v206, v229, v231
    v_fma_f32 v207, v207, v229, v231
    v_cvt_pk_bf16_f32 v28, v200, v201
    v_cvt_pk_bf16_f32 v29, v202, v203
    v_cvt_pk_bf16_f32 v30, v204, v205
    v_cvt_pk_bf16_f32 v31, v206, v207
    ds_write_b128 v222, v[28:31] offset:128
    s_waitcnt vmcnt(2) lgkmcnt(0)
    s_barrier
    v_mfma_f32_32x32x16_bf16 v[64:79], v[160:163], v[184:187], v[64:79]
    ds_read_b128 v[192:195], v223 offset:20064
    ds_read_b64_tr_b16 v[172:173], v217 offset:4096
    v_mfma_f32_32x32x16_bf16 v[80:95], v[160:163], v[188:191], v[80:95]
    ds_read_b64_tr_b16 v[174:175], v217 offset:5120
    ds_read_b128 v[196:199], v223 offset:24288
    v_mfma_f32_32x32x16_bf16 v[96:111], v[164:167], v[184:187], v[96:111]
    ds_read_b64_tr_b16 v[176:177], v219 offset:4096
    ds_read_b64_tr_b16 v[178:179], v219 offset:5120
    v_mfma_f32_32x32x16_bf16 v[112:127], v[164:167], v[188:191], v[112:127]
    ds_read_b64_tr_b16 v[180:181], v221 offset:4096
    ds_read_b64_tr_b16 v[182:183], v221 offset:5120
    v_mfma_f32_32x32x16_bf16 v[128:143], v[168:171], v[184:187], v[128:143]
    v_mfma_f32_32x32x16_bf16 v[144:159], v[168:171], v[188:191], v[144:159]
    s_waitcnt lgkmcnt(5)
    s_nop 0
    v_mfma_f32_32x32x16_bf16 v[64:79], v[172:175], v[192:195], v[64:79]
    ds_read_b128 v[184:187], v223 offset:0
    ds_read_b64_tr_b16 v[160:161], v217 offset:16384
    s_waitcnt lgkmcnt(6)
    s_nop 0
    v_mfma_f32_32x32x16_bf16 v[80:95], v[172:175], v[196:199], v[80:95]
    ds_read_b64_tr_b16 v[162:163], v217 offset:17408
    ds_read_b128 v[188:191], v223 offset:4224
    s_waitcnt lgkmcnt(6)
    s_nop 0
    v_mfma_f32_32x32x16_bf16 v[96:111], v[176:179], v[192:195], v[96:111]
    ds_read_b64_tr_b16 v[164:165], v219 offset:16384
    ds_read_b64_tr_b16 v[166:167], v219 offset:17408
    v_mfma_f32_32x32x16_bf16 v[112:127], v[176:179], v[196:199], v[112:127]
    ds_read_b64_tr_b16 v[168:169], v221 offset:16384
    ds_read_b64_tr_b16 v[170:171], v221 offset:17408
    s_waitcnt lgkmcnt(8)
    s_nop 0
    v_mfma_f32_32x32x16_bf16 v[128:143], v[180:183], v[192:195], v[128:143]
    v_mfma_f32_32x32x16_bf16 v[144:159], v[180:183], v[196:199], v[144:159]
    s_add_u32 m0, s66, 0x8000
    s_nop 0
    buffer_load_dwordx4 v225, s[36:39], s65 offen lds
    v_lshlrev_b32 v200, 16, v32
    v_and_b32 v201, 0xffff0000, v32
    v_lshlrev_b32_e64 v202, 16, v33
    v_and_b32 v203, 0xffff0000, v33
    v_lshlrev_b32_e64 v204, 16, v34
    v_and_b32 v205, 0xffff0000, v34
    s_add_u32 m0, s66, 0xa000
    s_nop 0
    buffer_load_dwordx4 v226, s[40:43], s65 offen lds
    v_lshlrev_b32 v206, 16, v35
    v_and_b32 v207, 0xffff0000, v35
    v_fma_f32 v200, v200, v228, v230
    v_fma_f32 v201, v201, v228, v230
    v_fma_f32 v202, v202, v228, v230
    v_fma_f32 v203, v203, v228, v230
    s_add_u32 s65, s65, s75
    s_add_u32 m0, s66, 0x18000
    s_nop 0
    buffer_load_dwordx4 v224, s[32:35], s64 offen lds
    s_add_u32 s64, s64, 0x2a000
    s_cmp_eq_u32 s64, 0x126000
    s_cselect_b32 s64, 0, s64
    s_nop 0
    v_fma_f32 v204, v204, v228, v230
    v_fma_f32 v205, v205, v228, v230
    v_fma_f32 v206, v206, v228, v230
    v_fma_f32 v207, v207, v228, v230
    v_cvt_pk_bf16_f32 v32, v200, v201
    v_cvt_pk_bf16_f32 v33, v202, v203
    v_cvt_pk_bf16_f32 v34, v204, v205
    v_cvt_pk_bf16_f32 v35, v206, v207
    s_lshl_b32 s60, s2, 3
    s_add_u32 s60, s60, s3
    s_lshl_b32 s60, s60, 10
    s_nop 0
    s_sub_u32 s61, s60, 0x188000
    s_mov_b32 s62, 0x62000
    s_cmp_lt_u32 s60, 0x188000
    s_cselect_b32 s28, s18, s10
    s_cselect_b32 s29, s19, s11
    s_cselect_b32 s30, 0x188000, s62
    s_cselect_b32 s60, s60, s61
    s_and_b32 s29, s29, 0xffff
    buffer_load_dwordx4 v[8:11], v227, s[28:31], s60 offen
    s_barrier
    s_waitcnt lgkmcnt(5)
    s_nop 0
    v_mfma_f32_32x32x16_bf16 v[64:79], v[160:163], v[184:187], v[64:79]
    ds_read_b128 v[192:195], v223 offset:1056
    ds_read_b64_tr_b16 v[172:173], v217 offset:20480
    s_waitcnt lgkmcnt(6)
    s_nop 0
    v_mfma_f32_32x32x16_bf16 v[80:95], v[160:163], v[188:191], v[80:95]
    ds_read_b64_tr_b16 v[174:175], v217 offset:21504
    ds_read_b128 v[196:199], v223 offset:5280
    s_waitcnt lgkmcnt(6)
    s_nop 0
    v_mfma_f32_32x32x16_bf16 v[96:111], v[164:167], v[184:187], v[96:111]
    ds_read_b64_tr_b16 v[176:177], v219 offset:20480
    ds_read_b64_tr_b16 v[178:179], v219 offset:21504
    v_mfma_f32_32x32x16_bf16 v[112:127], v[164:167], v[188:191], v[112:127]
    ds_read_b64_tr_b16 v[180:181], v221 offset:20480
    ds_read_b64_tr_b16 v[182:183], v221 offset:21504
    s_waitcnt lgkmcnt(8)
    v_mfma_f32_32x32x16_bf16 v[128:143], v[168:171], v[184:187], v[128:143]
    v_mfma_f32_32x32x16_bf16 v[144:159], v[168:171], v[188:191], v[144:159]
    s_waitcnt lgkmcnt(5)
    v_mfma_f32_32x32x16_bf16 v[64:79], v[172:175], v[192:195], v[64:79]
    ds_read_b128 v[184:187], v223 offset:2112
    ds_read_b64_tr_b16 v[160:161], v217 offset:32768
    s_waitcnt lgkmcnt(6)
    s_nop 0
    v_mfma_f32_32x32x16_bf16 v[80:95], v[172:175], v[196:199], v[80:95]
    ds_read_b64_tr_b16 v[162:163], v217 offset:33792
    ds_read_b128 v[188:191], v223 offset:6336
    s_waitcnt lgkmcnt(6)
    s_nop 0
    v_mfma_f32_32x32x16_bf16 v[96:111], v[176:179], v[192:195], v[96:111]
    ds_read_b64_tr_b16 v[164:165], v219 offset:32768
    ds_read_b64_tr_b16 v[166:167], v219 offset:33792
    v_mfma_f32_32x32x16_bf16 v[112:127], v[176:179], v[196:199], v[112:127]
    ds_read_b64_tr_b16 v[168:169], v221 offset:32768
    ds_read_b64_tr_b16 v[170:171], v221 offset:33792
    s_waitcnt lgkmcnt(8)
    s_nop 0
    v_mfma_f32_32x32x16_bf16 v[128:143], v[180:183], v[192:195], v[128:143]
    v_mfma_f32_32x32x16_bf16 v[144:159], v[180:183], v[196:199], v[144:159]
    s_add_u32 m0, s66, 0xc000
    s_nop 0
    buffer_load_dwordx4 v225, s[36:39], s65 offen lds
    ds_write_b128 v222, v[32:35] offset:16896
    v_lshlrev_b32 v200, 16, v36
    v_and_b32 v201, 0xffff0000, v36
    v_lshlrev_b32_e64 v202, 16, v37
    v_and_b32 v203, 0xffff0000, v37
    v_lshlrev_b32_e64 v204, 16, v38
    v_and_b32 v205, 0xffff0000, v38
    v_lshlrev_b32_e64 v206, 16, v39
    v_and_b32 v207, 0xffff0000, v39
    v_fma_f32 v200, v200, v229, v231
    v_fma_f32 v201, v201, v229, v231
    s_add_u32 m0, s66, 0xe000
    s_nop 0
    buffer_load_dwordx4 v226, s[40:43], s65 offen lds
    s_add_u32 s65, s65, s75
    s_cmp_eq_u32 s65, s76
    s_cselect_b32 s65, 0, s65
    v_fma_f32 v202, v202, v229, v231
    v_fma_f32 v203, v203, v229, v231
    v_fma_f32 v204, v204, v229, v231
    v_fma_f32 v205, v205, v229, v231
    v_fma_f32 v206, v206, v229, v231
    v_fma_f32 v207, v207, v229, v231
    v_cvt_pk_bf16_f32 v36, v200, v201
    v_cvt_pk_bf16_f32 v37, v202, v203
    v_cvt_pk_bf16_f32 v38, v204, v205
    v_cvt_pk_bf16_f32 v39, v206, v207
    ds_write_b128 v222, v[36:39] offset:17024
    s_waitcnt vmcnt(3) lgkmcnt(0)
    s_barrier
    v_mfma_f32_32x32x16_bf16 v[64:79], v[160:163], v[184:187], v[64:79]
    ds_read_b128 v[192:195], v223 offset:3168
    ds_read_b64_tr_b16 v[172:173], v217 offset:36864
    v_mfma_f32_32x32x16_bf16 v[80:95], v[160:163], v[188:191], v[80:95]
    ds_read_b64_tr_b16 v[174:175], v217 offset:37888
    ds_read_b128 v[196:199], v223 offset:7392
    v_mfma_f32_32x32x16_bf16 v[96:111], v[164:167], v[184:187], v[96:111]
    ds_read_b64_tr_b16 v[176:177], v219 offset:36864
    ds_read_b64_tr_b16 v[178:179], v219 offset:37888
    v_mfma_f32_32x32x16_bf16 v[112:127], v[164:167], v[188:191], v[112:127]
    ds_read_b64_tr_b16 v[180:181], v221 offset:36864
    ds_read_b64_tr_b16 v[182:183], v221 offset:37888
    v_mfma_f32_32x32x16_bf16 v[128:143], v[168:171], v[184:187], v[128:143]
    v_mfma_f32_32x32x16_bf16 v[144:159], v[168:171], v[188:191], v[144:159]
    s_waitcnt lgkmcnt(5)
    s_nop 0
    v_mfma_f32_32x32x16_bf16 v[64:79], v[172:175], v[192:195], v[64:79]
    ds_read_b128 v[184:187], v223 offset:16896
    ds_read_b64_tr_b16 v[160:161], v216 offset:0
    s_waitcnt lgkmcnt(6)
    s_nop 0
    v_mfma_f32_32x32x16_bf16 v[80:95], v[172:175], v[196:199], v[80:95]
    ds_read_b64_tr_b16 v[162:163], v216 offset:1024
    ds_read_b128 v[188:191], v223 offset:21120
    s_waitcnt lgkmcnt(6)
    s_nop 0
    v_mfma_f32_32x32x16_bf16 v[96:111], v[176:179], v[192:195], v[96:111]
    ds_read_b64_tr_b16 v[164:165], v218 offset:0
    ds_read_b64_tr_b16 v[166:167], v218 offset:1024
    v_mfma_f32_32x32x16_bf16 v[112:127], v[176:179], v[196:199], v[112:127]
    ds_read_b64_tr_b16 v[168:169], v220 offset:0
    ds_read_b64_tr_b16 v[170:171], v220 offset:1024
    s_waitcnt lgkmcnt(8)
    s_nop 0
    v_mfma_f32_32x32x16_bf16 v[128:143], v[180:183], v[192:195], v[128:143]
    v_mfma_f32_32x32x16_bf16 v[144:159], v[180:183], v[196:199], v[144:159]
    s_add_u32 m0, s66, 0x10000
    s_nop 0
    buffer_load_dwordx4 v225, s[36:39], s65 offen lds
    v_lshlrev_b32 v200, 16, v40
    v_and_b32 v201, 0xffff0000, v40
    v_lshlrev_b32_e64 v202, 16, v41
    v_and_b32 v203, 0xffff0000, v41
    v_lshlrev_b32_e64 v204, 16, v42
    v_and_b32 v205, 0xffff0000, v42
    s_add_u32 m0, s66, 0x12000
    s_nop 0
    buffer_load_dwordx4 v226, s[40:43], s65 offen lds
    v_lshlrev_b32 v206, 16, v43
    v_and_b32 v207, 0xffff0000, v43
    v_fma_f32 v200, v200, v228, v230
    v_fma_f32 v201, v201, v228, v230
    v_fma_f32 v202, v202, v228, v230
    v_fma_f32 v203, v203, v228, v230
    s_add_u32 s65, s65, s75
    s_add_u32 m0, s66, 0x1a000
    s_nop 0
    buffer_load_dwordx4 v224, s[32:35], s64 offen lds
    s_add_u32 s64, s64, 0x2a000
    s_cmp_eq_u32 s64, 0x126000
    s_cselect_b32 s64, 0, s64
    s_nop 0
    v_fma_f32 v204, v204, v228, v230
    v_fma_f32 v205, v205, v228, v230
    v_fma_f32 v206, v206, v228, v230
    v_fma_f32 v207, v207, v228, v230
    v_cvt_pk_bf16_f32 v40, v200, v201
    v_cvt_pk_bf16_f32 v41, v202, v203
    v_cvt_pk_bf16_f32 v42, v204, v205
    v_cvt_pk_bf16_f32 v43, v206, v207
    s_barrier
    s_waitcnt lgkmcnt(5)
    v_mfma_f32_32x32x16_bf16 v[64:79], v[160:163], v[184:187], v[64:79]
    ds_read_b128 v[192:195], v223 offset:17952
    ds_read_b64_tr_b16 v[172:173], v216 offset:4096
    s_waitcnt lgkmcnt(6)
    s_nop 0
    v_mfma_f32_32x32x16_bf16 v[80:95], v[160:163], v[188:191], v[80:95]
    ds_read_b64_tr_b16 v[174:175], v216 offset:5120
    ds_read_b128 v[196:199], v223 offset:22176
    s_waitcnt lgkmcnt(6)
    s_nop 0
    v_mfma_f32_32x32x16_bf16 v[96:111], v[164:167], v[184:187], v[96:111]
    ds_read_b64_tr_b16 v[176:177], v218 offset:4096
    ds_read_b64_tr_b16 v[178:179], v218 offset:5120
    v_mfma_f32_32x32x16_bf16 v[112:127], v[164:167], v[188:191], v[112:127]
    ds_read_b64_tr_b16 v[180:181], v220 offset:4096
    ds_read_b64_tr_b16 v[182:183], v220 offset:5120
    s_waitcnt lgkmcnt(8)
    v_mfma_f32_32x32x16_bf16 v[128:143], v[168:171], v[184:187], v[128:143]
    v_mfma_f32_32x32x16_bf16 v[144:159], v[168:171], v[188:191], v[144:159]
    s_waitcnt lgkmcnt(5)
    v_mfma_f32_32x32x16_bf16 v[64:79], v[172:175], v[192:195], v[64:79]
    ds_read_b128 v[184:187], v223 offset:19008
    ds_read_b64_tr_b16 v[160:161], v216 offset:16384
    s_waitcnt lgkmcnt(6)
    s_nop 0
    v_mfma_f32_32x32x16_bf16 v[80:95], v[172:175], v[196:199], v[80:95]
    ds_read_b64_tr_b16 v[162:163], v216 offset:17408
    ds_read_b128 v[188:191], v223 offset:23232
    s_waitcnt lgkmcnt(6)
    s_nop 0
    v_mfma_f32_32x32x16_bf16 v[96:111], v[176:179], v[192:195], v[96:111]
    ds_read_b64_tr_b16 v[164:165], v218 offset:16384
    ds_read_b64_tr_b16 v[166:167], v218 offset:17408
    v_mfma_f32_32x32x16_bf16 v[112:127], v[176:179], v[196:199], v[112:127]
    ds_read_b64_tr_b16 v[168:169], v220 offset:16384
    ds_read_b64_tr_b16 v[170:171], v220 offset:17408
    s_waitcnt lgkmcnt(8)
    s_nop 0
    v_mfma_f32_32x32x16_bf16 v[128:143], v[180:183], v[192:195], v[128:143]
    v_mfma_f32_32x32x16_bf16 v[144:159], v[180:183], v[196:199], v[144:159]
    s_add_u32 m0, s66, 0x14000
    s_nop 0
    buffer_load_dwordx4 v225, s[36:39], s65 offen lds
    ds_write_b128 v222, v[40:43] offset:0
    v_lshlrev_b32 v200, 16, v44
    v_and_b32 v201, 0xffff0000, v44
    v_lshlrev_b32_e64 v202, 16, v45
    v_and_b32 v203, 0xffff0000, v45
    v_lshlrev_b32_e64 v204, 16, v46
    v_and_b32 v205, 0xffff0000, v46
    v_lshlrev_b32_e64 v206, 16, v47
    v_and_b32 v207, 0xffff0000, v47
    v_fma_f32 v200, v200, v229, v231
    v_fma_f32 v201, v201, v229, v231
    s_add_u32 m0, s66, 0x16000
    s_nop 0
    buffer_load_dwordx4 v226, s[40:43], s65 offen lds
    s_add_u32 s65, s65, s75
    s_cmp_eq_u32 s65, s76
    s_cselect_b32 s65, 0, s65
    v_fma_f32 v202, v202, v229, v231
    v_fma_f32 v203, v203, v229, v231
    v_fma_f32 v204, v204, v229, v231
    v_fma_f32 v205, v205, v229, v231
    v_fma_f32 v206, v206, v229, v231
    v_fma_f32 v207, v207, v229, v231
    v_cvt_pk_bf16_f32 v44, v200, v201
    v_cvt_pk_bf16_f32 v45, v202, v203
    v_cvt_pk_bf16_f32 v46, v204, v205
    v_cvt_pk_bf16_f32 v47, v206, v207
    ds_write_b128 v222, v[44:47] offset:128
    s_waitcnt vmcnt(2) lgkmcnt(0)
    s_barrier
    v_mfma_f32_32x32x16_bf16 v[64:79], v[160:163], v[184:187], v[64:79]
    ds_read_b128 v[192:195], v223 offset:20064
    ds_read_b64_tr_b16 v[172:173], v216 offset:20480
    v_mfma_f32_32x32x16_bf16 v[80:95], v[160:163], v[188:191], v[80:95]
    ds_read_b64_tr_b16 v[174:175], v216 offset:21504
    ds_read_b128 v[196:199], v223 offset:24288
    v_mfma_f32_32x32x16_bf16 v[96:111], v[164:167], v[184:187], v[96:111]
    ds_read_b64_tr_b16 v[176:177], v218 offset:20480
    ds_read_b64_tr_b16 v[178:179], v218 offset:21504
    v_mfma_f32_32x32x16_bf16 v[112:127], v[164:167], v[188:191], v[112:127]
    ds_read_b64_tr_b16 v[180:181], v220 offset:20480
    ds_read_b64_tr_b16 v[182:183], v220 offset:21504
    v_mfma_f32_32x32x16_bf16 v[128:143], v[168:171], v[184:187], v[128:143]
    v_mfma_f32_32x32x16_bf16 v[144:159], v[168:171], v[188:191], v[144:159]
    s_waitcnt lgkmcnt(5)
    s_nop 0
    v_mfma_f32_32x32x16_bf16 v[64:79], v[172:175], v[192:195], v[64:79]
    ds_read_b128 v[184:187], v223 offset:0
    ds_read_b64_tr_b16 v[160:161], v216 offset:32768
    s_waitcnt lgkmcnt(6)
    s_nop 0
    v_mfma_f32_32x32x16_bf16 v[80:95], v[172:175], v[196:199], v[80:95]
    ds_read_b64_tr_b16 v[162:163], v216 offset:33792
    ds_read_b128 v[188:191], v223 offset:4224
    s_waitcnt lgkmcnt(6)
    s_nop 0
    v_mfma_f32_32x32x16_bf16 v[96:111], v[176:179], v[192:195], v[96:111]
    ds_read_b64_tr_b16 v[164:165], v218 offset:32768
    ds_read_b64_tr_b16 v[166:167], v218 offset:33792
    v_mfma_f32_32x32x16_bf16 v[112:127], v[176:179], v[196:199], v[112:127]
    ds_read_b64_tr_b16 v[168:169], v220 offset:32768
    ds_read_b64_tr_b16 v[170:171], v220 offset:33792
    s_waitcnt lgkmcnt(8)
    v_mfma_f32_32x32x16_bf16 v[128:143], v[180:183], v[192:195], v[128:143]
    v_mfma_f32_32x32x16_bf16 v[144:159], v[180:183], v[196:199], v[144:159]
    s_add_u32 m0, s66, 0
    s_nop 0
    buffer_load_dwordx4 v225, s[36:39], s65 offen lds
    v_lshlrev_b32 v200, 16, v48
    v_and_b32 v201, 0xffff0000, v48
    v_lshlrev_b32_e64 v202, 16, v49
    v_and_b32 v203, 0xffff0000, v49
    v_lshlrev_b32_e64 v204, 16, v50
    v_and_b32 v205, 0xffff0000, v50
    s_add_u32 m0, s66, 0x2000
    s_nop 0
    buffer_load_dwordx4 v226, s[40:43], s65 offen lds
    v_lshlrev_b32 v206, 16, v51
    v_and_b32 v207, 0xffff0000, v51
    v_fma_f32 v200, v200, v228, v230
    v_fma_f32 v201, v201, v228, v230
    v_fma_f32 v202, v202, v228, v230
    v_fma_f32 v203, v203, v228, v230
    s_add_u32 s65, s65, s75
    s_add_u32 m0, s66, 0x1c000
    s_nop 0
    buffer_load_dwordx4 v224, s[32:35], s64 offen lds
    s_add_u32 s64, s64, 0x2a000
    s_cmp_eq_u32 s64, 0x126000
    s_cselect_b32 s64, 0, s64
    s_nop 0
    v_fma_f32 v204, v204, v228, v230
    v_fma_f32 v205, v205, v228, v230
    v_fma_f32 v206, v206, v228, v230
    v_fma_f32 v207, v207, v228, v230
    v_cvt_pk_bf16_f32 v48, v200, v201
    v_cvt_pk_bf16_f32 v49, v202, v203
    v_cvt_pk_bf16_f32 v50, v204, v205
    v_cvt_pk_bf16_f32 v51, v206, v207
    s_barrier
    s_waitcnt lgkmcnt(5)
    v_mfma_f32_32x32x16_bf16 v[64:79], v[160:163], v[184:187], v[64:79]
    ds_read_b128 v[192:195], v223 offset:1056
    ds_read_b64_tr_b16 v[172:173], v216 offset:36864
    s_waitcnt lgkmcnt(6)
    s_nop 0
    v_mfma_f32_32x32x16_bf16 v[80:95], v[160:163], v[188:191], v[80:95]
    ds_read_b64_tr_b16 v[174:175], v216 offset:37888
    ds_read_b128 v[196:199], v223 offset:5280
    s_waitcnt lgkmcnt(6)
    s_nop 0
    v_mfma_f32_32x32x16_bf16 v[96:111], v[164:167], v[184:187], v[96:111]
    ds_read_b64_tr_b16 v[176:177], v218 offset:36864
    ds_read_b64_tr_b16 v[178:179], v218 offset:37888
    v_mfma_f32_32x32x16_bf16 v[112:127], v[164:167], v[188:191], v[112:127]
    ds_read_b64_tr_b16 v[180:181], v220 offset:36864
    ds_read_b64_tr_b16 v[182:183], v220 offset:37888
    s_waitcnt lgkmcnt(8)
    v_mfma_f32_32x32x16_bf16 v[128:143], v[168:171], v[184:187], v[128:143]
    v_mfma_f32_32x32x16_bf16 v[144:159], v[168:171], v[188:191], v[144:159]
    s_waitcnt lgkmcnt(5)
    v_mfma_f32_32x32x16_bf16 v[64:79], v[172:175], v[192:195], v[64:79]
    ds_read_b128 v[184:187], v223 offset:2112
    ds_read_b64_tr_b16 v[160:161], v217 offset:0
    s_waitcnt lgkmcnt(6)
    s_nop 0
    v_mfma_f32_32x32x16_bf16 v[80:95], v[172:175], v[196:199], v[80:95]
    ds_read_b64_tr_b16 v[162:163], v217 offset:1024
    ds_read_b128 v[188:191], v223 offset:6336
    s_waitcnt lgkmcnt(6)
    s_nop 0
    v_mfma_f32_32x32x16_bf16 v[96:111], v[176:179], v[192:195], v[96:111]
    ds_read_b64_tr_b16 v[164:165], v219 offset:0
    ds_read_b64_tr_b16 v[166:167], v219 offset:1024
    v_mfma_f32_32x32x16_bf16 v[112:127], v[176:179], v[196:199], v[112:127]
    ds_read_b64_tr_b16 v[168:169], v221 offset:0
    ds_read_b64_tr_b16 v[170:171], v221 offset:1024
    s_waitcnt lgkmcnt(8)
    s_nop 0
    v_mfma_f32_32x32x16_bf16 v[128:143], v[180:183], v[192:195], v[128:143]
    v_mfma_f32_32x32x16_bf16 v[144:159], v[180:183], v[196:199], v[144:159]
    s_add_u32 m0, s66, 0x4000
    s_nop 0
    buffer_load_dwordx4 v225, s[36:39], s65 offen lds
    ds_write_b128 v222, v[48:51] offset:16896
    v_lshlrev_b32 v200, 16, v52
    v_and_b32 v201, 0xffff0000, v52
    v_lshlrev_b32_e64 v202, 16, v53
    v_and_b32 v203, 0xffff0000, v53
    v_lshlrev_b32_e64 v204, 16, v54
    v_and_b32 v205, 0xffff0000, v54
    v_lshlrev_b32_e64 v206, 16, v55
    v_and_b32 v207, 0xffff0000, v55
    v_fma_f32 v200, v200, v229, v231
    v_fma_f32 v201, v201, v229, v231
    s_add_u32 m0, s66, 0x6000
    s_nop 0
    s_nop 0
    buffer_load_dwordx4 v226, s[40:43], s65 offen lds
    v_fma_f32 v202, v202, v229, v231
    v_fma_f32 v203, v203, v229, v231
    v_fma_f32 v204, v204, v229, v231
    v_fma_f32 v205, v205, v229, v231
    v_fma_f32 v206, v206, v229, v231
    v_fma_f32 v207, v207, v229, v231
    v_cvt_pk_bf16_f32 v52, v200, v201
    v_cvt_pk_bf16_f32 v53, v202, v203
    v_cvt_pk_bf16_f32 v54, v204, v205
    v_cvt_pk_bf16_f32 v55, v206, v207
    ds_write_b128 v222, v[52:55] offset:17024
    s_mov_b32 s48, s18
    s_nop 0
    s_and_b32 s49, s19, 0xffff
    s_mov_b32 s50, 0x188000
    s_mov_b32 s51, 0x20000
    s_sub_u32 s62, s2, 32
    s_and_b32 s60, s62, 7
    s_lshr_b32 s61, s62, 3
    s_mul_i32 s62, s61, 37
    s_lshr_b32 s62, s62, 8
    s_lshl_b32 s67, s60, 2
    s_add_u32 s67, s67, s62
    s_mul_i32 s62, s62, 7
    s_sub_u32 s68, s61, s62
    s_lshl_b32 s60, s68, 7
    s_mul_i32 s69, s3, 0x62000
    s_add_u32 s69, s69, s60
    s_cmp_lt_u32 s2, 32
    s_cselect_b32 s69, 0x7fff0000, s69
    s_lshl_b32 s58, s3, 11
    v_lshrrev_b32 v1, 3, v0
    v_and_b32_e64 v2, 7, v0
    v_bfe_u32 v3, v0, 4, 1
    v_lshlrev_b32 v3, 2, v3
    v_xor_b32 v2, v2, v3
    v_mul_u32_u24 v244, 0x380, v1
    v_lshl_add_u32 v244, v2, 4, v244
    s_waitcnt vmcnt(2) lgkmcnt(0)
    s_barrier
    v_mfma_f32_32x32x16_bf16 v[64:79], v[160:163], v[184:187], v[64:79]
    ds_read_b128 v[192:195], v223 offset:3168
    ds_read_b64_tr_b16 v[172:173], v217 offset:4096
    v_mfma_f32_32x32x16_bf16 v[80:95], v[160:163], v[188:191], v[80:95]
    ds_read_b64_tr_b16 v[174:175], v217 offset:5120
    ds_read_b128 v[196:199], v223 offset:7392
    v_mfma_f32_32x32x16_bf16 v[96:111], v[164:167], v[184:187], v[96:111]
    ds_read_b64_tr_b16 v[176:177], v219 offset:4096
    ds_read_b64_tr_b16 v[178:179], v219 offset:5120
    v_mfma_f32_32x32x16_bf16 v[112:127], v[164:167], v[188:191], v[112:127]
    ds_read_b64_tr_b16 v[180:181], v221 offset:4096
    ds_read_b64_tr_b16 v[182:183], v221 offset:5120
    v_mfma_f32_32x32x16_bf16 v[128:143], v[168:171], v[184:187], v[128:143]
    v_mfma_f32_32x32x16_bf16 v[144:159], v[168:171], v[188:191], v[144:159]
    s_waitcnt lgkmcnt(5)
    s_nop 0
    v_mfma_f32_32x32x16_bf16 v[64:79], v[172:175], v[192:195], v[64:79]
    ds_read_b128 v[184:187], v223 offset:16896
    ds_read_b64_tr_b16 v[160:161], v217 offset:16384
    s_waitcnt lgkmcnt(6)
    s_nop 0
    v_mfma_f32_32x32x16_bf16 v[80:95], v[172:175], v[196:199], v[80:95]
    ds_read_b64_tr_b16 v[162:163], v217 offset:17408
    ds_read_b128 v[188:191], v223 offset:21120
    s_waitcnt lgkmcnt(6)
    s_nop 0
    v_mfma_f32_32x32x16_bf16 v[96:111], v[176:179], v[192:195], v[96:111]
    ds_read_b64_tr_b16 v[164:165], v219 offset:16384
    ds_read_b64_tr_b16 v[166:167], v219 offset:17408
    v_mfma_f32_32x32x16_bf16 v[112:127], v[176:179], v[196:199], v[112:127]
    ds_read_b64_tr_b16 v[168:169], v221 offset:16384
    ds_read_b64_tr_b16 v[170:171], v221 offset:17408
    s_waitcnt lgkmcnt(8)
    s_nop 0
    v_mfma_f32_32x32x16_bf16 v[128:143], v[180:183], v[192:195], v[128:143]
    v_mfma_f32_32x32x16_bf16 v[144:159], v[180:183], v[196:199], v[144:159]
    s_add_u32 m0, s66, 0x18000
    s_nop 0
    buffer_load_dwordx4 v224, s[32:35], s64 offen lds
    v_lshlrev_b32 v200, 16, v56
    v_and_b32 v201, 0xffff0000, v56
    v_lshlrev_b32_e64 v202, 16, v57
    v_and_b32 v203, 0xffff0000, v57
    v_lshlrev_b32_e64 v204, 16, v58
    v_and_b32 v205, 0xffff0000, v58
    v_lshlrev_b32_e64 v206, 16, v59
    v_and_b32 v207, 0xffff0000, v59
    v_fma_f32 v200, v200, v228, v230
    v_fma_f32 v201, v201, v228, v230
    v_fma_f32 v202, v202, v228, v230
    v_fma_f32 v203, v203, v228, v230
    v_fma_f32 v204, v204, v228, v230
    v_fma_f32 v205, v205, v228, v230
    v_fma_f32 v206, v206, v228, v230
    v_fma_f32 v207, v207, v228, v230
    v_cvt_pk_bf16_f32 v56, v200, v201
    v_cvt_pk_bf16_f32 v57, v202, v203
    v_cvt_pk_bf16_f32 v58, v204, v205
    v_cvt_pk_bf16_f32 v59, v206, v207
    s_add_u32 s59, s69, 0
    s_add_u32 m0, s58, 0x8000
    s_nop 0
    buffer_load_dwordx4 v244, s[48:51], s59 offen lds
    s_add_u32 s59, s69, 0x1c00
    s_add_u32 m0, s58, 0x8400
    s_nop 0
    s_nop 0
    buffer_load_dwordx4 v244, s[48:51], s59 offen lds
    s_add_u32 s59, s69, 0x3800
    s_add_u32 m0, s58, 0xa000
    s_nop 0
    s_nop 0
    buffer_load_dwordx4 v244, s[48:51], s59 offen lds
    s_add_u32 s59, s69, 0x5400
    s_add_u32 m0, s58, 0xa400
    s_nop 0
    buffer_load_dwordx4 v244, s[48:51], s59 offen lds
    s_barrier
    s_waitcnt lgkmcnt(5)
    s_nop 0
    v_mfma_f32_32x32x16_bf16 v[64:79], v[160:163], v[184:187], v[64:79]
    ds_read_b128 v[192:195], v223 offset:17952
    ds_read_b64_tr_b16 v[172:173], v217 offset:20480
    s_waitcnt lgkmcnt(6)
    s_nop 0
    v_mfma_f32_32x32x16_bf16 v[80:95], v[160:163], v[188:191], v[80:95]
    ds_read_b64_tr_b16 v[174:175], v217 offset:21504
    ds_read_b128 v[196:199], v223 offset:22176
    s_waitcnt lgkmcnt(6)
    s_nop 0
    v_mfma_f32_32x32x16_bf16 v[96:111], v[164:167], v[184:187], v[96:111]
    ds_read_b64_tr_b16 v[176:177], v219 offset:20480
    ds_read_b64_tr_b16 v[178:179], v219 offset:21504
    v_mfma_f32_32x32x16_bf16 v[112:127], v[164:167], v[188:191], v[112:127]
    ds_read_b64_tr_b16 v[180:181], v221 offset:20480
    ds_read_b64_tr_b16 v[182:183], v221 offset:21504
    s_waitcnt lgkmcnt(8)
    v_mfma_f32_32x32x16_bf16 v[128:143], v[168:171], v[184:187], v[128:143]
    v_mfma_f32_32x32x16_bf16 v[144:159], v[168:171], v[188:191], v[144:159]
    s_waitcnt lgkmcnt(5)
    v_mfma_f32_32x32x16_bf16 v[64:79], v[172:175], v[192:195], v[64:79]
    ds_read_b128 v[184:187], v223 offset:19008
    ds_read_b64_tr_b16 v[160:161], v217 offset:32768
    s_waitcnt lgkmcnt(6)
    s_nop 0
    v_mfma_f32_32x32x16_bf16 v[80:95], v[172:175], v[196:199], v[80:95]
    ds_read_b64_tr_b16 v[162:163], v217 offset:33792
    ds_read_b128 v[188:191], v223 offset:23232
    s_waitcnt lgkmcnt(6)
    s_nop 0
    v_mfma_f32_32x32x16_bf16 v[96:111], v[176:179], v[192:195], v[96:111]
    ds_read_b64_tr_b16 v[164:165], v219 offset:32768
    ds_read_b64_tr_b16 v[166:167], v219 offset:33792
    v_mfma_f32_32x32x16_bf16 v[112:127], v[176:179], v[196:199], v[112:127]
    ds_read_b64_tr_b16 v[168:169], v221 offset:32768
    ds_read_b64_tr_b16 v[170:171], v221 offset:33792
    s_waitcnt lgkmcnt(8)
    s_nop 0
    v_mfma_f32_32x32x16_bf16 v[128:143], v[180:183], v[192:195], v[128:143]
    v_mfma_f32_32x32x16_bf16 v[144:159], v[180:183], v[196:199], v[144:159]
    ds_write_b128 v222, v[56:59] offset:0
    v_lshlrev_b32_e64 v200, 16, v60
    v_and_b32 v201, 0xffff0000, v60
    v_lshlrev_b32_e64 v202, 16, v61
    v_and_b32 v203, 0xffff0000, v61
    v_lshlrev_b32_e64 v204, 16, v62
    v_and_b32 v205, 0xffff0000, v62
    v_lshlrev_b32_e64 v206, 16, v63
    v_and_b32 v207, 0xffff0000, v63
    v_fma_f32 v200, v200, v229, v231
    v_fma_f32 v201, v201, v229, v231
    v_fma_f32 v202, v202, v229, v231
    v_fma_f32 v203, v203, v229, v231
    v_fma_f32 v204, v204, v229, v231
    v_fma_f32 v205, v205, v229, v231
    v_fma_f32 v206, v206, v229, v231
    v_fma_f32 v207, v207, v229, v231
    v_cvt_pk_bf16_f32 v60, v200, v201
    v_cvt_pk_bf16_f32 v61, v202, v203
    v_cvt_pk_bf16_f32 v62, v204, v205
    v_cvt_pk_bf16_f32 v63, v206, v207
    ds_write_b128 v222, v[60:63] offset:128
    s_add_u32 s59, s69, 0x7000
    s_add_u32 m0, s58, 0xc000
    s_nop 0
    s_nop 0
    buffer_load_dwordx4 v244, s[48:51], s59 offen lds
    s_add_u32 s59, s69, 0x8c00
    s_add_u32 m0, s58, 0xc400
    s_nop 0
    s_nop 0
    buffer_load_dwordx4 v244, s[48:51], s59 offen lds
    s_add_u32 s59, s69, 0xa800
    s_add_u32 m0, s58, 0xe000
    s_nop 0
    s_nop 0
    buffer_load_dwordx4 v244, s[48:51], s59 offen lds
    s_add_u32 s59, s69, 0xc400
    s_add_u32 m0, s58, 0xe400
    s_nop 0
    s_nop 0
    buffer_load_dwordx4 v244, s[48:51], s59 offen lds
    s_add_u32 s59, s69, 0xe000
    s_add_u32 m0, s58, 0x1a000
    s_nop 0
    s_nop 0
    buffer_load_dwordx4 v244, s[48:51], s59 offen lds
    s_add_u32 s59, s69, 0xfc00
    s_add_u32 m0, s58, 0x1a400
    s_nop 0
    buffer_load_dwordx4 v244, s[48:51], s59 offen lds
    s_waitcnt vmcnt(10) lgkmcnt(0)
    s_barrier
    s_nop 0
    v_mfma_f32_32x32x16_bf16 v[64:79], v[160:163], v[184:187], v[64:79]
    ds_read_b128 v[192:195], v223 offset:20064
    ds_read_b64_tr_b16 v[172:173], v217 offset:36864
    v_mfma_f32_32x32x16_bf16 v[80:95], v[160:163], v[188:191], v[80:95]
    ds_read_b64_tr_b16 v[174:175], v217 offset:37888
    ds_read_b128 v[196:199], v223 offset:24288
    v_mfma_f32_32x32x16_bf16 v[96:111], v[164:167], v[184:187], v[96:111]
    ds_read_b64_tr_b16 v[176:177], v219 offset:36864
    ds_read_b64_tr_b16 v[178:179], v219 offset:37888
    v_mfma_f32_32x32x16_bf16 v[112:127], v[164:167], v[188:191], v[112:127]
    ds_read_b64_tr_b16 v[180:181], v221 offset:36864
    ds_read_b64_tr_b16 v[182:183], v221 offset:37888
    v_mfma_f32_32x32x16_bf16 v[128:143], v[168:171], v[184:187], v[128:143]
    v_mfma_f32_32x32x16_bf16 v[144:159], v[168:171], v[188:191], v[144:159]
    s_waitcnt lgkmcnt(5)
    s_nop 0
    v_mfma_f32_32x32x16_bf16 v[64:79], v[172:175], v[192:195], v[64:79]
    ds_read_b128 v[184:187], v223 offset:0
    ds_read_b64_tr_b16 v[160:161], v216 offset:0
    s_waitcnt lgkmcnt(6)
    s_nop 0
    v_mfma_f32_32x32x16_bf16 v[80:95], v[172:175], v[196:199], v[80:95]
    ds_read_b64_tr_b16 v[162:163], v216 offset:1024
    ds_read_b128 v[188:191], v223 offset:4224
    s_waitcnt lgkmcnt(6)
    s_nop 0
    v_mfma_f32_32x32x16_bf16 v[96:111], v[176:179], v[192:195], v[96:111]
    ds_read_b64_tr_b16 v[164:165], v218 offset:0
    ds_read_b64_tr_b16 v[166:167], v218 offset:1024
    v_mfma_f32_32x32x16_bf16 v[112:127], v[176:179], v[196:199], v[112:127]
    ds_read_b64_tr_b16 v[168:169], v220 offset:0
    ds_read_b64_tr_b16 v[170:171], v220 offset:1024
    s_waitcnt lgkmcnt(8)
    v_mfma_f32_32x32x16_bf16 v[128:143], v[180:183], v[192:195], v[128:143]
    v_mfma_f32_32x32x16_bf16 v[144:159], v[180:183], v[196:199], v[144:159]
    s_mov_b32 s52, s22
    s_and_b32 s53, s23, 0xffff
    s_mov_b32 s54, 0x100
    s_mov_b32 s55, 0x20000
    v_lshlrev_b32_e64 v235, 2, v0
    buffer_load_dword v234, v235, s[52:55], 0 offen sc1
    s_add_u32 s59, s69, 0x11800
    s_add_u32 m0, s58, 0x10000
    s_nop 0
    s_nop 0
    buffer_load_dwordx4 v244, s[48:51], s59 offen lds
    s_add_u32 s59, s69, 0x13400
    s_add_u32 m0, s58, 0x10400
    s_nop 0
    s_nop 0
    buffer_load_dwordx4 v244, s[48:51], s59 offen lds
    s_add_u32 s59, s69, 0x15000
    s_add_u32 m0, s58, 0x12000
    s_nop 0
    s_nop 0
    buffer_load_dwordx4 v244, s[48:51], s59 offen lds
    s_add_u32 s59, s69, 0x16c00
    s_add_u32 m0, s58, 0x12400
    s_nop 0
    buffer_load_dwordx4 v244, s[48:51], s59 offen lds
    s_barrier
    s_waitcnt lgkmcnt(5)
    s_nop 0
    v_mfma_f32_32x32x16_bf16 v[64:79], v[160:163], v[184:187], v[64:79]
    ds_read_b128 v[192:195], v223 offset:1056
    ds_read_b64_tr_b16 v[172:173], v216 offset:4096
    s_waitcnt lgkmcnt(6)
    s_nop 0
    v_mfma_f32_32x32x16_bf16 v[80:95], v[160:163], v[188:191], v[80:95]
    ds_read_b64_tr_b16 v[174:175], v216 offset:5120
    ds_read_b128 v[196:199], v223 offset:5280
    s_waitcnt lgkmcnt(6)
    s_nop 0
    v_mfma_f32_32x32x16_bf16 v[96:111], v[164:167], v[184:187], v[96:111]
    ds_read_b64_tr_b16 v[176:177], v218 offset:4096
    ds_read_b64_tr_b16 v[178:179], v218 offset:5120
    v_mfma_f32_32x32x16_bf16 v[112:127], v[164:167], v[188:191], v[112:127]
    ds_read_b64_tr_b16 v[180:181], v220 offset:4096
    ds_read_b64_tr_b16 v[182:183], v220 offset:5120
    s_waitcnt lgkmcnt(8)
    v_mfma_f32_32x32x16_bf16 v[128:143], v[168:171], v[184:187], v[128:143]
    v_mfma_f32_32x32x16_bf16 v[144:159], v[168:171], v[188:191], v[144:159]
    s_waitcnt lgkmcnt(5)
    v_mfma_f32_32x32x16_bf16 v[64:79], v[172:175], v[192:195], v[64:79]
    ds_read_b128 v[184:187], v223 offset:2112
    ds_read_b64_tr_b16 v[160:161], v216 offset:16384
    s_waitcnt lgkmcnt(6)
    s_nop 0
    v_mfma_f32_32x32x16_bf16 v[80:95], v[172:175], v[196:199], v[80:95]
    ds_read_b64_tr_b16 v[162:163], v216 offset:17408
    ds_read_b128 v[188:191], v223 offset:6336
    s_waitcnt lgkmcnt(6)
    s_nop 0
    v_mfma_f32_32x32x16_bf16 v[96:111], v[176:179], v[192:195], v[96:111]
    ds_read_b64_tr_b16 v[164:165], v218 offset:16384
    ds_read_b64_tr_b16 v[166:167], v218 offset:17408
    v_mfma_f32_32x32x16_bf16 v[112:127], v[176:179], v[196:199], v[112:127]
    ds_read_b64_tr_b16 v[168:169], v220 offset:16384
    ds_read_b64_tr_b16 v[170:171], v220 offset:17408
    s_waitcnt lgkmcnt(8)
    v_mfma_f32_32x32x16_bf16 v[128:143], v[180:183], v[192:195], v[128:143]
    v_mfma_f32_32x32x16_bf16 v[144:159], v[180:183], v[196:199], v[144:159]
    v_mov_b32 v208, 0
    v_mov_b32 v209, 0x26000
    ds_write_b32 v209, v208
    s_add_u32 s59, s69, 0x18800
    s_add_u32 m0, s58, 0x14000
    s_nop 0
    s_nop 0
    buffer_load_dwordx4 v244, s[48:51], s59 offen lds
    s_add_u32 s59, s69, 0x1a400
    s_add_u32 m0, s58, 0x14400
    s_nop 0
    s_nop 0
    buffer_load_dwordx4 v244, s[48:51], s59 offen lds
    s_add_u32 s59, s69, 0x1c000
    s_add_u32 m0, s58, 0x16000
    s_nop 0
    s_nop 0
    buffer_load_dwordx4 v244, s[48:51], s59 offen lds
    s_add_u32 s59, s69, 0x1dc00
    s_add_u32 m0, s58, 0x16400
    s_nop 0
    s_nop 0
    buffer_load_dwordx4 v244, s[48:51], s59 offen lds
    s_add_u32 s59, s69, 0x1f800
    s_add_u32 m0, s58, 0x1c000
    s_nop 0
    s_nop 0
    buffer_load_dwordx4 v244, s[48:51], s59 offen lds
    s_add_u32 s59, s69, 0x21400
    s_add_u32 m0, s58, 0x1c400
    s_nop 0
    buffer_load_dwordx4 v244, s[48:51], s59 offen lds
    s_waitcnt lgkmcnt(0)
    s_barrier
    s_nop 0
    v_mfma_f32_32x32x16_bf16 v[64:79], v[160:163], v[184:187], v[64:79]
    ds_read_b128 v[192:195], v223 offset:3168
    ds_read_b64_tr_b16 v[172:173], v216 offset:20480
    v_mfma_f32_32x32x16_bf16 v[80:95], v[160:163], v[188:191], v[80:95]
    ds_read_b64_tr_b16 v[174:175], v216 offset:21504
    ds_read_b128 v[196:199], v223 offset:7392
    v_mfma_f32_32x32x16_bf16 v[96:111], v[164:167], v[184:187], v[96:111]
    ds_read_b64_tr_b16 v[176:177], v218 offset:20480
    ds_read_b64_tr_b16 v[178:179], v218 offset:21504
    v_mfma_f32_32x32x16_bf16 v[112:127], v[164:167], v[188:191], v[112:127]
    ds_read_b64_tr_b16 v[180:181], v220 offset:20480
    ds_read_b64_tr_b16 v[182:183], v220 offset:21504
    v_mfma_f32_32x32x16_bf16 v[128:143], v[168:171], v[184:187], v[128:143]
    v_mfma_f32_32x32x16_bf16 v[144:159], v[168:171], v[188:191], v[144:159]
    s_waitcnt lgkmcnt(5)
    v_mfma_f32_32x32x16_bf16 v[64:79], v[172:175], v[192:195], v[64:79]
    s_waitcnt lgkmcnt(4)
    v_mfma_f32_32x32x16_bf16 v[80:95], v[172:175], v[196:199], v[80:95]
    s_waitcnt lgkmcnt(2)
    v_mfma_f32_32x32x16_bf16 v[96:111], v[176:179], v[192:195], v[96:111]
    v_mfma_f32_32x32x16_bf16 v[112:127], v[176:179], v[196:199], v[112:127]
    s_waitcnt lgkmcnt(0)
    v_mfma_f32_32x32x16_bf16 v[128:143], v[180:183], v[192:195], v[128:143]
    v_mfma_f32_32x32x16_bf16 v[144:159], v[180:183], v[196:199], v[144:159]
    s_add_u32 s59, s69, 0x23000
    s_add_u32 m0, s58, 0
    s_nop 0
    buffer_load_dwordx4 v244, s[48:51], s59 offen lds
    s_add_u32 s59, s69, 0x24c00
    s_add_u32 m0, s58, 0x400
    s_nop 0
    s_nop 0
    buffer_load_dwordx4 v244, s[48:51], s59 offen lds
    s_add_u32 s59, s69, 0x26800
    s_add_u32 m0, s58, 0x2000
    s_nop 0
    s_nop 0
    buffer_load_dwordx4 v244, s[48:51], s59 offen lds
    s_add_u32 s59, s69, 0x28400
    s_add_u32 m0, s58, 0x2400
    s_nop 0
    buffer_load_dwordx4 v244, s[48:51], s59 offen lds
    s_barrier
    s_waitcnt vmcnt(14)
    v_mov_b32 v234, v234
    v_cmp_ne_u32 vcc, 1, v234
    s_nop 4
    s_cbranch_vccz SP_Z_Q0_OK
    s_mov_b32 s61, 0
SP_Z_Q0:
    buffer_load_dword v234, v235, s[52:55], 0 offen sc1
    s_add_u32 s61, s61, 1
    s_cmp_gt_u32 s61, 0x20000
    s_cbranch_scc1 SP_Z_Q0_OK
    s_waitcnt vmcnt(0)
    v_cmp_ne_u32 vcc, 1, v234
    s_nop 4
    s_cbranch_vccz SP_Z_Q0_OK
    s_sleep 4
    s_branch SP_Z_Q0
SP_Z_Q0_OK:
    v_mov_b32 v56, 0xbdd2d3e8
    v_mov_b32 v57, 0xc0135761
    v_mov_b32_e64 v241, 1
    v_mov_b32 v240, 0x7fff0000
    v_cmp_eq_u32 vcc, 0, v0
    s_nop 1
    v_cndmask_b32 v242, v240, 0, vcc
    s_mov_b32 s36, s10
    s_nop 0
    s_and_b32 s37, s11, 0xffff
    s_mov_b32 s38, 0x62000
    s_mov_b32 s39, 0x20000
    s_mov_b32 s40, s20
    s_nop 0
    s_and_b32 s41, s21, 0xffff
    s_mov_b32 s42, 0x1c0000
    s_mov_b32 s43, 0x20000
    s_lshl_b32 s60, s68, 7
    s_mul_i32 s66, s3, 0x18800
    s_add_u32 s66, s66, s60
    v_cmp_gt_u32 vcc, 32, v0
    s_nop 1
    v_cndmask_b32 v245, v240, v244, vcc
    s_nop 0
    v_bfe_u32 v1, v0, 2, 2
    v_lshl_add_u32 v1, v237, 2, v1
    v_bfe_u32 v2, v0, 4, 1
    v_and_b32 v3, 3, v0
    v_lshlrev_b32 v3, 3, v3
    v_lshl_add_u32 v2, v2, 5, v3
    v_bfe_u32 v3, v0, 3, 1
    v_lshlrev_b32 v3, 6, v3
    v_xor_b32 v2, v2, v3
    v_lshl_add_u32 v246, v1, 7, v2
    v_add_u32 v246, s58, v246
    v_xor_b32 v238, 64, v246
    v_add_u32 v247, 0xe000, v246
    v_add_u32 v239, 0xe000, v238
    s_add_u32 s63, s70, 0x8000
    s_add_u32 s78, s70, 0x1000
    s_add_u32 s79, s63, 0x1000
    s_add_u32 s59, s69, 0x2a000
    s_add_u32 m0, s58, 0x4000
    s_nop 0
    s_nop 0
    buffer_load_dwordx4 v244, s[48:51], s59 offen lds
    v_cvt_pk_bf16_f32 v160, v64, v65
    v_cvt_pk_bf16_f32 v161, v66, v67
    v_cvt_pk_bf16_f32 v162, v68, v69
    v_cvt_pk_bf16_f32 v163, v70, v71
    v_cvt_pk_bf16_f32 v164, v72, v73
    s_add_u32 s59, s69, 0x2bc00
    s_add_u32 m0, s58, 0x4400
    s_nop 0
    s_nop 0
    buffer_load_dwordx4 v244, s[48:51], s59 offen lds
    v_cvt_pk_bf16_f32 v165, v74, v75
    v_cvt_pk_bf16_f32 v166, v76, v77
    v_cvt_pk_bf16_f32 v167, v78, v79
    buffer_store_dwordx4 v[160:163], v227, s[44:47], s70 offen offset:0 sc1
    buffer_store_dwordx4 v[164:167], v227, s[44:47], s70 offen offset:1024 sc1
    s_add_u32 s59, s69, 0x2d800
    s_add_u32 m0, s58, 0x6000
    s_nop 0
    s_nop 0
    buffer_load_dwordx4 v244, s[48:51], s59 offen lds
    v_cvt_pk_bf16_f32 v168, v80, v81
    v_cvt_pk_bf16_f32 v169, v82, v83
    v_cvt_pk_bf16_f32 v170, v84, v85
    v_cvt_pk_bf16_f32 v171, v86, v87
    v_cvt_pk_bf16_f32 v172, v88, v89
    s_add_u32 s59, s69, 0x2f400
    s_add_u32 m0, s58, 0x6400
    s_nop 0
    s_nop 0
    buffer_load_dwordx4 v244, s[48:51], s59 offen lds
    v_cvt_pk_bf16_f32 v173, v90, v91
    v_cvt_pk_bf16_f32 v174, v92, v93
    v_cvt_pk_bf16_f32 v175, v94, v95
    buffer_store_dwordx4 v[168:171], v227, s[44:47], s63 offen offset:0 sc1
    buffer_store_dwordx4 v[172:175], v227, s[44:47], s63 offen offset:1024 sc1
    s_add_u32 s59, s69, 0x31000
    s_add_u32 m0, s58, 0x18000
    s_nop 0
    s_nop 0
    buffer_load_dwordx4 v244, s[48:51], s59 offen lds
    v_cvt_pk_bf16_f32 v176, v96, v97
    v_cvt_pk_bf16_f32 v177, v98, v99
    v_cvt_pk_bf16_f32 v178, v100, v101
    v_cvt_pk_bf16_f32 v179, v102, v103
    v_cvt_pk_bf16_f32 v180, v104, v105
    s_add_u32 s59, s69, 0x32c00
    s_add_u32 m0, s58, 0x18400
    s_nop 0
    s_nop 0
    buffer_load_dwordx4 v244, s[48:51], s59 offen lds
    v_cvt_pk_bf16_f32 v181, v106, v107
    v_cvt_pk_bf16_f32 v182, v108, v109
    v_cvt_pk_bf16_f32 v183, v110, v111
    buffer_store_dwordx4 v[176:179], v227, s[44:47], s70 offen offset:2048 sc1
    buffer_store_dwordx4 v[180:183], v227, s[44:47], s70 offen offset:3072 sc1
    v_cvt_pk_bf16_f32 v184, v112, v113
    v_cvt_pk_bf16_f32 v185, v114, v115
    v_cvt_pk_bf16_f32 v186, v116, v117
    v_cvt_pk_bf16_f32 v187, v118, v119
    v_cvt_pk_bf16_f32 v188, v120, v121
    v_cvt_pk_bf16_f32 v189, v122, v123
    v_cvt_pk_bf16_f32 v190, v124, v125
    v_cvt_pk_bf16_f32 v191, v126, v127
    buffer_store_dwordx4 v[184:187], v227, s[44:47], s63 offen offset:2048 sc1
    buffer_store_dwordx4 v[188:191], v227, s[44:47], s63 offen offset:3072 sc1
    v_cvt_pk_bf16_f32 v160, v128, v129
    v_cvt_pk_bf16_f32 v161, v130, v131
    v_cvt_pk_bf16_f32 v162, v132, v133
    v_cvt_pk_bf16_f32 v163, v134, v135
    v_cvt_pk_bf16_f32 v164, v136, v137
    v_cvt_pk_bf16_f32 v165, v138, v139
    v_cvt_pk_bf16_f32 v166, v140, v141
    v_cvt_pk_bf16_f32 v167, v142, v143
    buffer_store_dwordx4 v[160:163], v227, s[44:47], s78 offen offset:0 sc1
    buffer_store_dwordx4 v[164:167], v227, s[44:47], s78 offen offset:1024 sc1
    v_cvt_pk_bf16_f32 v168, v144, v145
    v_cvt_pk_bf16_f32 v169, v146, v147
    v_cvt_pk_bf16_f32 v170, v148, v149
    v_cvt_pk_bf16_f32 v171, v150, v151
    v_cvt_pk_bf16_f32 v172, v152, v153
    v_cvt_pk_bf16_f32 v173, v154, v155
    v_cvt_pk_bf16_f32 v174, v156, v157
    v_cvt_pk_bf16_f32 v175, v158, v159
    buffer_store_dwordx4 v[168:171], v227, s[44:47], s79 offen offset:0 sc1
    buffer_store_dwordx4 v[172:175], v227, s[44:47], s79 offen offset:1024 sc1
    s_lshl_b32 s60, s26, 1
    s_and_b32 s61, s3, 1
    s_add_u32 s60, s60, s61
    s_lshl_b32 s60, s60, 8
    s_lshl_b32 s61, s27, 2
    s_lshr_b32 s62, s3, 1
    s_add_u32 s61, s61, s62
    s_lshl_b32 s61, s61, 2
    s_add_u32 s60, s60, s61
    s_add_u32 s60, s60, 0x1100000
    s_waitcnt vmcnt(0)
    buffer_store_dword v241, v242, s[44:47], s60 offen sc1
    s_cmp_lt_u32 s2, 32
    s_cbranch_scc1 P2_END_Q0
    s_mul_i32 s60, s3, 0x7000
    s_mul_i32 s61, s67, 0x48000
    s_add_u32 s70, s61, s60
    s_add_u32 s71, s70, 0x24000
    s_lshl_b32 s60, s3, 13
    s_add_u32 s60, s60, 0x1c000
    s_add_u32 s73, s61, s60
    s_add_u32 s74, s73, 0x24000
    v_add_u32 v56, 0, v227
    v_add_u32 v57, 0x1000, v227
    v_add_u32 v58, 0x2000, v227
    v_add_u32 v59, 0x3000, v227
    v_add_u32 v60, 0x4000, v227
    v_add_u32 v61, 0x5000, v227
    v_add_u32 v62, 0x6000, v227
    s_mov_b32 s28, s4
    s_nop 0
    s_and_b32 s29, s5, 0xffff
    s_mov_b32 s30, 0x1c0000
    s_mov_b32 s31, 0x20000
    s_lshl_b32 s60, s3, 6
    v_add_u32 v1, s60, v0
    v_lshrrev_b32 v2, 3, v1
    v_and_b32 v3, 7, v1
    s_lshl_b32 s60, s67, 6
    v_add_u32 v230, s60, v2
    v_mul_u32_u24 v230, 0x380, v230
    v_lshl_add_u32 v230, v3, 4, v230
    s_lshl_b32 s60, s68, 7
    v_add_u32 v230, s60, v230
    v_mul_u32_u24 v231, 0x110, v2
    v_lshl_add_u32 v231, v3, 5, v231
    v_mul_u32_u24 v232, 0x110, v236
    v_lshl_add_u32 v232, v237, 4, v232
    s_mul_i32 s60, s3, 0x4400
    v_add_u32 v232, s60, v232
    v_lshlrev_b32 v229, 2, v0
    s_mul_i32 s60, s3, 7
    s_lshr_b32 s60, s60, 1
    s_lshl_b32 s60, s60, 2
    s_mov_b32 s56, 0xffff
    s_mov_b32 s57, 0
    s_lshl_b64 s[56:57], s[56:57], s60
    s_lshl_b32 s75, s67, 8
    s_add_u32 s75, s75, 0x1100000
    s_mov_b32 s77, 0x7000
    buffer_load_dwordx4 v[248:251], v230, s[28:31], 0 offen
    buffer_load_dwordx4 v[252:255], v230, s[28:31], s77 offen
    ds_read_b64_tr_b16 v[128:129], v246 offset:32768
    ds_read_b64_tr_b16 v[130:131], v246 offset:33792
    ds_read_b64_tr_b16 v[132:133], v238 offset:32768
    ds_read_b64_tr_b16 v[134:135], v238 offset:33792
    ds_read_b64_tr_b16 v[136:137], v246 offset:40960
    ds_read_b64_tr_b16 v[138:139], v246 offset:41984
    ds_read_b64_tr_b16 v[140:141], v238 offset:40960
    ds_read_b64_tr_b16 v[142:143], v238 offset:41984
    s_waitcnt lgkmcnt(4)
    s_add_u32 s59, s69, 0x34800
    s_add_u32 m0, s58, 0x8000
    s_nop 0
    buffer_load_dwordx4 v244, s[48:51], s59 offen lds
    s_add_u32 s59, s69, 0x36400
    s_add_u32 m0, s58, 0x8400
    s_nop 0
    s_nop 0
    buffer_load_dwordx4 v244, s[48:51], s59 offen lds
    ds_read_b64_tr_b16 v[144:145], v246 offset:49152
    ds_read_b64_tr_b16 v[146:147], v246 offset:50176
    ds_read_b64_tr_b16 v[148:149], v238 offset:49152
    ds_read_b64_tr_b16 v[150:151], v238 offset:50176
    s_waitcnt lgkmcnt(4)
    s_add_u32 s59, s69, 0x38000
    s_add_u32 m0, s58, 0xa000
    s_nop 0
    buffer_load_dwordx4 v244, s[48:51], s59 offen lds
    s_add_u32 s59, s69, 0x39c00
    s_add_u32 m0, s58, 0xa400
    s_nop 0
    s_nop 0
    buffer_load_dwordx4 v244, s[48:51], s59 offen lds
    ds_read_b64_tr_b16 v[152:153], v247 offset:0
    ds_read_b64_tr_b16 v[154:155], v247 offset:1024
    ds_read_b64_tr_b16 v[156:157], v239 offset:0
    ds_read_b64_tr_b16 v[158:159], v239 offset:1024
    s_waitcnt lgkmcnt(4)
    s_add_u32 s59, s69, 0x3b800
    s_add_u32 m0, s58, 0xc000
    s_nop 0
    buffer_load_dwordx4 v244, s[48:51], s59 offen lds
    s_add_u32 s59, s69, 0x3d400
    s_add_u32 m0, s58, 0xc400
    s_nop 0
    s_nop 0
    buffer_load_dwordx4 v244, s[48:51], s59 offen lds
    ds_read_b64_tr_b16 v[160:161], v247 offset:49152
    ds_read_b64_tr_b16 v[162:163], v247 offset:50176
    ds_read_b64_tr_b16 v[164:165], v239 offset:49152
    ds_read_b64_tr_b16 v[166:167], v239 offset:50176
    s_waitcnt lgkmcnt(4)
    s_add_u32 s59, s69, 0x3f000
    s_add_u32 m0, s58, 0xe000
    s_nop 0
    buffer_load_dwordx4 v244, s[48:51], s59 offen lds
    s_add_u32 s59, s69, 0x40c00
    s_add_u32 m0, s58, 0xe400
    s_nop 0
    s_nop 0
    buffer_load_dwordx4 v244, s[48:51], s59 offen lds
    ds_read_b64_tr_b16 v[168:169], v247 offset:8192
    ds_read_b64_tr_b16 v[170:171], v247 offset:9216
    ds_read_b64_tr_b16 v[172:173], v239 offset:8192
    ds_read_b64_tr_b16 v[174:175], v239 offset:9216
    s_waitcnt lgkmcnt(4)
    s_add_u32 s59, s69, 0x42800
    s_add_u32 m0, s58, 0x1a000
    s_nop 0
    buffer_load_dwordx4 v244, s[48:51], s59 offen lds
    s_add_u32 s59, s69, 0x44400
    s_add_u32 m0, s58, 0x1a400
    s_nop 0
    s_nop 0
    buffer_load_dwordx4 v244, s[48:51], s59 offen lds
    ds_read_b64_tr_b16 v[176:177], v247 offset:16384
    ds_read_b64_tr_b16 v[178:179], v247 offset:17408
    ds_read_b64_tr_b16 v[180:181], v239 offset:16384
    ds_read_b64_tr_b16 v[182:183], v239 offset:17408
    s_waitcnt lgkmcnt(4)
    s_add_u32 s59, s69, 0x46000
    s_add_u32 m0, s58, 0x10000
    s_nop 0
    buffer_load_dwordx4 v244, s[48:51], s59 offen lds
    s_add_u32 s59, s69, 0x47c00
    s_add_u32 m0, s58, 0x10400
    s_nop 0
    s_nop 0
    buffer_load_dwordx4 v244, s[48:51], s59 offen lds
    ds_read_b64_tr_b16 v[184:185], v247 offset:24576
    ds_read_b64_tr_b16 v[186:187], v247 offset:25600
    ds_read_b64_tr_b16 v[188:189], v239 offset:24576
    ds_read_b64_tr_b16 v[190:191], v239 offset:25600
    s_waitcnt lgkmcnt(4)
    s_add_u32 s59, s69, 0x49800
    s_add_u32 m0, s58, 0x12000
    s_nop 0
    buffer_load_dwordx4 v244, s[48:51], s59 offen lds
    s_add_u32 s59, s69, 0x4b400
    s_add_u32 m0, s58, 0x12400
    s_nop 0
    s_nop 0
    buffer_load_dwordx4 v244, s[48:51], s59 offen lds
    ds_read_b64_tr_b16 v[192:193], v247 offset:32768
    ds_read_b64_tr_b16 v[194:195], v247 offset:33792
    ds_read_b64_tr_b16 v[196:197], v239 offset:32768
    ds_read_b64_tr_b16 v[198:199], v239 offset:33792
    s_waitcnt lgkmcnt(4)
    s_add_u32 s59, s69, 0x4d000
    s_add_u32 m0, s58, 0x14000
    s_nop 0
    buffer_load_dwordx4 v244, s[48:51], s59 offen lds
    s_add_u32 s59, s69, 0x4ec00
    s_add_u32 m0, s58, 0x14400
    s_nop 0
    s_nop 0
    buffer_load_dwordx4 v244, s[48:51], s59 offen lds
    ds_read_b64_tr_b16 v[200:201], v247 offset:57344
    ds_read_b64_tr_b16 v[202:203], v247 offset:58368
    ds_read_b64_tr_b16 v[204:205], v239 offset:57344
    ds_read_b64_tr_b16 v[206:207], v239 offset:58368
    s_waitcnt lgkmcnt(4)
    s_add_u32 s59, s69, 0x50800
    s_add_u32 m0, s58, 0x16000
    s_nop 0
    buffer_load_dwordx4 v244, s[48:51], s59 offen lds
    s_add_u32 s59, s69, 0x52400
    s_add_u32 m0, s58, 0x16400
    s_nop 0
    s_nop 0
    buffer_load_dwordx4 v244, s[48:51], s59 offen lds
    ds_read_b64_tr_b16 v[208:209], v246 offset:0
    ds_read_b64_tr_b16 v[210:211], v246 offset:1024
    ds_read_b64_tr_b16 v[212:213], v238 offset:0
    ds_read_b64_tr_b16 v[214:215], v238 offset:1024
    s_waitcnt lgkmcnt(4)
    s_add_u32 s59, s69, 0x54000
    s_add_u32 m0, s58, 0x1c000
    s_nop 0
    buffer_load_dwordx4 v244, s[48:51], s59 offen lds
    s_add_u32 s59, s69, 0x55c00
    s_add_u32 m0, s58, 0x1c400
    s_nop 0
    s_nop 0
    buffer_load_dwordx4 v244, s[48:51], s59 offen lds
    ds_read_b64_tr_b16 v[216:217], v246 offset:8192
    ds_read_b64_tr_b16 v[218:219], v246 offset:9216
    ds_read_b64_tr_b16 v[220:221], v238 offset:8192
    ds_read_b64_tr_b16 v[222:223], v238 offset:9216
    s_waitcnt lgkmcnt(4)
    s_add_u32 s59, s69, 0x57800
    s_add_u32 m0, s58, 0
    s_nop 0
    s_nop 0
    buffer_load_dwordx4 v244, s[48:51], s59 offen lds
    s_add_u32 s59, s69, 0x59400
    s_add_u32 m0, s58, 0x400
    s_nop 0
    buffer_load_dwordx4 v244, s[48:51], s59 offen lds
    s_waitcnt lgkmcnt(0)
    s_add_u32 s59, s69, 0x5b000
    s_add_u32 m0, s58, 0x2000
    s_nop 0
    s_nop 0
    buffer_load_dwordx4 v244, s[48:51], s59 offen lds
    s_add_u32 s59, s69, 0x5cc00
    s_add_u32 m0, s58, 0x2400
    s_nop 0
    buffer_load_dwordx4 v244, s[48:51], s59 offen lds
    s_mov_b32 s61, 0
SP_H_Q0:
    buffer_load_dword v228, v229, s[44:47], s75 offen sc1
    s_add_u32 s61, s61, 1
    s_cmp_gt_u32 s61, 0x20000
    s_cbranch_scc1 SP_H_Q0_OK
    s_waitcnt vmcnt(0)
    v_cmp_ne_u32 vcc, 1, v228
    s_nop 4
    s_and_b64 vcc, vcc, s[56:57]
    s_cbranch_vccz SP_H_Q0_OK
    s_sleep 4
    s_branch SP_H_Q0
SP_H_Q0_OK:
    s_lshl_b32 s75, s67, 7
    s_add_u32 s75, s75, 0x1103000
    v_lshlrev_b32_e64 v229, 2, v236
    buffer_load_dwordx4 v[8:11], v56, s[44:47], s70 offen offset:0 sc1
    buffer_load_dwordx4 v[12:15], v56, s[44:47], s71 offen offset:0 sc1
    buffer_load_dwordx4 v[16:19], v56, s[44:47], s70 offen offset:1024 sc1
    buffer_load_dwordx4 v[20:23], v56, s[44:47], s71 offen offset:1024 sc1
    buffer_load_dwordx4 v[24:27], v56, s[44:47], s70 offen offset:2048 sc1
    buffer_load_dwordx4 v[28:31], v56, s[44:47], s71 offen offset:2048 sc1
    buffer_load_dwordx4 v[32:35], v56, s[44:47], s70 offen offset:3072 sc1
    buffer_load_dwordx4 v[36:39], v56, s[44:47], s71 offen offset:3072 sc1
    s_waitcnt vmcnt(7)
    v_mfma_f32_32x32x16_bf16 v[64:79], v[128:131], v[8:11], 0
    v_mfma_f32_32x32x16_bf16 v[80:95], v[132:135], v[8:11], 0
    s_waitcnt vmcnt(6)
    v_mfma_f32_32x32x16_bf16 v[96:111], v[128:131], v[12:15], 0
    v_mfma_f32_32x32x16_bf16 v[112:127], v[132:135], v[12:15], 0
    buffer_load_dwordx4 v[8:11], v57, s[44:47], s70 offen offset:0 sc1
    buffer_load_dwordx4 v[12:15], v57, s[44:47], s71 offen offset:0 sc1
    buffer_load_dwordx4 v[128:131], v57, s[44:47], s70 offen offset:1024 sc1
    buffer_load_dwordx4 v[132:135], v57, s[44:47], s71 offen offset:1024 sc1
    s_waitcnt vmcnt(9)
    v_mfma_f32_32x32x16_bf16 v[64:79], v[136:139], v[16:19], v[64:79]
    v_mfma_f32_32x32x16_bf16 v[80:95], v[140:143], v[16:19], v[80:95]
    s_waitcnt vmcnt(8)
    v_mfma_f32_32x32x16_bf16 v[96:111], v[136:139], v[20:23], v[96:111]
    v_mfma_f32_32x32x16_bf16 v[112:127], v[140:143], v[20:23], v[112:127]
    buffer_load_dwordx4 v[16:19], v57, s[44:47], s70 offen offset:2048 sc1
    buffer_load_dwordx4 v[20:23], v57, s[44:47], s71 offen offset:2048 sc1
    buffer_load_dwordx4 v[136:139], v57, s[44:47], s70 offen offset:3072 sc1
    buffer_load_dwordx4 v[140:143], v57, s[44:47], s71 offen offset:3072 sc1
    s_waitcnt vmcnt(11)
    v_mfma_f32_32x32x16_bf16 v[64:79], v[144:147], v[24:27], v[64:79]
    v_mfma_f32_32x32x16_bf16 v[80:95], v[148:151], v[24:27], v[80:95]
    s_waitcnt vmcnt(10)
    v_mfma_f32_32x32x16_bf16 v[96:111], v[144:147], v[28:31], v[96:111]
    v_mfma_f32_32x32x16_bf16 v[112:127], v[148:151], v[28:31], v[112:127]
    buffer_load_dwordx4 v[24:27], v58, s[44:47], s70 offen offset:0 sc1
    buffer_load_dwordx4 v[28:31], v58, s[44:47], s71 offen offset:0 sc1
    buffer_load_dwordx4 v[144:147], v58, s[44:47], s70 offen offset:1024 sc1
    buffer_load_dwordx4 v[148:151], v58, s[44:47], s71 offen offset:1024 sc1
    s_waitcnt vmcnt(13)
    v_mfma_f32_32x32x16_bf16 v[64:79], v[152:155], v[32:35], v[64:79]
    v_mfma_f32_32x32x16_bf16 v[80:95], v[156:159], v[32:35], v[80:95]
    s_waitcnt vmcnt(12)
    v_mfma_f32_32x32x16_bf16 v[96:111], v[152:155], v[36:39], v[96:111]
    v_mfma_f32_32x32x16_bf16 v[112:127], v[156:159], v[36:39], v[112:127]
    buffer_load_dwordx4 v[32:35], v58, s[44:47], s70 offen offset:2048 sc1
    buffer_load_dwordx4 v[36:39], v58, s[44:47], s71 offen offset:2048 sc1
    buffer_load_dwordx4 v[152:155], v58, s[44:47], s70 offen offset:3072 sc1
    buffer_load_dwordx4 v[156:159], v58, s[44:47], s71 offen offset:3072 sc1
    s_waitcnt vmcnt(15)
    v_mfma_f32_32x32x16_bf16 v[64:79], v[160:163], v[8:11], v[64:79]
    v_mfma_f32_32x32x16_bf16 v[80:95], v[164:167], v[8:11], v[80:95]
    s_waitcnt vmcnt(14)
    v_mfma_f32_32x32x16_bf16 v[96:111], v[160:163], v[12:15], v[96:111]
    v_mfma_f32_32x32x16_bf16 v[112:127], v[164:167], v[12:15], v[112:127]
    buffer_load_dwordx4 v[8:11], v59, s[44:47], s70 offen offset:0 sc1
    buffer_load_dwordx4 v[12:15], v59, s[44:47], s71 offen offset:0 sc1
    s_waitcnt vmcnt(15)
    v_mfma_f32_32x32x16_bf16 v[64:79], v[168:171], v[128:131], v[64:79]
    v_mfma_f32_32x32x16_bf16 v[80:95], v[172:175], v[128:131], v[80:95]
    s_waitcnt vmcnt(14)
    v_mfma_f32_32x32x16_bf16 v[96:111], v[168:171], v[132:135], v[96:111]
    v_mfma_f32_32x32x16_bf16 v[112:127], v[172:175], v[132:135], v[112:127]
    buffer_load_dwordx4 v[160:163], v59, s[44:47], s70 offen offset:1024 sc1
    buffer_load_dwordx4 v[164:167], v59, s[44:47], s71 offen offset:1024 sc1
    s_waitcnt vmcnt(15)
    v_mfma_f32_32x32x16_bf16 v[64:79], v[176:179], v[16:19], v[64:79]
    v_mfma_f32_32x32x16_bf16 v[80:95], v[180:183], v[16:19], v[80:95]
    s_waitcnt vmcnt(14)
    v_mfma_f32_32x32x16_bf16 v[96:111], v[176:179], v[20:23], v[96:111]
    v_mfma_f32_32x32x16_bf16 v[112:127], v[180:183], v[20:23], v[112:127]
    buffer_load_dwordx4 v[128:131], v59, s[44:47], s70 offen offset:2048 sc1
    buffer_load_dwordx4 v[132:135], v59, s[44:47], s71 offen offset:2048 sc1
    s_waitcnt vmcnt(15)
    v_mfma_f32_32x32x16_bf16 v[64:79], v[184:187], v[136:139], v[64:79]
    v_mfma_f32_32x32x16_bf16 v[80:95], v[188:191], v[136:139], v[80:95]
    s_waitcnt vmcnt(14)
    v_mfma_f32_32x32x16_bf16 v[96:111], v[184:187], v[140:143], v[96:111]
    v_mfma_f32_32x32x16_bf16 v[112:127], v[188:191], v[140:143], v[112:127]
    buffer_load_dwordx4 v[168:171], v59, s[44:47], s70 offen offset:3072 sc1
    buffer_load_dwordx4 v[172:175], v59, s[44:47], s71 offen offset:3072 sc1
    s_waitcnt vmcnt(15)
    v_mfma_f32_32x32x16_bf16 v[64:79], v[192:195], v[24:27], v[64:79]
    v_mfma_f32_32x32x16_bf16 v[80:95], v[196:199], v[24:27], v[80:95]
    s_waitcnt vmcnt(14)
    v_mfma_f32_32x32x16_bf16 v[96:111], v[192:195], v[28:31], v[96:111]
    v_mfma_f32_32x32x16_bf16 v[112:127], v[196:199], v[28:31], v[112:127]
    buffer_load_dwordx4 v[16:19], v60, s[44:47], s70 offen offset:0 sc1
    buffer_load_dwordx4 v[20:23], v60, s[44:47], s71 offen offset:0 sc1
    s_waitcnt vmcnt(15)
    v_mfma_f32_32x32x16_bf16 v[64:79], v[200:203], v[144:147], v[64:79]
    v_mfma_f32_32x32x16_bf16 v[80:95], v[204:207], v[144:147], v[80:95]
    s_waitcnt vmcnt(14)
    v_mfma_f32_32x32x16_bf16 v[96:111], v[200:203], v[148:151], v[96:111]
    v_mfma_f32_32x32x16_bf16 v[112:127], v[204:207], v[148:151], v[112:127]
    buffer_load_dwordx4 v[176:179], v60, s[44:47], s70 offen offset:1024 sc1
    buffer_load_dwordx4 v[180:183], v60, s[44:47], s71 offen offset:1024 sc1
    s_waitcnt vmcnt(15)
    v_mfma_f32_32x32x16_bf16 v[64:79], v[208:211], v[32:35], v[64:79]
    v_mfma_f32_32x32x16_bf16 v[80:95], v[212:215], v[32:35], v[80:95]
    s_waitcnt vmcnt(14)
    v_mfma_f32_32x32x16_bf16 v[96:111], v[208:211], v[36:39], v[96:111]
    v_mfma_f32_32x32x16_bf16 v[112:127], v[212:215], v[36:39], v[112:127]
    buffer_load_dwordx4 v[136:139], v60, s[44:47], s70 offen offset:2048 sc1
    buffer_load_dwordx4 v[140:143], v60, s[44:47], s71 offen offset:2048 sc1
    ds_read_b64_tr_b16 v[40:41], v246 offset:16384
    ds_read_b64_tr_b16 v[42:43], v246 offset:17408
    ds_read_b64_tr_b16 v[44:45], v238 offset:16384
    ds_read_b64_tr_b16 v[46:47], v238 offset:17408
    s_waitcnt vmcnt(15)
    v_mfma_f32_32x32x16_bf16 v[64:79], v[216:219], v[152:155], v[64:79]
    v_mfma_f32_32x32x16_bf16 v[80:95], v[220:223], v[152:155], v[80:95]
    s_waitcnt vmcnt(14)
    v_mfma_f32_32x32x16_bf16 v[96:111], v[216:219], v[156:159], v[96:111]
    v_mfma_f32_32x32x16_bf16 v[112:127], v[220:223], v[156:159], v[112:127]
    buffer_load_dwordx4 v[184:187], v60, s[44:47], s70 offen offset:3072 sc1
    buffer_load_dwordx4 v[188:191], v60, s[44:47], s71 offen offset:3072 sc1
    ds_read_b64_tr_b16 v[48:49], v246 offset:24576
    ds_read_b64_tr_b16 v[50:51], v246 offset:25600
    ds_read_b64_tr_b16 v[52:53], v238 offset:24576
    ds_read_b64_tr_b16 v[54:55], v238 offset:25600
    s_waitcnt vmcnt(15) lgkmcnt(6)
    v_mfma_f32_32x32x16_bf16 v[64:79], v[40:43], v[8:11], v[64:79]
    s_waitcnt lgkmcnt(4)
    v_mfma_f32_32x32x16_bf16 v[80:95], v[44:47], v[8:11], v[80:95]
    s_waitcnt vmcnt(14)
    s_nop 0
    v_mfma_f32_32x32x16_bf16 v[96:111], v[40:43], v[12:15], v[96:111]
    v_mfma_f32_32x32x16_bf16 v[112:127], v[44:47], v[12:15], v[112:127]
    buffer_load_dwordx4 v[24:27], v61, s[44:47], s70 offen offset:0 sc1
    buffer_load_dwordx4 v[28:31], v61, s[44:47], s71 offen offset:0 sc1
    s_add_u32 s59, s69, 0x5e800
    s_add_u32 m0, s58, 0x4000
    s_nop 0
    s_nop 0
    buffer_load_dwordx4 v244, s[48:51], s59 offen lds
    s_add_u32 s59, s69, 0x60400
    s_add_u32 m0, s58, 0x4400
    s_nop 0
    s_nop 0
    buffer_load_dwordx4 v244, s[48:51], s59 offen lds
    ds_read_b64_tr_b16 v[40:41], v247 offset:40960
    ds_read_b64_tr_b16 v[42:43], v247 offset:41984
    ds_read_b64_tr_b16 v[44:45], v239 offset:40960
    ds_read_b64_tr_b16 v[46:47], v239 offset:41984
    s_waitcnt vmcnt(17) lgkmcnt(6)
    v_mfma_f32_32x32x16_bf16 v[64:79], v[48:51], v[160:163], v[64:79]
    s_waitcnt lgkmcnt(4)
    v_mfma_f32_32x32x16_bf16 v[80:95], v[52:55], v[160:163], v[80:95]
    s_waitcnt vmcnt(16)
    s_nop 0
    v_mfma_f32_32x32x16_bf16 v[96:111], v[48:51], v[164:167], v[96:111]
    v_mfma_f32_32x32x16_bf16 v[112:127], v[52:55], v[164:167], v[112:127]
    buffer_load_dwordx4 v[192:195], v61, s[44:47], s70 offen offset:1024 sc1
    buffer_load_dwordx4 v[196:199], v61, s[44:47], s71 offen offset:1024 sc1
    s_add_u32 s59, s66, 0
    s_add_u32 m0, s58, 0x6000
    s_nop 0
    buffer_load_dwordx4 v244, s[36:39], s59 offen lds
    s_add_u32 s59, s66, 0x1c00
    s_add_u32 m0, s58, 0x6400
    s_nop 0
    s_nop 0
    buffer_load_dwordx4 v244, s[36:39], s59 offen lds
    ds_read_b64_tr_b16 v[48:49], v246 offset:32768
    ds_read_b64_tr_b16 v[50:51], v246 offset:33792
    ds_read_b64_tr_b16 v[52:53], v238 offset:32768
    ds_read_b64_tr_b16 v[54:55], v238 offset:33792
    s_waitcnt vmcnt(19) lgkmcnt(6)
    v_mfma_f32_32x32x16_bf16 v[64:79], v[40:43], v[128:131], v[64:79]
    s_waitcnt lgkmcnt(4)
    v_mfma_f32_32x32x16_bf16 v[80:95], v[44:47], v[128:131], v[80:95]
    s_waitcnt vmcnt(18)
    s_nop 0
    v_mfma_f32_32x32x16_bf16 v[96:111], v[40:43], v[132:135], v[96:111]
    v_mfma_f32_32x32x16_bf16 v[112:127], v[44:47], v[132:135], v[112:127]
    buffer_load_dwordx4 v[144:147], v61, s[44:47], s70 offen offset:2048 sc1
    buffer_load_dwordx4 v[148:151], v61, s[44:47], s71 offen offset:2048 sc1
    s_add_u32 s59, s66, 0x3800
    s_add_u32 m0, s58, 0x18000
    s_nop 0
    s_nop 0
    buffer_load_dwordx4 v244, s[36:39], s59 offen lds
    s_add_u32 s59, s66, 0x5400
    s_add_u32 m0, s58, 0x18400
    s_nop 0
    s_nop 0
    buffer_load_dwordx4 v245, s[36:39], s59 offen lds
    ds_read_b64_tr_b16 v[40:41], v246 offset:40960
    ds_read_b64_tr_b16 v[42:43], v246 offset:41984
    ds_read_b64_tr_b16 v[44:45], v238 offset:40960
    ds_read_b64_tr_b16 v[46:47], v238 offset:41984
    s_waitcnt vmcnt(21) lgkmcnt(6)
    v_mfma_f32_32x32x16_bf16 v[64:79], v[48:51], v[168:171], v[64:79]
    s_waitcnt lgkmcnt(4)
    v_mfma_f32_32x32x16_bf16 v[80:95], v[52:55], v[168:171], v[80:95]
    s_waitcnt vmcnt(20)
    s_nop 0
    v_mfma_f32_32x32x16_bf16 v[96:111], v[48:51], v[172:175], v[96:111]
    v_mfma_f32_32x32x16_bf16 v[112:127], v[52:55], v[172:175], v[112:127]
    buffer_load_dwordx4 v[200:203], v61, s[44:47], s70 offen offset:3072 sc1
    buffer_load_dwordx4 v[204:207], v61, s[44:47], s71 offen offset:3072 sc1
    s_add_u32 s59, s66, 0x6200
    s_add_u32 m0, s58, 0x8000
    s_nop 0
    s_nop 0
    buffer_load_dwordx4 v244, s[36:39], s59 offen lds
    s_add_u32 s59, s66, 0x7e00
    s_add_u32 m0, s58, 0x8400
    s_nop 0
    s_nop 0
    buffer_load_dwordx4 v244, s[36:39], s59 offen lds
    ds_read_b64_tr_b16 v[48:49], v246 offset:49152
    ds_read_b64_tr_b16 v[50:51], v246 offset:50176
    ds_read_b64_tr_b16 v[52:53], v238 offset:49152
    ds_read_b64_tr_b16 v[54:55], v238 offset:50176
    s_waitcnt vmcnt(23) lgkmcnt(6)
    v_mfma_f32_32x32x16_bf16 v[64:79], v[40:43], v[16:19], v[64:79]
    s_waitcnt lgkmcnt(4)
    v_mfma_f32_32x32x16_bf16 v[80:95], v[44:47], v[16:19], v[80:95]
    s_waitcnt vmcnt(22)
    s_nop 0
    v_mfma_f32_32x32x16_bf16 v[96:111], v[40:43], v[20:23], v[96:111]
    v_mfma_f32_32x32x16_bf16 v[112:127], v[44:47], v[20:23], v[112:127]
    buffer_load_dwordx4 v[32:35], v62, s[44:47], s70 offen offset:0 sc1
    buffer_load_dwordx4 v[36:39], v62, s[44:47], s71 offen offset:0 sc1
    s_add_u32 s59, s66, 0x9a00
    s_add_u32 m0, s58, 0xa000
    s_nop 0
    s_nop 0
    buffer_load_dwordx4 v244, s[36:39], s59 offen lds
    s_add_u32 s59, s66, 0xb600
    s_add_u32 m0, s58, 0xa400
    s_nop 0
    s_nop 0
    buffer_load_dwordx4 v245, s[36:39], s59 offen lds
    ds_read_b64_tr_b16 v[40:41], v247 offset:0
    ds_read_b64_tr_b16 v[42:43], v247 offset:1024
    ds_read_b64_tr_b16 v[44:45], v239 offset:0
    ds_read_b64_tr_b16 v[46:47], v239 offset:1024
    s_waitcnt vmcnt(25) lgkmcnt(6)
    v_mfma_f32_32x32x16_bf16 v[64:79], v[48:51], v[176:179], v[64:79]
    s_waitcnt lgkmcnt(4)
    v_mfma_f32_32x32x16_bf16 v[80:95], v[52:55], v[176:179], v[80:95]
    s_waitcnt vmcnt(24)
    s_nop 0
    v_mfma_f32_32x32x16_bf16 v[96:111], v[48:51], v[180:183], v[96:111]
    v_mfma_f32_32x32x16_bf16 v[112:127], v[52:55], v[180:183], v[112:127]
    buffer_load_dwordx4 v[208:211], v62, s[44:47], s70 offen offset:1024 sc1
    buffer_load_dwordx4 v[212:215], v62, s[44:47], s71 offen offset:1024 sc1
    s_add_u32 s59, s66, 0xc400
    s_add_u32 m0, s58, 0xc000
    s_nop 0
    s_nop 0
    buffer_load_dwordx4 v244, s[36:39], s59 offen lds
    s_add_u32 s59, s66, 0xe000
    s_add_u32 m0, s58, 0xc400
    s_nop 0
    s_nop 0
    buffer_load_dwordx4 v244, s[36:39], s59 offen lds
    ds_read_b64_tr_b16 v[48:49], v247 offset:49152
    ds_read_b64_tr_b16 v[50:51], v247 offset:50176
    ds_read_b64_tr_b16 v[52:53], v239 offset:49152
    ds_read_b64_tr_b16 v[54:55], v239 offset:50176
    s_waitcnt vmcnt(27) lgkmcnt(6)
    v_mfma_f32_32x32x16_bf16 v[64:79], v[40:43], v[136:139], v[64:79]
    s_waitcnt lgkmcnt(4)
    v_mfma_f32_32x32x16_bf16 v[80:95], v[44:47], v[136:139], v[80:95]
    s_waitcnt vmcnt(26)
    s_nop 0
    v_mfma_f32_32x32x16_bf16 v[96:111], v[40:43], v[140:143], v[96:111]
    v_mfma_f32_32x32x16_bf16 v[112:127], v[44:47], v[140:143], v[112:127]
    buffer_load_dwordx4 v[152:155], v62, s[44:47], s70 offen offset:2048 sc1
    buffer_load_dwordx4 v[156:159], v62, s[44:47], s71 offen offset:2048 sc1
    s_add_u32 s59, s66, 0xfc00
    s_add_u32 m0, s58, 0xe000
    s_nop 0
    s_nop 0
    buffer_load_dwordx4 v244, s[36:39], s59 offen lds
    s_add_u32 s59, s66, 0x11800
    s_add_u32 m0, s58, 0xe400
    s_nop 0
    s_nop 0
    buffer_load_dwordx4 v245, s[36:39], s59 offen lds
    ds_read_b64_tr_b16 v[40:41], v247 offset:8192
    ds_read_b64_tr_b16 v[42:43], v247 offset:9216
    ds_read_b64_tr_b16 v[44:45], v239 offset:8192
    ds_read_b64_tr_b16 v[46:47], v239 offset:9216
    s_waitcnt vmcnt(29) lgkmcnt(6)
    v_mfma_f32_32x32x16_bf16 v[64:79], v[48:51], v[184:187], v[64:79]
    s_waitcnt lgkmcnt(4)
    v_mfma_f32_32x32x16_bf16 v[80:95], v[52:55], v[184:187], v[80:95]
    s_waitcnt vmcnt(28)
    s_nop 0
    v_mfma_f32_32x32x16_bf16 v[96:111], v[48:51], v[188:191], v[96:111]
    v_mfma_f32_32x32x16_bf16 v[112:127], v[52:55], v[188:191], v[112:127]
    buffer_load_dwordx4 v[216:219], v62, s[44:47], s70 offen offset:3072 sc1
    buffer_load_dwordx4 v[220:223], v62, s[44:47], s71 offen offset:3072 sc1
    s_add_u32 s59, s66, 0x12600
    s_add_u32 m0, s58, 0x1a000
    s_nop 0
    s_nop 0
    buffer_load_dwordx4 v244, s[36:39], s59 offen lds
    s_add_u32 s59, s66, 0x14200
    s_add_u32 m0, s58, 0x1a400
    s_nop 0
    s_nop 0
    buffer_load_dwordx4 v244, s[36:39], s59 offen lds
    ds_read_b64_tr_b16 v[48:49], v247 offset:16384
    ds_read_b64_tr_b16 v[50:51], v247 offset:17408
    ds_read_b64_tr_b16 v[52:53], v239 offset:16384
    ds_read_b64_tr_b16 v[54:55], v239 offset:17408
    s_waitcnt vmcnt(31) lgkmcnt(6)
    v_mfma_f32_32x32x16_bf16 v[64:79], v[40:43], v[24:27], v[64:79]
    s_waitcnt lgkmcnt(4)
    v_mfma_f32_32x32x16_bf16 v[80:95], v[44:47], v[24:27], v[80:95]
    s_waitcnt vmcnt(30)
    s_nop 0
    v_mfma_f32_32x32x16_bf16 v[96:111], v[40:43], v[28:31], v[96:111]
    v_mfma_f32_32x32x16_bf16 v[112:127], v[44:47], v[28:31], v[112:127]
    s_add_u32 s59, s66, 0x15e00
    s_add_u32 m0, s58, 0x10000
    s_nop 0
    s_nop 0
    buffer_load_dwordx4 v244, s[36:39], s59 offen lds
    s_add_u32 s59, s66, 0x17a00
    s_add_u32 m0, s58, 0x10400
    s_nop 0
    s_nop 0
    buffer_load_dwordx4 v245, s[36:39], s59 offen lds
    ds_read_b64_tr_b16 v[40:41], v247 offset:24576
    ds_read_b64_tr_b16 v[42:43], v247 offset:25600
    ds_read_b64_tr_b16 v[44:45], v239 offset:24576
    ds_read_b64_tr_b16 v[46:47], v239 offset:25600
    s_waitcnt vmcnt(29) lgkmcnt(6)
    v_mfma_f32_32x32x16_bf16 v[64:79], v[48:51], v[192:195], v[64:79]
    s_waitcnt lgkmcnt(4)
    v_mfma_f32_32x32x16_bf16 v[80:95], v[52:55], v[192:195], v[80:95]
    s_waitcnt vmcnt(28)
    s_nop 0
    v_mfma_f32_32x32x16_bf16 v[96:111], v[48:51], v[196:199], v[96:111]
    v_mfma_f32_32x32x16_bf16 v[112:127], v[52:55], v[196:199], v[112:127]
    ds_read_b64_tr_b16 v[48:49], v247 offset:32768
    ds_read_b64_tr_b16 v[50:51], v247 offset:33792
    ds_read_b64_tr_b16 v[52:53], v239 offset:32768
    ds_read_b64_tr_b16 v[54:55], v239 offset:33792
    s_waitcnt vmcnt(25) lgkmcnt(6)
    v_mfma_f32_32x32x16_bf16 v[64:79], v[40:43], v[144:147], v[64:79]
    s_waitcnt lgkmcnt(4)
    v_mfma_f32_32x32x16_bf16 v[80:95], v[44:47], v[144:147], v[80:95]
    s_waitcnt vmcnt(24)
    s_nop 0
    v_mfma_f32_32x32x16_bf16 v[96:111], v[40:43], v[148:151], v[96:111]
    v_mfma_f32_32x32x16_bf16 v[112:127], v[44:47], v[148:151], v[112:127]
    ds_read_b64_tr_b16 v[40:41], v247 offset:57344
    ds_read_b64_tr_b16 v[42:43], v247 offset:58368
    ds_read_b64_tr_b16 v[44:45], v239 offset:57344
    ds_read_b64_tr_b16 v[46:47], v239 offset:58368
    s_waitcnt vmcnt(21) lgkmcnt(6)
    v_mfma_f32_32x32x16_bf16 v[64:79], v[48:51], v[200:203], v[64:79]
    s_waitcnt lgkmcnt(4)
    v_mfma_f32_32x32x16_bf16 v[80:95], v[52:55], v[200:203], v[80:95]
    s_waitcnt vmcnt(20)
    s_nop 0
    v_mfma_f32_32x32x16_bf16 v[96:111], v[48:51], v[204:207], v[96:111]
    v_mfma_f32_32x32x16_bf16 v[112:127], v[52:55], v[204:207], v[112:127]
    ds_read_b64_tr_b16 v[48:49], v246 offset:0
    ds_read_b64_tr_b16 v[50:51], v246 offset:1024
    ds_read_b64_tr_b16 v[52:53], v238 offset:0
    ds_read_b64_tr_b16 v[54:55], v238 offset:1024
    s_waitcnt vmcnt(17) lgkmcnt(6)
    v_mfma_f32_32x32x16_bf16 v[64:79], v[40:43], v[32:35], v[64:79]
    s_waitcnt lgkmcnt(4)
    v_mfma_f32_32x32x16_bf16 v[80:95], v[44:47], v[32:35], v[80:95]
    s_waitcnt vmcnt(16)
    s_nop 0
    v_mfma_f32_32x32x16_bf16 v[96:111], v[40:43], v[36:39], v[96:111]
    v_mfma_f32_32x32x16_bf16 v[112:127], v[44:47], v[36:39], v[112:127]
    buffer_load_dword v228, v229, s[44:47], s75 offen sc1
    ds_read_b64_tr_b16 v[40:41], v246 offset:8192
    ds_read_b64_tr_b16 v[42:43], v246 offset:9216
    ds_read_b64_tr_b16 v[44:45], v238 offset:8192
    ds_read_b64_tr_b16 v[46:47], v238 offset:9216
    s_waitcnt vmcnt(14) lgkmcnt(6)
    v_mfma_f32_32x32x16_bf16 v[64:79], v[48:51], v[208:211], v[64:79]
    s_waitcnt lgkmcnt(4)
    v_mfma_f32_32x32x16_bf16 v[80:95], v[52:55], v[208:211], v[80:95]
    s_waitcnt vmcnt(13)
    s_nop 0
    v_mfma_f32_32x32x16_bf16 v[96:111], v[48:51], v[212:215], v[96:111]
    v_mfma_f32_32x32x16_bf16 v[112:127], v[52:55], v[212:215], v[112:127]
    ds_read_b64_tr_b16 v[48:49], v246 offset:16384
    ds_read_b64_tr_b16 v[50:51], v246 offset:17408
    ds_read_b64_tr_b16 v[52:53], v238 offset:16384
    ds_read_b64_tr_b16 v[54:55], v238 offset:17408
    s_waitcnt vmcnt(10) lgkmcnt(6)
    v_mfma_f32_32x32x16_bf16 v[64:79], v[40:43], v[152:155], v[64:79]
    s_waitcnt lgkmcnt(4)
    v_mfma_f32_32x32x16_bf16 v[80:95], v[44:47], v[152:155], v[80:95]
    s_waitcnt vmcnt(9)
    v_mfma_f32_32x32x16_bf16 v[96:111], v[40:43], v[156:159], v[96:111]
    v_mfma_f32_32x32x16_bf16 v[112:127], v[44:47], v[156:159], v[112:127]
    s_waitcnt vmcnt(0)
    v_mov_b32 v228, v228
    v_cmp_ne_u32 vcc, 1, v228
    s_nop 4
    s_cbranch_vccz SP_O_Q0_OK
    s_mov_b32 s61, 0
SP_O_Q0:
    buffer_load_dword v228, v229, s[44:47], s75 offen sc1
    s_add_u32 s61, s61, 1
    s_cmp_gt_u32 s61, 0x20000
    s_cbranch_scc1 SP_O_Q0_OK
    s_waitcnt vmcnt(0)
    v_cmp_ne_u32 vcc, 1, v228
    s_nop 4
    s_cbranch_vccz SP_O_Q0_OK
    s_sleep 8
    s_branch SP_O_Q0
SP_O_Q0_OK:
    s_nop 0
    buffer_load_dwordx4 v[8:11], v56, s[44:47], s73 offen offset:0 sc1
    buffer_load_dwordx4 v[12:15], v56, s[44:47], s74 offen offset:0 sc1
    buffer_load_dwordx4 v[160:163], v56, s[44:47], s73 offen offset:1024 sc1
    buffer_load_dwordx4 v[164:167], v56, s[44:47], s74 offen offset:1024 sc1
    buffer_load_dwordx4 v[128:131], v56, s[44:47], s73 offen offset:2048 sc1
    buffer_load_dwordx4 v[132:135], v56, s[44:47], s74 offen offset:2048 sc1
    buffer_load_dwordx4 v[168:171], v56, s[44:47], s73 offen offset:3072 sc1
    buffer_load_dwordx4 v[172:175], v56, s[44:47], s74 offen offset:3072 sc1
    buffer_load_dwordx4 v[16:19], v57, s[44:47], s73 offen offset:0 sc1
    buffer_load_dwordx4 v[20:23], v57, s[44:47], s74 offen offset:0 sc1
    buffer_load_dwordx4 v[176:179], v57, s[44:47], s73 offen offset:1024 sc1
    buffer_load_dwordx4 v[180:183], v57, s[44:47], s74 offen offset:1024 sc1
    buffer_load_dwordx4 v[136:139], v57, s[44:47], s73 offen offset:2048 sc1
    buffer_load_dwordx4 v[140:143], v57, s[44:47], s74 offen offset:2048 sc1
    buffer_load_dwordx4 v[184:187], v57, s[44:47], s73 offen offset:3072 sc1
    buffer_load_dwordx4 v[188:191], v57, s[44:47], s74 offen offset:3072 sc1
    ds_read_b64_tr_b16 v[40:41], v246 offset:24576
    ds_read_b64_tr_b16 v[42:43], v246 offset:25600
    ds_read_b64_tr_b16 v[44:45], v238 offset:24576
    ds_read_b64_tr_b16 v[46:47], v238 offset:25600
    s_waitcnt lgkmcnt(6)
    v_mfma_f32_32x32x16_bf16 v[64:79], v[48:51], v[216:219], v[64:79]
    s_waitcnt lgkmcnt(4)
    v_mfma_f32_32x32x16_bf16 v[80:95], v[52:55], v[216:219], v[80:95]
    v_mfma_f32_32x32x16_bf16 v[96:111], v[48:51], v[220:223], v[96:111]
    v_mfma_f32_32x32x16_bf16 v[112:127], v[52:55], v[220:223], v[112:127]
    ds_read_b64_tr_b16 v[48:49], v247 offset:40960
    ds_read_b64_tr_b16 v[50:51], v247 offset:41984
    ds_read_b64_tr_b16 v[52:53], v239 offset:40960
    ds_read_b64_tr_b16 v[54:55], v239 offset:41984
    s_waitcnt vmcnt(15) lgkmcnt(6)
    v_mfma_f32_32x32x16_bf16 v[64:79], v[40:43], v[8:11], v[64:79]
    s_waitcnt lgkmcnt(4)
    v_mfma_f32_32x32x16_bf16 v[80:95], v[44:47], v[8:11], v[80:95]
    s_waitcnt vmcnt(14)
    s_nop 0
    v_mfma_f32_32x32x16_bf16 v[96:111], v[40:43], v[12:15], v[96:111]
    v_mfma_f32_32x32x16_bf16 v[112:127], v[44:47], v[12:15], v[112:127]
    ds_read_b64_tr_b16 v[40:41], v246 offset:32768
    ds_read_b64_tr_b16 v[42:43], v246 offset:33792
    ds_read_b64_tr_b16 v[44:45], v238 offset:32768
    ds_read_b64_tr_b16 v[46:47], v238 offset:33792
    s_waitcnt vmcnt(13) lgkmcnt(6)
    v_mfma_f32_32x32x16_bf16 v[64:79], v[48:51], v[160:163], v[64:79]
    s_waitcnt lgkmcnt(4)
    v_mfma_f32_32x32x16_bf16 v[80:95], v[52:55], v[160:163], v[80:95]
    s_waitcnt vmcnt(12)
    s_nop 0
    v_mfma_f32_32x32x16_bf16 v[96:111], v[48:51], v[164:167], v[96:111]
    v_mfma_f32_32x32x16_bf16 v[112:127], v[52:55], v[164:167], v[112:127]
    ds_read_b64_tr_b16 v[48:49], v246 offset:40960
    ds_read_b64_tr_b16 v[50:51], v246 offset:41984
    ds_read_b64_tr_b16 v[52:53], v238 offset:40960
    ds_read_b64_tr_b16 v[54:55], v238 offset:41984
    s_waitcnt vmcnt(11) lgkmcnt(6)
    v_mfma_f32_32x32x16_bf16 v[64:79], v[40:43], v[128:131], v[64:79]
    s_waitcnt lgkmcnt(4)
    v_mfma_f32_32x32x16_bf16 v[80:95], v[44:47], v[128:131], v[80:95]
    s_waitcnt vmcnt(10)
    s_nop 0
    v_mfma_f32_32x32x16_bf16 v[96:111], v[40:43], v[132:135], v[96:111]
    v_mfma_f32_32x32x16_bf16 v[112:127], v[44:47], v[132:135], v[112:127]
    ds_read_b64_tr_b16 v[40:41], v246 offset:49152
    ds_read_b64_tr_b16 v[42:43], v246 offset:50176
    ds_read_b64_tr_b16 v[44:45], v238 offset:49152
    ds_read_b64_tr_b16 v[46:47], v238 offset:50176
    s_waitcnt vmcnt(9) lgkmcnt(6)
    v_mfma_f32_32x32x16_bf16 v[64:79], v[48:51], v[168:171], v[64:79]
    s_waitcnt lgkmcnt(4)
    v_mfma_f32_32x32x16_bf16 v[80:95], v[52:55], v[168:171], v[80:95]
    s_waitcnt vmcnt(8)
    s_nop 0
    v_mfma_f32_32x32x16_bf16 v[96:111], v[48:51], v[172:175], v[96:111]
    v_mfma_f32_32x32x16_bf16 v[112:127], v[52:55], v[172:175], v[112:127]
    ds_read_b64_tr_b16 v[48:49], v247 offset:0
    ds_read_b64_tr_b16 v[50:51], v247 offset:1024
    ds_read_b64_tr_b16 v[52:53], v239 offset:0
    ds_read_b64_tr_b16 v[54:55], v239 offset:1024
    s_waitcnt vmcnt(7) lgkmcnt(6)
    v_mfma_f32_32x32x16_bf16 v[64:79], v[40:43], v[16:19], v[64:79]
    s_waitcnt lgkmcnt(4)
    v_mfma_f32_32x32x16_bf16 v[80:95], v[44:47], v[16:19], v[80:95]
    s_waitcnt vmcnt(6)
    s_nop 0
    v_mfma_f32_32x32x16_bf16 v[96:111], v[40:43], v[20:23], v[96:111]
    v_mfma_f32_32x32x16_bf16 v[112:127], v[44:47], v[20:23], v[112:127]
    ds_read_b64_tr_b16 v[40:41], v247 offset:49152
    ds_read_b64_tr_b16 v[42:43], v247 offset:50176
    ds_read_b64_tr_b16 v[44:45], v239 offset:49152
    ds_read_b64_tr_b16 v[46:47], v239 offset:50176
    s_waitcnt vmcnt(5) lgkmcnt(6)
    v_mfma_f32_32x32x16_bf16 v[64:79], v[48:51], v[176:179], v[64:79]
    s_waitcnt lgkmcnt(4)
    v_mfma_f32_32x32x16_bf16 v[80:95], v[52:55], v[176:179], v[80:95]
    s_waitcnt vmcnt(4)
    s_nop 0
    v_mfma_f32_32x32x16_bf16 v[96:111], v[48:51], v[180:183], v[96:111]
    v_mfma_f32_32x32x16_bf16 v[112:127], v[52:55], v[180:183], v[112:127]
    ds_read_b64_tr_b16 v[48:49], v247 offset:8192
    ds_read_b64_tr_b16 v[50:51], v247 offset:9216
    ds_read_b64_tr_b16 v[52:53], v239 offset:8192
    ds_read_b64_tr_b16 v[54:55], v239 offset:9216
    s_waitcnt vmcnt(3) lgkmcnt(6)
    v_mfma_f32_32x32x16_bf16 v[64:79], v[40:43], v[136:139], v[64:79]
    s_waitcnt lgkmcnt(4)
    v_mfma_f32_32x32x16_bf16 v[80:95], v[44:47], v[136:139], v[80:95]
    s_waitcnt vmcnt(2)
    v_mfma_f32_32x32x16_bf16 v[96:111], v[40:43], v[140:143], v[96:111]
    v_mfma_f32_32x32x16_bf16 v[112:127], v[44:47], v[140:143], v[112:127]
    s_waitcnt vmcnt(1) lgkmcnt(2)
    v_mfma_f32_32x32x16_bf16 v[64:79], v[48:51], v[184:187], v[64:79]
    s_waitcnt lgkmcnt(0)
    v_mfma_f32_32x32x16_bf16 v[80:95], v[52:55], v[184:187], v[80:95]
    s_waitcnt vmcnt(0)
    v_mfma_f32_32x32x16_bf16 v[96:111], v[48:51], v[188:191], v[96:111]
    v_mfma_f32_32x32x16_bf16 v[112:127], v[52:55], v[188:191], v[112:127]
    s_barrier
    s_nop 5
    ds_write_b128 v232, v[64:67] offset:0
    ds_write_b128 v232, v[68:71] offset:32
    ds_write_b128 v232, v[72:75] offset:64
    ds_write_b128 v232, v[76:79] offset:96
    ds_write_b128 v232, v[80:83] offset:128
    ds_write_b128 v232, v[84:87] offset:160
    ds_write_b128 v232, v[88:91] offset:192
    ds_write_b128 v232, v[92:95] offset:224
    ds_write_b128 v232, v[96:99] offset:8704
    ds_write_b128 v232, v[100:103] offset:8736
    ds_write_b128 v232, v[104:107] offset:8768
    ds_write_b128 v232, v[108:111] offset:8800
    ds_write_b128 v232, v[112:115] offset:8832
    ds_write_b128 v232, v[116:119] offset:8864
    ds_write_b128 v232, v[120:123] offset:8896
    ds_write_b128 v232, v[124:127] offset:8928
    s_waitcnt lgkmcnt(0)
    s_barrier
    ds_read_b128 v[64:67], v231 offset:0
    ds_read_b128 v[68:71], v231 offset:16
    ds_read_b128 v[72:75], v231 offset:17408
    ds_read_b128 v[76:79], v231 offset:17424
    ds_read_b128 v[80:83], v231 offset:34816
    ds_read_b128 v[84:87], v231 offset:34832
    ds_read_b128 v[88:91], v231 offset:52224
    ds_read_b128 v[92:95], v231 offset:52240
    ds_read_b128 v[96:99], v231 offset:8704
    ds_read_b128 v[100:103], v231 offset:8720
    ds_read_b128 v[104:107], v231 offset:26112
    ds_read_b128 v[108:111], v231 offset:26128
    ds_read_b128 v[112:115], v231 offset:43520
    ds_read_b128 v[116:119], v231 offset:43536
    ds_read_b128 v[120:123], v231 offset:60928
    ds_read_b128 v[124:127], v231 offset:60944
    s_waitcnt lgkmcnt(13)
    v_add_f32 v64, v64, v72
    v_add_f32 v65, v65, v73
    v_add_f32 v66, v66, v74
    v_add_f32 v67, v67, v75
    s_waitcnt lgkmcnt(12)
    v_add_f32 v68, v68, v76
    v_add_f32 v69, v69, v77
    v_add_f32 v70, v70, v78
    v_add_f32 v71, v71, v79
    s_waitcnt lgkmcnt(9)
    v_add_f32 v80, v80, v88
    v_add_f32 v81, v81, v89
    v_add_f32 v82, v82, v90
    v_add_f32 v83, v83, v91
    s_waitcnt lgkmcnt(8)
    v_add_f32 v84, v84, v92
    v_add_f32 v85, v85, v93
    v_add_f32 v86, v86, v94
    v_add_f32 v87, v87, v95
    v_lshlrev_b32_e64 v8, 16, v248
    v_and_b32 v9, 0xffff0000, v248
    v_lshlrev_b32_e64 v10, 16, v249
    v_and_b32 v11, 0xffff0000, v249
    v_lshlrev_b32_e64 v12, 16, v250
    v_and_b32 v13, 0xffff0000, v250
    v_lshlrev_b32_e64 v14, 16, v251
    v_and_b32 v15, 0xffff0000, v251
    v_add_f32 v64, v64, v80
    v_add_f32 v65, v65, v81
    v_add_f32 v66, v66, v82
    v_add_f32 v67, v67, v83
    v_add_f32 v68, v68, v84
    v_add_f32 v69, v69, v85
    v_add_f32 v70, v70, v86
    v_add_f32 v71, v71, v87
    v_add_f32 v64, v64, v8
    v_add_f32 v65, v65, v9
    v_add_f32 v66, v66, v10
    v_add_f32 v67, v67, v11
    v_add_f32 v68, v68, v12
    v_add_f32 v69, v69, v13
    v_add_f32 v70, v70, v14
    v_add_f32 v71, v71, v15
    v_cvt_pk_bf16_f32 v16, v64, v65
    v_cvt_pk_bf16_f32 v17, v66, v67
    v_cvt_pk_bf16_f32 v18, v68, v69
    v_cvt_pk_bf16_f32 v19, v70, v71
    buffer_store_dwordx4 v[16:19], v230, s[40:43], 0 offen sc1
    s_waitcnt lgkmcnt(5)
    v_add_f32 v96, v96, v104
    v_add_f32 v97, v97, v105
    v_add_f32 v98, v98, v106
    v_add_f32 v99, v99, v107
    s_waitcnt lgkmcnt(4)
    v_add_f32 v100, v100, v108
    v_add_f32 v101, v101, v109
    v_add_f32 v102, v102, v110
    v_add_f32 v103, v103, v111
    s_waitcnt lgkmcnt(1)
    v_add_f32 v112, v112, v120
    v_add_f32 v113, v113, v121
    v_add_f32 v114, v114, v122
    v_add_f32 v115, v115, v123
    s_waitcnt lgkmcnt(0)
    v_add_f32 v116, v116, v124
    v_add_f32 v117, v117, v125
    v_add_f32 v118, v118, v126
    v_add_f32 v119, v119, v127
    v_lshlrev_b32_e64 v8, 16, v252
    v_and_b32 v9, 0xffff0000, v252
    v_lshlrev_b32_e64 v10, 16, v253
    v_and_b32 v11, 0xffff0000, v253
    v_lshlrev_b32_e64 v12, 16, v254
    v_and_b32 v13, 0xffff0000, v254
    v_lshlrev_b32_e64 v14, 16, v255
    v_and_b32 v15, 0xffff0000, v255
    v_add_f32 v96, v96, v112
    v_add_f32 v97, v97, v113
    v_add_f32 v98, v98, v114
    v_add_f32 v99, v99, v115
    v_add_f32 v100, v100, v116
    v_add_f32 v101, v101, v117
    v_add_f32 v102, v102, v118
    v_add_f32 v103, v103, v119
    v_add_f32 v96, v96, v8
    v_add_f32 v97, v97, v9
    v_add_f32 v98, v98, v10
    v_add_f32 v99, v99, v11
    v_add_f32 v100, v100, v12
    v_add_f32 v101, v101, v13
    v_add_f32 v102, v102, v14
    v_add_f32 v103, v103, v15
    v_cvt_pk_bf16_f32 v20, v96, v97
    v_cvt_pk_bf16_f32 v21, v98, v99
    v_cvt_pk_bf16_f32 v22, v100, v101
    v_cvt_pk_bf16_f32 v23, v102, v103
    buffer_store_dwordx4 v[20:23], v230, s[40:43], s77 offen sc1
P2_END_Q0:
    s_endpgm
K1_Q1:
    v_bfe_u32 v3, v0, 4, 1
    v_bfe_u32 v4, v0, 2, 2
    v_and_b32 v5, 3, v0
    v_lshl_add_u32 v6, v237, 3, v4
    v_lshlrev_b32_e64 v5, 3, v5
    v_lshl_add_u32 v1, v3, 5, v5
    v_lshlrev_b32 v7, 6, v4
    s_lshr_b32 s60, s3, 1
    s_and_b32 s60, s60, 1
    s_add_u32 s61, s60, 6
    s_and_b32 s62, s61, 3
    s_mul_i32 s62, s62, 56
    s_lshr_b32 s63, s61, 2
    s_lshl_b32 s63, s63, 13
    v_add_u32 v2, s62, v1
    v_xor_b32 v2, v2, v7
    v_add_u32_e64 v2, s63, v2
    v_lshl_add_u32 v216, v6, 8, v2
    v_add_u32 v217, 0xc000, v216
    v_bfe_u32 v7, v0, 3, 1
    v_lshlrev_b32 v7, 6, v7
    v_xor_b32 v2, v1, v7
    v_lshl_add_u32 v2, v6, 7, v2
    v_add_u32 v218, 0x18000, v2
    v_xor_b32 v220, 64, v218
    s_and_b32 s62, s3, 1
    s_lshl_b32 s62, s62, 1
    s_lshl_b32 s63, s26, 2
    s_add_u32 s62, s62, s63
    s_lshl_b32 s70, s62, 15
    s_sub_u32 s63, s27, 14
    s_lshl_b32 s63, s63, 3
    s_add_u32 s63, s63, s61
    s_lshl_b32 s63, s63, 11
    s_add_u32 s70, s70, s63
    s_nop 0
    s_add_u32 s70, s70, 0xc00000
    s_mul_i32 s63, s60, 0x1080
    v_add_u32 v238, 0x1080, v223
    v_subrev_u32 v238, s63, v238
    v_add_u32 v223, s63, v223
    v_mov_b32_e64 v243, v238
    s_mul_i32 s63, s60, 0x8000
    s_add_u32 s77, s70, 0x8000
    s_sub_u32 s77, s77, s63
    s_add_u32 s70, s70, s63
    s_mov_b32 s59, s77
    v_lshlrev_b32 v200, 16, v16
    v_and_b32 v201, 0xffff0000, v16
    v_lshlrev_b32_e64 v202, 16, v17
    v_and_b32 v203, 0xffff0000, v17
    v_lshlrev_b32_e64 v204, 16, v18
    v_and_b32 v205, 0xffff0000, v18
    v_lshlrev_b32_e64 v206, 16, v19
    v_and_b32 v207, 0xffff0000, v19
    v_fma_f32 v200, v200, v228, v230
    v_fma_f32 v201, v201, v228, v230
    v_fma_f32 v202, v202, v228, v230
    v_fma_f32 v203, v203, v228, v230
    v_fma_f32 v204, v204, v228, v230
    v_fma_f32 v205, v205, v228, v230
    v_fma_f32 v206, v206, v228, v230
    v_fma_f32 v207, v207, v228, v230
    v_cvt_pk_bf16_f32 v16, v200, v201
    v_cvt_pk_bf16_f32 v17, v202, v203
    v_cvt_pk_bf16_f32 v18, v204, v205
    v_cvt_pk_bf16_f32 v19, v206, v207
    s_waitcnt vmcnt(3) lgkmcnt(0)
    s_barrier
    ds_read_b128 v[184:187], v223 offset:0
    ds_read_b64_tr_b16 v[160:161], v216 offset:0
    ds_read_b64_tr_b16 v[162:163], v216 offset:1024
    ds_read_b128 v[188:191], v243 offset:0
    ds_read_b64_tr_b16 v[164:165], v218 offset:0
    ds_read_b64_tr_b16 v[166:167], v218 offset:512
    ds_read_b64_tr_b16 v[168:169], v220 offset:0
    ds_read_b64_tr_b16 v[170:171], v220 offset:512
    s_add_u32 m0, s66, 0xc000
    s_nop 0
    buffer_load_dwordx4 v225, s[36:39], s65 offen lds
    ds_write_b128 v222, v[16:19] offset:16896
    v_lshlrev_b32 v200, 16, v20
    v_and_b32 v201, 0xffff0000, v20
    v_lshlrev_b32_e64 v202, 16, v21
    v_and_b32 v203, 0xffff0000, v21
    s_add_u32 m0, s66, 0xe000
    s_nop 0
    buffer_load_dwordx4 v226, s[40:43], s65 offen lds
    v_lshlrev_b32 v204, 16, v22
    v_and_b32 v205, 0xffff0000, v22
    v_lshlrev_b32_e64 v206, 16, v23
    v_and_b32 v207, 0xffff0000, v23
    v_fma_f32 v200, v200, v229, v231
    s_add_u32 s65, s65, s75
    s_cmp_eq_u32 s65, s76
    s_cselect_b32 s65, 0, s65
    s_add_u32 m0, s66, 0x10000
    s_nop 0
    buffer_load_dwordx4 v225, s[36:39], s65 offen lds
    v_fma_f32 v201, v201, v229, v231
    v_fma_f32 v202, v202, v229, v231
    v_fma_f32 v203, v203, v229, v231
    v_fma_f32 v204, v204, v229, v231
    v_fma_f32 v205, v205, v229, v231
    s_add_u32 m0, s66, 0x12000
    s_nop 0
    buffer_load_dwordx4 v226, s[40:43], s65 offen lds
    s_add_u32 s65, s65, s75
    v_fma_f32 v206, v206, v229, v231
    v_fma_f32 v207, v207, v229, v231
    v_cvt_pk_bf16_f32 v20, v200, v201
    v_cvt_pk_bf16_f32 v21, v202, v203
    v_cvt_pk_bf16_f32 v22, v204, v205
    v_cvt_pk_bf16_f32 v23, v206, v207
    ds_write_b128 v222, v[20:23] offset:17024
    s_mov_b32 s52, s22
    s_nop 0
    s_and_b32 s53, s23, 0xffff
    s_mov_b32 s54, 0x100
    s_mov_b32 s55, 0x20000
    v_mov_b32 v240, 0x7fff0000
    v_cmp_eq_u32 vcc, 0, v0
    s_nop 1
    v_cndmask_b32 v235, v240, 0, vcc
    s_lshl_b32 s60, s27, 2
    s_add_u32 s60, s60, s3
    s_sub_u32 s60, s60, 4
    s_lshl_b32 s61, s60, 11
    s_add_u32 s61, s61, 0x1000000
    s_lshl_b32 s62, s60, 8
    s_add_u32 s62, s62, 0x1100000
    s_lshl_b32 s74, s60, 2
    s_lshl_b32 s73, s27, 13
    s_add_u32 s73, s73, 0x1000000
    s_cmp_eq_u32 s26, s27
    s_cselect_b32 s62, s62, 0x7fff0000
    s_cselect_b32 s61, s61, 0x7fff0000
    s_cselect_b32 s74, s74, 0x7fff0000
    v_mov_b32 v128, 0
    v_mov_b32 v129, 0
    v_mov_b32 v130, 0
    v_mov_b32 v131, 0
    buffer_store_dwordx4 v[128:131], v227, s[44:47], s61 offen offset:0 sc1
    buffer_store_dwordx4 v[128:131], v227, s[44:47], s61 offen offset:1024 sc1
    v_cmp_gt_u32 vcc, 16, v0
    s_nop 1
    v_cndmask_b32 v238, v240, v227, vcc
    buffer_store_dwordx4 v[128:131], v238, s[44:47], s62 offen sc1
    s_waitcnt lgkmcnt(7)
    v_mfma_f32_32x32x16_bf16 v[64:79], v[160:163], v[184:187], 0
    ds_read_b128 v[192:195], v223 offset:1056
    ds_read_b64_tr_b16 v[172:173], v216 offset:4096
    ds_read_b64_tr_b16 v[174:175], v216 offset:5120
    s_waitcnt lgkmcnt(9)
    s_nop 0
    v_mfma_f32_32x32x16_bf16 v[80:95], v[160:163], v[188:191], 0
    ds_read_b128 v[196:199], v243 offset:1056
    ds_read_b64_tr_b16 v[176:177], v218 offset:2048
    ds_read_b64_tr_b16 v[178:179], v218 offset:2560
    s_waitcnt lgkmcnt(10)
    s_nop 0
    v_mfma_f32_32x32x16_bf16 v[96:111], v[164:167], v[184:187], 0
    ds_read_b64_tr_b16 v[180:181], v220 offset:2048
    ds_read_b64_tr_b16 v[182:183], v220 offset:2560
    s_waitcnt lgkmcnt(10)
    v_mfma_f32_32x32x16_bf16 v[112:127], v[184:187], v[168:171], 0
    s_waitcnt lgkmcnt(5)
    v_mfma_f32_32x32x16_bf16 v[64:79], v[172:175], v[192:195], v[64:79]
    ds_read_b128 v[184:187], v223 offset:2112
    ds_read_b64_tr_b16 v[160:161], v216 offset:16384
    ds_read_b64_tr_b16 v[162:163], v216 offset:17408
    s_waitcnt lgkmcnt(7)
    s_nop 0
    v_mfma_f32_32x32x16_bf16 v[80:95], v[172:175], v[196:199], v[80:95]
    ds_read_b128 v[188:191], v243 offset:2112
    ds_read_b64_tr_b16 v[164:165], v218 offset:4096
    ds_read_b64_tr_b16 v[166:167], v218 offset:4608
    s_waitcnt lgkmcnt(8)
    s_nop 0
    v_mfma_f32_32x32x16_bf16 v[96:111], v[176:179], v[192:195], v[96:111]
    ds_read_b64_tr_b16 v[168:169], v220 offset:4096
    ds_read_b64_tr_b16 v[170:171], v220 offset:4608
    s_waitcnt lgkmcnt(8)
    v_mfma_f32_32x32x16_bf16 v[112:127], v[192:195], v[180:183], v[112:127]
    s_waitcnt vmcnt(7)
    s_barrier
    s_add_u32 m0, s66, 0x14000
    s_nop 0
    buffer_load_dwordx4 v225, s[36:39], s65 offen lds
    v_lshlrev_b32_e64 v200, 16, v24
    v_and_b32 v201, 0xffff0000, v24
    v_lshlrev_b32_e64 v202, 16, v25
    v_and_b32 v203, 0xffff0000, v25
    s_add_u32 m0, s66, 0x16000
    s_nop 0
    buffer_load_dwordx4 v226, s[40:43], s65 offen lds
    v_lshlrev_b32 v204, 16, v26
    v_and_b32 v205, 0xffff0000, v26
    v_lshlrev_b32_e64 v206, 16, v27
    v_and_b32 v207, 0xffff0000, v27
    s_add_u32 s65, s65, s75
    s_cmp_eq_u32 s65, s76
    s_cselect_b32 s65, 0, s65
    s_add_u32 m0, s66, 0
    s_nop 0
    s_nop 0
    buffer_load_dwordx4 v225, s[36:39], s65 offen lds
    v_fma_f32 v200, v200, v228, v230
    v_fma_f32 v201, v201, v228, v230
    v_fma_f32 v202, v202, v228, v230
    v_fma_f32 v203, v203, v228, v230
    s_add_u32 m0, s66, 0x2000
    s_nop 0
    s_nop 0
    buffer_load_dwordx4 v226, s[40:43], s65 offen lds
    v_fma_f32 v204, v204, v228, v230
    v_fma_f32 v205, v205, v228, v230
    v_fma_f32 v206, v206, v228, v230
    v_fma_f32 v207, v207, v228, v230
    s_add_u32 s65, s65, s75
    s_add_u32 m0, s66, 0x1c000
    s_nop 0
    buffer_load_dwordx4 v224, s[32:35], s64 offen lds
    s_add_u32 s64, s64, 0x2a000
    s_cmp_eq_u32 s64, 0x126000
    s_cselect_b32 s64, 0, s64
    s_nop 0
    v_cvt_pk_bf16_f32 v24, v200, v201
    v_cvt_pk_bf16_f32 v25, v202, v203
    v_cvt_pk_bf16_f32 v26, v204, v205
    v_cvt_pk_bf16_f32 v27, v206, v207
    s_waitcnt lgkmcnt(5)
    s_nop 0
    v_mfma_f32_32x32x16_bf16 v[64:79], v[160:163], v[184:187], v[64:79]
    ds_read_b128 v[192:195], v223 offset:3168
    ds_read_b64_tr_b16 v[172:173], v216 offset:20480
    ds_read_b64_tr_b16 v[174:175], v216 offset:21504
    s_waitcnt lgkmcnt(7)
    s_nop 0
    v_mfma_f32_32x32x16_bf16 v[80:95], v[160:163], v[188:191], v[80:95]
    ds_read_b128 v[196:199], v243 offset:3168
    ds_read_b64_tr_b16 v[176:177], v218 offset:6144
    ds_read_b64_tr_b16 v[178:179], v218 offset:6656
    s_waitcnt lgkmcnt(8)
    s_nop 0
    v_mfma_f32_32x32x16_bf16 v[96:111], v[164:167], v[184:187], v[96:111]
    ds_read_b64_tr_b16 v[180:181], v220 offset:6144
    ds_read_b64_tr_b16 v[182:183], v220 offset:6656
    s_waitcnt lgkmcnt(8)
    v_mfma_f32_32x32x16_bf16 v[112:127], v[184:187], v[168:171], v[112:127]
    s_waitcnt lgkmcnt(5)
    v_mfma_f32_32x32x16_bf16 v[64:79], v[172:175], v[192:195], v[64:79]
    ds_read_b128 v[184:187], v223 offset:16896
    ds_read_b64_tr_b16 v[160:161], v216 offset:32768
    ds_read_b64_tr_b16 v[162:163], v216 offset:33792
    s_waitcnt lgkmcnt(7)
    s_nop 0
    v_mfma_f32_32x32x16_bf16 v[80:95], v[172:175], v[196:199], v[80:95]
    ds_read_b128 v[188:191], v243 offset:16896
    ds_read_b64_tr_b16 v[164:165], v218 offset:8192
    ds_read_b64_tr_b16 v[166:167], v218 offset:8704
    s_waitcnt lgkmcnt(8)
    s_nop 0
    v_mfma_f32_32x32x16_bf16 v[96:111], v[176:179], v[192:195], v[96:111]
    ds_read_b64_tr_b16 v[168:169], v220 offset:8192
    ds_read_b64_tr_b16 v[170:171], v220 offset:8704
    s_waitcnt lgkmcnt(8)
    v_mfma_f32_32x32x16_bf16 v[112:127], v[192:195], v[180:183], v[112:127]
    s_waitcnt vmcnt(10)
    s_barrier
    s_add_u32 m0, s66, 0x4000
    s_nop 0
    buffer_load_dwordx4 v225, s[36:39], s65 offen lds
    ds_write_b128 v222, v[24:27] offset:0
    v_lshlrev_b32_e64 v200, 16, v28
    v_and_b32 v201, 0xffff0000, v28
    v_lshlrev_b32_e64 v202, 16, v29
    v_and_b32 v203, 0xffff0000, v29
    v_lshlrev_b32_e64 v204, 16, v30
    v_and_b32 v205, 0xffff0000, v30
    v_lshlrev_b32_e64 v206, 16, v31
    v_and_b32 v207, 0xffff0000, v31
    v_fma_f32 v200, v200, v229, v231
    v_fma_f32 v201, v201, v229, v231
    s_add_u32 m0, s66, 0x6000
    s_nop 0
    buffer_load_dwordx4 v226, s[40:43], s65 offen lds
    s_add_u32 s65, s65, s75
    s_cmp_eq_u32 s65, s76
    s_cselect_b32 s65, 0, s65
    v_fma_f32 v202, v202, v229, v231
    v_fma_f32 v203, v203, v229, v231
    v_fma_f32 v204, v204, v229, v231
    v_fma_f32 v205, v205, v229, v231
    v_fma_f32 v206, v206, v229, v231
    v_fma_f32 v207, v207, v229, v231
    v_cvt_pk_bf16_f32 v28, v200, v201
    v_cvt_pk_bf16_f32 v29, v202, v203
    v_cvt_pk_bf16_f32 v30, v204, v205
    v_cvt_pk_bf16_f32 v31, v206, v207
    ds_write_b128 v222, v[28:31] offset:128
    s_waitcnt lgkmcnt(7)
    s_nop 0
    v_mfma_f32_32x32x16_bf16 v[64:79], v[160:163], v[184:187], v[64:79]
    ds_read_b128 v[192:195], v223 offset:17952
    ds_read_b64_tr_b16 v[172:173], v216 offset:36864
    ds_read_b64_tr_b16 v[174:175], v216 offset:37888
    s_waitcnt lgkmcnt(9)
    s_nop 0
    v_mfma_f32_32x32x16_bf16 v[80:95], v[160:163], v[188:191], v[80:95]
    ds_read_b128 v[196:199], v243 offset:17952
    ds_read_b64_tr_b16 v[176:177], v218 offset:10240
    ds_read_b64_tr_b16 v[178:179], v218 offset:10752
    s_waitcnt lgkmcnt(10)
    s_nop 0
    v_mfma_f32_32x32x16_bf16 v[96:111], v[164:167], v[184:187], v[96:111]
    ds_read_b64_tr_b16 v[180:181], v220 offset:10240
    ds_read_b64_tr_b16 v[182:183], v220 offset:10752
    s_waitcnt lgkmcnt(10)
    v_mfma_f32_32x32x16_bf16 v[112:127], v[184:187], v[168:171], v[112:127]
    s_waitcnt lgkmcnt(5)
    v_mfma_f32_32x32x16_bf16 v[64:79], v[172:175], v[192:195], v[64:79]
    ds_read_b128 v[184:187], v223 offset:19008
    ds_read_b64_tr_b16 v[160:161], v217 offset:0
    ds_read_b64_tr_b16 v[162:163], v217 offset:1024
    s_waitcnt lgkmcnt(7)
    s_nop 0
    v_mfma_f32_32x32x16_bf16 v[80:95], v[172:175], v[196:199], v[80:95]
    ds_read_b128 v[188:191], v243 offset:19008
    ds_read_b64_tr_b16 v[164:165], v218 offset:12288
    ds_read_b64_tr_b16 v[166:167], v218 offset:12800
    s_waitcnt lgkmcnt(8)
    s_nop 0
    v_mfma_f32_32x32x16_bf16 v[96:111], v[176:179], v[192:195], v[96:111]
    ds_read_b64_tr_b16 v[168:169], v220 offset:12288
    ds_read_b64_tr_b16 v[170:171], v220 offset:12800
    s_waitcnt lgkmcnt(8)
    v_mfma_f32_32x32x16_bf16 v[112:127], v[192:195], v[180:183], v[112:127]
    s_waitcnt vmcnt(2)
    s_barrier
    s_add_u32 m0, s66, 0x8000
    s_nop 0
    buffer_load_dwordx4 v225, s[36:39], s65 offen lds
    v_lshlrev_b32_e64 v200, 16, v32
    v_and_b32 v201, 0xffff0000, v32
    v_lshlrev_b32_e64 v202, 16, v33
    v_and_b32 v203, 0xffff0000, v33
    v_lshlrev_b32_e64 v204, 16, v34
    v_and_b32 v205, 0xffff0000, v34
    s_add_u32 m0, s66, 0xa000
    s_nop 0
    buffer_load_dwordx4 v226, s[40:43], s65 offen lds
    v_lshlrev_b32 v206, 16, v35
    v_and_b32 v207, 0xffff0000, v35
    v_fma_f32 v200, v200, v228, v230
    v_fma_f32 v201, v201, v228, v230
    v_fma_f32 v202, v202, v228, v230
    v_fma_f32 v203, v203, v228, v230
    s_add_u32 s65, s65, s75
    s_add_u32 m0, s66, 0x18000
    s_nop 0
    buffer_load_dwordx4 v224, s[32:35], s64 offen lds
    s_add_u32 s64, s64, 0x2a000
    s_cmp_eq_u32 s64, 0x126000
    s_cselect_b32 s64, 0, s64
    s_nop 0
    v_fma_f32 v204, v204, v228, v230
    v_fma_f32 v205, v205, v228, v230
    v_fma_f32 v206, v206, v228, v230
    v_fma_f32 v207, v207, v228, v230
    v_cvt_pk_bf16_f32 v32, v200, v201
    v_cvt_pk_bf16_f32 v33, v202, v203
    v_cvt_pk_bf16_f32 v34, v204, v205
    v_cvt_pk_bf16_f32 v35, v206, v207
    s_lshl_b32 s60, s2, 3
    s_add_u32 s60, s60, s3
    s_lshl_b32 s60, s60, 10
    s_nop 0
    s_sub_u32 s61, s60, 0x188000
    s_mov_b32 s62, 0x62000
    s_cmp_lt_u32 s60, 0x188000
    s_cselect_b32 s28, s18, s10
    s_cselect_b32 s29, s19, s11
    s_cselect_b32 s30, 0x188000, s62
    s_cselect_b32 s60, s60, s61
    s_and_b32 s29, s29, 0xffff
    buffer_load_dwordx4 v[8:11], v227, s[28:31], s60 offen
    s_waitcnt lgkmcnt(5)
    v_mfma_f32_32x32x16_bf16 v[64:79], v[160:163], v[184:187], v[64:79]
    ds_read_b128 v[192:195], v223 offset:20064
    ds_read_b64_tr_b16 v[172:173], v217 offset:4096
    ds_read_b64_tr_b16 v[174:175], v217 offset:5120
    s_waitcnt lgkmcnt(7)
    s_nop 0
    v_mfma_f32_32x32x16_bf16 v[80:95], v[160:163], v[188:191], v[80:95]
    ds_read_b128 v[196:199], v243 offset:20064
    ds_read_b64_tr_b16 v[176:177], v218 offset:14336
    ds_read_b64_tr_b16 v[178:179], v218 offset:14848
    s_waitcnt lgkmcnt(8)
    s_nop 0
    v_mfma_f32_32x32x16_bf16 v[96:111], v[164:167], v[184:187], v[96:111]
    ds_read_b64_tr_b16 v[180:181], v220 offset:14336
    ds_read_b64_tr_b16 v[182:183], v220 offset:14848
    s_waitcnt lgkmcnt(8)
    v_mfma_f32_32x32x16_bf16 v[112:127], v[184:187], v[168:171], v[112:127]
    s_waitcnt lgkmcnt(5)
    v_mfma_f32_32x32x16_bf16 v[64:79], v[172:175], v[192:195], v[64:79]
    ds_read_b128 v[184:187], v223 offset:0
    ds_read_b64_tr_b16 v[160:161], v217 offset:16384
    ds_read_b64_tr_b16 v[162:163], v217 offset:17408
    s_waitcnt lgkmcnt(7)
    s_nop 0
    v_mfma_f32_32x32x16_bf16 v[80:95], v[172:175], v[196:199], v[80:95]
    ds_read_b128 v[188:191], v243 offset:0
    ds_read_b64_tr_b16 v[164:165], v218 offset:16384
    ds_read_b64_tr_b16 v[166:167], v218 offset:16896
    s_waitcnt lgkmcnt(8)
    s_nop 0
    v_mfma_f32_32x32x16_bf16 v[96:111], v[176:179], v[192:195], v[96:111]
    ds_read_b64_tr_b16 v[168:169], v220 offset:16384
    ds_read_b64_tr_b16 v[170:171], v220 offset:16896
    s_waitcnt lgkmcnt(8)
    v_mfma_f32_32x32x16_bf16 v[112:127], v[192:195], v[180:183], v[112:127]
    s_barrier
    s_add_u32 m0, s66, 0xc000
    s_nop 0
    buffer_load_dwordx4 v225, s[36:39], s65 offen lds
    ds_write_b128 v222, v[32:35] offset:16896
    v_lshlrev_b32 v200, 16, v36
    v_and_b32 v201, 0xffff0000, v36
    v_lshlrev_b32_e64 v202, 16, v37
    v_and_b32 v203, 0xffff0000, v37
    v_lshlrev_b32_e64 v204, 16, v38
    v_and_b32 v205, 0xffff0000, v38
    v_lshlrev_b32_e64 v206, 16, v39
    v_and_b32 v207, 0xffff0000, v39
    v_fma_f32 v200, v200, v229, v231
    v_fma_f32 v201, v201, v229, v231
    s_add_u32 m0, s66, 0xe000
    s_nop 0
    buffer_load_dwordx4 v226, s[40:43], s65 offen lds
    s_add_u32 s65, s65, s75
    s_cmp_eq_u32 s65, s76
    s_cselect_b32 s65, 0, s65
    v_fma_f32 v202, v202, v229, v231
    v_fma_f32 v203, v203, v229, v231
    v_fma_f32 v204, v204, v229, v231
    v_fma_f32 v205, v205, v229, v231
    v_fma_f32 v206, v206, v229, v231
    v_fma_f32 v207, v207, v229, v231
    v_cvt_pk_bf16_f32 v36, v200, v201
    v_cvt_pk_bf16_f32 v37, v202, v203
    v_cvt_pk_bf16_f32 v38, v204, v205
    v_cvt_pk_bf16_f32 v39, v206, v207
    ds_write_b128 v222, v[36:39] offset:17024
    s_waitcnt lgkmcnt(7)
    s_nop 0
    v_mfma_f32_32x32x16_bf16 v[64:79], v[160:163], v[184:187], v[64:79]
    ds_read_b128 v[192:195], v223 offset:1056
    ds_read_b64_tr_b16 v[172:173], v217 offset:20480
    ds_read_b64_tr_b16 v[174:175], v217 offset:21504
    s_waitcnt lgkmcnt(9)
    s_nop 0
    v_mfma_f32_32x32x16_bf16 v[80:95], v[160:163], v[188:191], v[80:95]
    ds_read_b128 v[196:199], v243 offset:1056
    ds_read_b64_tr_b16 v[176:177], v218 offset:18432
    ds_read_b64_tr_b16 v[178:179], v218 offset:18944
    s_waitcnt lgkmcnt(10)
    s_nop 0
    v_mfma_f32_32x32x16_bf16 v[96:111], v[164:167], v[184:187], v[96:111]
    ds_read_b64_tr_b16 v[180:181], v220 offset:18432
    ds_read_b64_tr_b16 v[182:183], v220 offset:18944
    s_waitcnt lgkmcnt(10)
    v_mfma_f32_32x32x16_bf16 v[112:127], v[184:187], v[168:171], v[112:127]
    s_waitcnt lgkmcnt(5)
    v_mfma_f32_32x32x16_bf16 v[64:79], v[172:175], v[192:195], v[64:79]
    ds_read_b128 v[184:187], v223 offset:2112
    ds_read_b64_tr_b16 v[160:161], v217 offset:32768
    ds_read_b64_tr_b16 v[162:163], v217 offset:33792
    s_waitcnt lgkmcnt(7)
    s_nop 0
    v_mfma_f32_32x32x16_bf16 v[80:95], v[172:175], v[196:199], v[80:95]
    ds_read_b128 v[188:191], v243 offset:2112
    ds_read_b64_tr_b16 v[164:165], v218 offset:20480
    ds_read_b64_tr_b16 v[166:167], v218 offset:20992
    s_waitcnt lgkmcnt(8)
    s_nop 0
    v_mfma_f32_32x32x16_bf16 v[96:111], v[176:179], v[192:195], v[96:111]
    ds_read_b64_tr_b16 v[168:169], v220 offset:20480
    ds_read_b64_tr_b16 v[170:171], v220 offset:20992
    s_waitcnt lgkmcnt(8)
    v_mfma_f32_32x32x16_bf16 v[112:127], v[192:195], v[180:183], v[112:127]
    s_waitcnt vmcnt(3)
    s_barrier
    s_add_u32 m0, s66, 0x10000
    s_nop 0
    buffer_load_dwordx4 v225, s[36:39], s65 offen lds
    v_lshlrev_b32_e64 v200, 16, v40
    v_and_b32 v201, 0xffff0000, v40
    v_lshlrev_b32_e64 v202, 16, v41
    v_and_b32 v203, 0xffff0000, v41
    v_lshlrev_b32_e64 v204, 16, v42
    v_and_b32 v205, 0xffff0000, v42
    s_add_u32 m0, s66, 0x12000
    s_nop 0
    buffer_load_dwordx4 v226, s[40:43], s65 offen lds
    v_lshlrev_b32 v206, 16, v43
    v_and_b32 v207, 0xffff0000, v43
    v_fma_f32 v200, v200, v228, v230
    v_fma_f32 v201, v201, v228, v230
    v_fma_f32 v202, v202, v228, v230
    v_fma_f32 v203, v203, v228, v230
    s_add_u32 s65, s65, s75
    s_add_u32 m0, s66, 0x1a000
    s_nop 0
    buffer_load_dwordx4 v224, s[32:35], s64 offen lds
    s_add_u32 s64, s64, 0x2a000
    s_cmp_eq_u32 s64, 0x126000
    s_cselect_b32 s64, 0, s64
    s_nop 0
    v_fma_f32 v204, v204, v228, v230
    v_fma_f32 v205, v205, v228, v230
    v_fma_f32 v206, v206, v228, v230
    v_fma_f32 v207, v207, v228, v230
    v_cvt_pk_bf16_f32 v40, v200, v201
    v_cvt_pk_bf16_f32 v41, v202, v203
    v_cvt_pk_bf16_f32 v42, v204, v205
    v_cvt_pk_bf16_f32 v43, v206, v207
    v_mov_b32_e64 v234, 1
    buffer_store_dword v234, v235, s[52:55], s74 offen sc1
    s_waitcnt lgkmcnt(5)
    s_nop 0
    v_mfma_f32_32x32x16_bf16 v[64:79], v[160:163], v[184:187], v[64:79]
    ds_read_b128 v[192:195], v223 offset:3168
    ds_read_b64_tr_b16 v[172:173], v217 offset:36864
    ds_read_b64_tr_b16 v[174:175], v217 offset:37888
    s_waitcnt lgkmcnt(7)
    s_nop 0
    v_mfma_f32_32x32x16_bf16 v[80:95], v[160:163], v[188:191], v[80:95]
    ds_read_b128 v[196:199], v243 offset:3168
    ds_read_b64_tr_b16 v[176:177], v218 offset:22528
    ds_read_b64_tr_b16 v[178:179], v218 offset:23040
    s_waitcnt lgkmcnt(8)
    s_nop 0
    v_mfma_f32_32x32x16_bf16 v[96:111], v[164:167], v[184:187], v[96:111]
    ds_read_b64_tr_b16 v[180:181], v220 offset:22528
    ds_read_b64_tr_b16 v[182:183], v220 offset:23040
    s_waitcnt lgkmcnt(8)
    v_mfma_f32_32x32x16_bf16 v[112:127], v[184:187], v[168:171], v[112:127]
    s_waitcnt lgkmcnt(5)
    v_mfma_f32_32x32x16_bf16 v[64:79], v[172:175], v[192:195], v[64:79]
    ds_read_b128 v[184:187], v223 offset:16896
    ds_read_b64_tr_b16 v[160:161], v216 offset:0
    ds_read_b64_tr_b16 v[162:163], v216 offset:1024
    s_waitcnt lgkmcnt(7)
    s_nop 0
    v_mfma_f32_32x32x16_bf16 v[80:95], v[172:175], v[196:199], v[80:95]
    ds_read_b128 v[188:191], v243 offset:16896
    ds_read_b64_tr_b16 v[164:165], v218 offset:0
    ds_read_b64_tr_b16 v[166:167], v218 offset:512
    s_waitcnt lgkmcnt(8)
    s_nop 0
    v_mfma_f32_32x32x16_bf16 v[96:111], v[176:179], v[192:195], v[96:111]
    ds_read_b64_tr_b16 v[168:169], v220 offset:0
    ds_read_b64_tr_b16 v[170:171], v220 offset:512
    s_waitcnt lgkmcnt(8)
    v_mfma_f32_32x32x16_bf16 v[112:127], v[192:195], v[180:183], v[112:127]
    s_barrier
    s_add_u32 m0, s66, 0x14000
    s_nop 0
    buffer_load_dwordx4 v225, s[36:39], s65 offen lds
    ds_write_b128 v222, v[40:43] offset:0
    v_lshlrev_b32 v200, 16, v44
    v_and_b32 v201, 0xffff0000, v44
    v_lshlrev_b32_e64 v202, 16, v45
    v_and_b32 v203, 0xffff0000, v45
    v_lshlrev_b32_e64 v204, 16, v46
    v_and_b32 v205, 0xffff0000, v46
    v_lshlrev_b32_e64 v206, 16, v47
    v_and_b32 v207, 0xffff0000, v47
    v_fma_f32 v200, v200, v229, v231
    v_fma_f32 v201, v201, v229, v231
    s_add_u32 m0, s66, 0x16000
    s_nop 0
    buffer_load_dwordx4 v226, s[40:43], s65 offen lds
    s_add_u32 s65, s65, s75
    s_cmp_eq_u32 s65, s76
    s_cselect_b32 s65, 0, s65
    v_fma_f32 v202, v202, v229, v231
    v_fma_f32 v203, v203, v229, v231
    v_fma_f32 v204, v204, v229, v231
    v_fma_f32 v205, v205, v229, v231
    v_fma_f32 v206, v206, v229, v231
    v_fma_f32 v207, v207, v229, v231
    v_cvt_pk_bf16_f32 v44, v200, v201
    v_cvt_pk_bf16_f32 v45, v202, v203
    v_cvt_pk_bf16_f32 v46, v204, v205
    v_cvt_pk_bf16_f32 v47, v206, v207
    ds_write_b128 v222, v[44:47] offset:128
    s_waitcnt lgkmcnt(7)
    s_nop 0
    v_mfma_f32_32x32x16_bf16 v[64:79], v[160:163], v[184:187], v[64:79]
    ds_read_b128 v[192:195], v223 offset:17952
    ds_read_b64_tr_b16 v[172:173], v216 offset:4096
    ds_read_b64_tr_b16 v[174:175], v216 offset:5120
    s_waitcnt lgkmcnt(9)
    s_nop 0
    v_mfma_f32_32x32x16_bf16 v[80:95], v[160:163], v[188:191], v[80:95]
    ds_read_b128 v[196:199], v243 offset:17952
    ds_read_b64_tr_b16 v[176:177], v218 offset:2048
    ds_read_b64_tr_b16 v[178:179], v218 offset:2560
    s_waitcnt lgkmcnt(10)
    s_nop 0
    v_mfma_f32_32x32x16_bf16 v[96:111], v[164:167], v[184:187], v[96:111]
    ds_read_b64_tr_b16 v[180:181], v220 offset:2048
    ds_read_b64_tr_b16 v[182:183], v220 offset:2560
    s_waitcnt lgkmcnt(10)
    v_mfma_f32_32x32x16_bf16 v[112:127], v[184:187], v[168:171], v[112:127]
    s_waitcnt lgkmcnt(5)
    v_mfma_f32_32x32x16_bf16 v[64:79], v[172:175], v[192:195], v[64:79]
    ds_read_b128 v[184:187], v223 offset:19008
    ds_read_b64_tr_b16 v[160:161], v216 offset:16384
    ds_read_b64_tr_b16 v[162:163], v216 offset:17408
    s_waitcnt lgkmcnt(7)
    s_nop 0
    v_mfma_f32_32x32x16_bf16 v[80:95], v[172:175], v[196:199], v[80:95]
    ds_read_b128 v[188:191], v243 offset:19008
    ds_read_b64_tr_b16 v[164:165], v218 offset:4096
    ds_read_b64_tr_b16 v[166:167], v218 offset:4608
    s_waitcnt lgkmcnt(8)
    s_nop 0
    v_mfma_f32_32x32x16_bf16 v[96:111], v[176:179], v[192:195], v[96:111]
    ds_read_b64_tr_b16 v[168:169], v220 offset:4096
    ds_read_b64_tr_b16 v[170:171], v220 offset:4608
    s_waitcnt lgkmcnt(8)
    v_mfma_f32_32x32x16_bf16 v[112:127], v[192:195], v[180:183], v[112:127]
    s_waitcnt vmcnt(3)
    s_barrier
    s_add_u32 m0, s66, 0
    s_nop 0
    buffer_load_dwordx4 v225, s[36:39], s65 offen lds
    v_lshlrev_b32 v200, 16, v48
    v_and_b32 v201, 0xffff0000, v48
    v_lshlrev_b32_e64 v202, 16, v49
    v_and_b32 v203, 0xffff0000, v49
    v_lshlrev_b32_e64 v204, 16, v50
    v_and_b32 v205, 0xffff0000, v50
    s_add_u32 m0, s66, 0x2000
    s_nop 0
    buffer_load_dwordx4 v226, s[40:43], s65 offen lds
    v_lshlrev_b32 v206, 16, v51
    v_and_b32 v207, 0xffff0000, v51
    v_fma_f32 v200, v200, v228, v230
    v_fma_f32 v201, v201, v228, v230
    v_fma_f32 v202, v202, v228, v230
    v_fma_f32 v203, v203, v228, v230
    s_add_u32 s65, s65, s75
    s_add_u32 m0, s66, 0x1c000
    s_nop 0
    buffer_load_dwordx4 v224, s[32:35], s64 offen lds
    s_add_u32 s64, s64, 0x2a000
    s_cmp_eq_u32 s64, 0x126000
    s_cselect_b32 s64, 0, s64
    s_nop 0
    v_fma_f32 v204, v204, v228, v230
    v_fma_f32 v205, v205, v228, v230
    v_fma_f32 v206, v206, v228, v230
    v_fma_f32 v207, v207, v228, v230
    v_cvt_pk_bf16_f32 v48, v200, v201
    v_cvt_pk_bf16_f32 v49, v202, v203
    v_cvt_pk_bf16_f32 v50, v204, v205
    v_cvt_pk_bf16_f32 v51, v206, v207
    s_waitcnt lgkmcnt(5)
    s_nop 0
    v_mfma_f32_32x32x16_bf16 v[64:79], v[160:163], v[184:187], v[64:79]
    ds_read_b128 v[192:195], v223 offset:20064
    ds_read_b64_tr_b16 v[172:173], v216 offset:20480
    ds_read_b64_tr_b16 v[174:175], v216 offset:21504
    s_waitcnt lgkmcnt(7)
    s_nop 0
    v_mfma_f32_32x32x16_bf16 v[80:95], v[160:163], v[188:191], v[80:95]
    ds_read_b128 v[196:199], v243 offset:20064
    ds_read_b64_tr_b16 v[176:177], v218 offset:6144
    ds_read_b64_tr_b16 v[178:179], v218 offset:6656
    s_waitcnt lgkmcnt(8)
    s_nop 0
    v_mfma_f32_32x32x16_bf16 v[96:111], v[164:167], v[184:187], v[96:111]
    ds_read_b64_tr_b16 v[180:181], v220 offset:6144
    ds_read_b64_tr_b16 v[182:183], v220 offset:6656
    s_waitcnt lgkmcnt(8)
    v_mfma_f32_32x32x16_bf16 v[112:127], v[184:187], v[168:171], v[112:127]
    s_waitcnt lgkmcnt(5)
    v_mfma_f32_32x32x16_bf16 v[64:79], v[172:175], v[192:195], v[64:79]
    ds_read_b128 v[184:187], v223 offset:0
    ds_read_b64_tr_b16 v[160:161], v216 offset:32768
    ds_read_b64_tr_b16 v[162:163], v216 offset:33792
    s_waitcnt lgkmcnt(7)
    s_nop 0
    v_mfma_f32_32x32x16_bf16 v[80:95], v[172:175], v[196:199], v[80:95]
    ds_read_b128 v[188:191], v243 offset:0
    ds_read_b64_tr_b16 v[164:165], v218 offset:8192
    ds_read_b64_tr_b16 v[166:167], v218 offset:8704
    s_waitcnt lgkmcnt(8)
    s_nop 0
    v_mfma_f32_32x32x16_bf16 v[96:111], v[176:179], v[192:195], v[96:111]
    ds_read_b64_tr_b16 v[168:169], v220 offset:8192
    ds_read_b64_tr_b16 v[170:171], v220 offset:8704
    s_waitcnt lgkmcnt(8)
    v_mfma_f32_32x32x16_bf16 v[112:127], v[192:195], v[180:183], v[112:127]
    s_barrier
    s_add_u32 m0, s66, 0x4000
    s_nop 0
    buffer_load_dwordx4 v225, s[36:39], s65 offen lds
    ds_write_b128 v222, v[48:51] offset:16896
    v_lshlrev_b32 v200, 16, v52
    v_and_b32 v201, 0xffff0000, v52
    v_lshlrev_b32_e64 v202, 16, v53
    v_and_b32 v203, 0xffff0000, v53
    v_lshlrev_b32_e64 v204, 16, v54
    v_and_b32 v205, 0xffff0000, v54
    v_lshlrev_b32_e64 v206, 16, v55
    v_and_b32 v207, 0xffff0000, v55
    v_fma_f32 v200, v200, v229, v231
    v_fma_f32 v201, v201, v229, v231
    s_add_u32 m0, s66, 0x6000
    s_nop 0
    s_nop 0
    buffer_load_dwordx4 v226, s[40:43], s65 offen lds
    v_fma_f32 v202, v202, v229, v231
    v_fma_f32 v203, v203, v229, v231
    v_fma_f32 v204, v204, v229, v231
    v_fma_f32 v205, v205, v229, v231
    v_fma_f32 v206, v206, v229, v231
    v_fma_f32 v207, v207, v229, v231
    v_cvt_pk_bf16_f32 v52, v200, v201
    v_cvt_pk_bf16_f32 v53, v202, v203
    v_cvt_pk_bf16_f32 v54, v204, v205
    v_cvt_pk_bf16_f32 v55, v206, v207
    ds_write_b128 v222, v[52:55] offset:17024
    s_waitcnt lgkmcnt(7)
    s_nop 0
    v_mfma_f32_32x32x16_bf16 v[64:79], v[160:163], v[184:187], v[64:79]
    ds_read_b128 v[192:195], v223 offset:1056
    ds_read_b64_tr_b16 v[172:173], v216 offset:36864
    ds_read_b64_tr_b16 v[174:175], v216 offset:37888
    s_waitcnt lgkmcnt(9)
    s_nop 0
    v_mfma_f32_32x32x16_bf16 v[80:95], v[160:163], v[188:191], v[80:95]
    ds_read_b128 v[196:199], v243 offset:1056
    ds_read_b64_tr_b16 v[176:177], v218 offset:10240
    ds_read_b64_tr_b16 v[178:179], v218 offset:10752
    s_waitcnt lgkmcnt(10)
    s_nop 0
    v_mfma_f32_32x32x16_bf16 v[96:111], v[164:167], v[184:187], v[96:111]
    ds_read_b64_tr_b16 v[180:181], v220 offset:10240
    ds_read_b64_tr_b16 v[182:183], v220 offset:10752
    s_waitcnt lgkmcnt(10)
    v_mfma_f32_32x32x16_bf16 v[112:127], v[184:187], v[168:171], v[112:127]
    s_waitcnt lgkmcnt(5)
    v_mfma_f32_32x32x16_bf16 v[64:79], v[172:175], v[192:195], v[64:79]
    ds_read_b128 v[184:187], v223 offset:2112
    ds_read_b64_tr_b16 v[160:161], v217 offset:0
    ds_read_b64_tr_b16 v[162:163], v217 offset:1024
    s_waitcnt lgkmcnt(7)
    s_nop 0
    v_mfma_f32_32x32x16_bf16 v[80:95], v[172:175], v[196:199], v[80:95]
    ds_read_b128 v[188:191], v243 offset:2112
    ds_read_b64_tr_b16 v[164:165], v218 offset:12288
    ds_read_b64_tr_b16 v[166:167], v218 offset:12800
    s_waitcnt lgkmcnt(8)
    s_nop 0
    v_mfma_f32_32x32x16_bf16 v[96:111], v[176:179], v[192:195], v[96:111]
    ds_read_b64_tr_b16 v[168:169], v220 offset:12288
    ds_read_b64_tr_b16 v[170:171], v220 offset:12800
    s_waitcnt lgkmcnt(8)
    v_mfma_f32_32x32x16_bf16 v[112:127], v[192:195], v[180:183], v[112:127]
    s_waitcnt vmcnt(2)
    s_barrier
    s_add_u32 m0, s66, 0x18000
    s_nop 0
    buffer_load_dwordx4 v224, s[32:35], s64 offen lds
    v_lshlrev_b32_e64 v200, 16, v56
    v_and_b32 v201, 0xffff0000, v56
    v_lshlrev_b32_e64 v202, 16, v57
    v_and_b32 v203, 0xffff0000, v57
    v_lshlrev_b32_e64 v204, 16, v58
    v_and_b32 v205, 0xffff0000, v58
    v_lshlrev_b32_e64 v206, 16, v59
    v_and_b32 v207, 0xffff0000, v59
    v_fma_f32 v200, v200, v228, v230
    v_fma_f32 v201, v201, v228, v230
    v_fma_f32 v202, v202, v228, v230
    v_fma_f32 v203, v203, v228, v230
    v_fma_f32 v204, v204, v228, v230
    v_fma_f32 v205, v205, v228, v230
    v_fma_f32 v206, v206, v228, v230
    v_fma_f32 v207, v207, v228, v230
    v_cvt_pk_bf16_f32 v56, v200, v201
    v_cvt_pk_bf16_f32 v57, v202, v203
    v_cvt_pk_bf16_f32 v58, v204, v205
    v_cvt_pk_bf16_f32 v59, v206, v207
    s_waitcnt lgkmcnt(5)
    s_nop 0
    v_mfma_f32_32x32x16_bf16 v[64:79], v[160:163], v[184:187], v[64:79]
    ds_read_b128 v[192:195], v223 offset:3168
    ds_read_b64_tr_b16 v[172:173], v217 offset:4096
    ds_read_b64_tr_b16 v[174:175], v217 offset:5120
    s_waitcnt lgkmcnt(7)
    s_nop 0
    v_mfma_f32_32x32x16_bf16 v[80:95], v[160:163], v[188:191], v[80:95]
    ds_read_b128 v[196:199], v243 offset:3168
    ds_read_b64_tr_b16 v[176:177], v218 offset:14336
    ds_read_b64_tr_b16 v[178:179], v218 offset:14848
    s_waitcnt lgkmcnt(8)
    s_nop 0
    v_mfma_f32_32x32x16_bf16 v[96:111], v[164:167], v[184:187], v[96:111]
    ds_read_b64_tr_b16 v[180:181], v220 offset:14336
    ds_read_b64_tr_b16 v[182:183], v220 offset:14848
    s_waitcnt lgkmcnt(8)
    v_mfma_f32_32x32x16_bf16 v[112:127], v[184:187], v[168:171], v[112:127]
    s_waitcnt lgkmcnt(5)
    v_mfma_f32_32x32x16_bf16 v[64:79], v[172:175], v[192:195], v[64:79]
    ds_read_b128 v[184:187], v223 offset:16896
    ds_read_b64_tr_b16 v[160:161], v217 offset:16384
    ds_read_b64_tr_b16 v[162:163], v217 offset:17408
    s_waitcnt lgkmcnt(7)
    s_nop 0
    v_mfma_f32_32x32x16_bf16 v[80:95], v[172:175], v[196:199], v[80:95]
    ds_read_b128 v[188:191], v243 offset:16896
    ds_read_b64_tr_b16 v[164:165], v218 offset:16384
    ds_read_b64_tr_b16 v[166:167], v218 offset:16896
    s_waitcnt lgkmcnt(8)
    s_nop 0
    v_mfma_f32_32x32x16_bf16 v[96:111], v[176:179], v[192:195], v[96:111]
    ds_read_b64_tr_b16 v[168:169], v220 offset:16384
    ds_read_b64_tr_b16 v[170:171], v220 offset:16896
    s_waitcnt lgkmcnt(8)
    v_mfma_f32_32x32x16_bf16 v[112:127], v[192:195], v[180:183], v[112:127]
    s_barrier
    ds_write_b128 v222, v[56:59] offset:0
    v_lshlrev_b32_e64 v200, 16, v60
    v_and_b32 v201, 0xffff0000, v60
    v_lshlrev_b32_e64 v202, 16, v61
    v_and_b32 v203, 0xffff0000, v61
    v_lshlrev_b32_e64 v204, 16, v62
    v_and_b32 v205, 0xffff0000, v62
    v_lshlrev_b32_e64 v206, 16, v63
    v_and_b32 v207, 0xffff0000, v63
    v_fma_f32 v200, v200, v229, v231
    v_fma_f32 v201, v201, v229, v231
    v_fma_f32 v202, v202, v229, v231
    v_fma_f32 v203, v203, v229, v231
    v_fma_f32 v204, v204, v229, v231
    v_fma_f32 v205, v205, v229, v231
    v_fma_f32 v206, v206, v229, v231
    v_fma_f32 v207, v207, v229, v231
    v_cvt_pk_bf16_f32 v60, v200, v201
    v_cvt_pk_bf16_f32 v61, v202, v203
    v_cvt_pk_bf16_f32 v62, v204, v205
    v_cvt_pk_bf16_f32 v63, v206, v207
    ds_write_b128 v222, v[60:63] offset:128
    s_mov_b32 s48, s8
    s_nop 0
    s_and_b32 s49, s9, 0xffff
    s_mov_b32 s50, 0x6200
    s_mov_b32 s51, 0x20000
    s_mov_b32 s67, 0x3fb8aa3b
    v_and_b32 v236, 31, v0
    v_lshrrev_b32 v237, 5, v0
    v_mov_b32 v240, 0x7fff0000
    v_subrev_u32 v238, 24, v236
    v_cmp_lt_u32 vcc, 27, v236
    s_nop 1
    v_cndmask_b32 v238, v236, v238, vcc
    v_lshlrev_b32_e64 v238, 1, v238
    v_mul_u32_u24 v239, 0xe0, v237
    v_add_u32_e64 v238, v238, v239
    s_mul_i32 s60, s27, 0x620
    v_add_u32 v238, s60, v238
    v_cmp_eq_u32 vcc, 1, v237
    s_nop 1
    v_cndmask_b32 v239, v238, v240, vcc
    buffer_load_ushort v16, v238, s[48:51], 0 offen offset:0
    buffer_load_ushort v17, v238, s[48:51], 0 offen offset:56
    buffer_load_ushort v18, v238, s[48:51], 0 offen offset:112
    buffer_load_ushort v19, v238, s[48:51], 0 offen offset:168
    buffer_load_ushort v20, v238, s[48:51], 0 offen offset:448
    buffer_load_ushort v21, v238, s[48:51], 0 offen offset:504
    buffer_load_ushort v22, v238, s[48:51], 0 offen offset:560
    buffer_load_ushort v23, v238, s[48:51], 0 offen offset:616
    buffer_load_ushort v24, v238, s[48:51], 0 offen offset:896
    buffer_load_ushort v25, v238, s[48:51], 0 offen offset:952
    buffer_load_ushort v26, v238, s[48:51], 0 offen offset:1008
    buffer_load_ushort v27, v238, s[48:51], 0 offen offset:1064
    buffer_load_ushort v28, v239, s[48:51], 0 offen offset:1344
    buffer_load_ushort v29, v239, s[48:51], 0 offen offset:1400
    buffer_load_ushort v30, v239, s[48:51], 0 offen offset:1456
    buffer_load_ushort v31, v239, s[48:51], 0 offen offset:1512
    v_cmp_eq_u32 vcc, 0, v237
    s_nop 1
    v_cndmask_b32 v232, 0, 1.0, vcc
    s_waitcnt lgkmcnt(7)
    s_nop 0
    v_mfma_f32_32x32x16_bf16 v[64:79], v[160:163], v[184:187], v[64:79]
    ds_read_b128 v[192:195], v223 offset:17952
    ds_read_b64_tr_b16 v[172:173], v217 offset:20480
    ds_read_b64_tr_b16 v[174:175], v217 offset:21504
    s_waitcnt lgkmcnt(9)
    s_nop 0
    v_mfma_f32_32x32x16_bf16 v[80:95], v[160:163], v[188:191], v[80:95]
    ds_read_b128 v[196:199], v243 offset:17952
    ds_read_b64_tr_b16 v[176:177], v218 offset:18432
    ds_read_b64_tr_b16 v[178:179], v218 offset:18944
    s_waitcnt lgkmcnt(10)
    s_nop 0
    v_mfma_f32_32x32x16_bf16 v[96:111], v[164:167], v[184:187], v[96:111]
    ds_read_b64_tr_b16 v[180:181], v220 offset:18432
    ds_read_b64_tr_b16 v[182:183], v220 offset:18944
    s_waitcnt lgkmcnt(10)
    v_mfma_f32_32x32x16_bf16 v[112:127], v[184:187], v[168:171], v[112:127]
    s_waitcnt lgkmcnt(5)
    v_mfma_f32_32x32x16_bf16 v[64:79], v[172:175], v[192:195], v[64:79]
    ds_read_b128 v[184:187], v223 offset:19008
    ds_read_b64_tr_b16 v[160:161], v217 offset:32768
    ds_read_b64_tr_b16 v[162:163], v217 offset:33792
    s_waitcnt lgkmcnt(7)
    s_nop 0
    v_mfma_f32_32x32x16_bf16 v[80:95], v[172:175], v[196:199], v[80:95]
    ds_read_b128 v[188:191], v243 offset:19008
    ds_read_b64_tr_b16 v[164:165], v218 offset:20480
    ds_read_b64_tr_b16 v[166:167], v218 offset:20992
    s_waitcnt lgkmcnt(8)
    s_nop 0
    v_mfma_f32_32x32x16_bf16 v[96:111], v[176:179], v[192:195], v[96:111]
    ds_read_b64_tr_b16 v[168:169], v220 offset:20480
    ds_read_b64_tr_b16 v[170:171], v220 offset:20992
    s_waitcnt lgkmcnt(8)
    v_mfma_f32_32x32x16_bf16 v[112:127], v[192:195], v[180:183], v[112:127]
    s_waitcnt vmcnt(16)
    s_barrier
    s_mov_b32 s52, s22
    s_and_b32 s53, s23, 0xffff
    s_mov_b32 s54, 0x100
    s_mov_b32 s55, 0x20000
    v_lshlrev_b32_e64 v235, 2, v0
    buffer_load_dword v234, v235, s[52:55], 0 offen sc1
    s_waitcnt lgkmcnt(5)
    s_nop 0
    v_mfma_f32_32x32x16_bf16 v[64:79], v[160:163], v[184:187], v[64:79]
    ds_read_b128 v[192:195], v223 offset:20064
    ds_read_b64_tr_b16 v[172:173], v217 offset:36864
    ds_read_b64_tr_b16 v[174:175], v217 offset:37888
    s_waitcnt lgkmcnt(7)
    s_nop 0
    v_mfma_f32_32x32x16_bf16 v[80:95], v[160:163], v[188:191], v[80:95]
    ds_read_b128 v[196:199], v243 offset:20064
    ds_read_b64_tr_b16 v[176:177], v218 offset:22528
    ds_read_b64_tr_b16 v[178:179], v218 offset:23040
    s_waitcnt lgkmcnt(8)
    s_nop 0
    v_mfma_f32_32x32x16_bf16 v[96:111], v[164:167], v[184:187], v[96:111]
    ds_read_b64_tr_b16 v[180:181], v220 offset:22528
    ds_read_b64_tr_b16 v[182:183], v220 offset:23040
    s_waitcnt lgkmcnt(8)
    v_mfma_f32_32x32x16_bf16 v[112:127], v[184:187], v[168:171], v[112:127]
    s_waitcnt lgkmcnt(5)
    v_mfma_f32_32x32x16_bf16 v[64:79], v[172:175], v[192:195], v[64:79]
    ds_read_b128 v[184:187], v223 offset:0
    ds_read_b64_tr_b16 v[160:161], v216 offset:0
    ds_read_b64_tr_b16 v[162:163], v216 offset:1024
    s_waitcnt lgkmcnt(7)
    s_nop 0
    v_mfma_f32_32x32x16_bf16 v[80:95], v[172:175], v[196:199], v[80:95]
    ds_read_b128 v[188:191], v243 offset:0
    ds_read_b64_tr_b16 v[164:165], v218 offset:0
    ds_read_b64_tr_b16 v[166:167], v218 offset:512
    s_waitcnt lgkmcnt(8)
    s_nop 0
    v_mfma_f32_32x32x16_bf16 v[96:111], v[176:179], v[192:195], v[96:111]
    ds_read_b64_tr_b16 v[168:169], v220 offset:0
    ds_read_b64_tr_b16 v[170:171], v220 offset:512
    s_waitcnt lgkmcnt(8)
    v_mfma_f32_32x32x16_bf16 v[112:127], v[192:195], v[180:183], v[112:127]
    s_barrier
    v_cmp_eq_u32 s[68:69], 28, v236
    v_lshlrev_b32 v238, 2, v237
    v_sub_u32 v238, v236, v238
    v_and_b32 v239, 1, v238
    v_lshlrev_b32 v239, 4, v239
    v_mov_b32 v240, 0x3f80
    v_lshlrev_b32 v239, v239, v240
    v_lshrrev_b32 v238, 1, v238
    v_cmp_eq_u32 vcc, 0, v238
    s_nop 1
    v_cndmask_b32 v32, 0, v239, vcc
    v_cmp_eq_u32 vcc, 1, v238
    s_nop 1
    v_cndmask_b32 v33, 0, v239, vcc
    v_cmp_eq_u32 vcc, 4, v238
    s_nop 1
    v_cndmask_b32 v34, 0, v239, vcc
    v_cmp_eq_u32 vcc, 5, v238
    s_nop 1
    v_cndmask_b32 v35, 0, v239, vcc
    v_cmp_eq_u32 vcc, 8, v238
    s_nop 1
    v_cndmask_b32 v36, 0, v239, vcc
    v_cmp_eq_u32 vcc, 9, v238
    s_nop 1
    v_cndmask_b32 v37, 0, v239, vcc
    v_cmp_eq_u32 vcc, 12, v238
    s_nop 1
    v_cndmask_b32 v38, 0, v239, vcc
    v_cmp_eq_u32 vcc, 13, v238
    s_nop 1
    v_cndmask_b32 v39, 0, v239, vcc
    v_mov_b32_e64 v208, 0
    v_mov_b32 v209, 0x26000
    ds_write_b32 v209, v208
    s_waitcnt lgkmcnt(6)
    s_nop 0
    v_mfma_f32_32x32x16_bf16 v[64:79], v[160:163], v[184:187], v[64:79]
    ds_read_b128 v[192:195], v223 offset:1056
    ds_read_b64_tr_b16 v[172:173], v216 offset:4096
    ds_read_b64_tr_b16 v[174:175], v216 offset:5120
    s_waitcnt lgkmcnt(8)
    s_nop 0
    v_mfma_f32_32x32x16_bf16 v[80:95], v[160:163], v[188:191], v[80:95]
    ds_read_b128 v[196:199], v243 offset:1056
    ds_read_b64_tr_b16 v[176:177], v218 offset:2048
    ds_read_b64_tr_b16 v[178:179], v218 offset:2560
    s_waitcnt lgkmcnt(9)
    s_nop 0
    v_mfma_f32_32x32x16_bf16 v[96:111], v[164:167], v[184:187], v[96:111]
    ds_read_b64_tr_b16 v[180:181], v220 offset:2048
    ds_read_b64_tr_b16 v[182:183], v220 offset:2560
    s_waitcnt lgkmcnt(9)
    v_mfma_f32_32x32x16_bf16 v[112:127], v[184:187], v[168:171], v[112:127]
    s_waitcnt lgkmcnt(5)
    v_mfma_f32_32x32x16_bf16 v[64:79], v[172:175], v[192:195], v[64:79]
    ds_read_b128 v[184:187], v223 offset:2112
    ds_read_b64_tr_b16 v[160:161], v216 offset:16384
    ds_read_b64_tr_b16 v[162:163], v216 offset:17408
    s_waitcnt lgkmcnt(7)
    s_nop 0
    v_mfma_f32_32x32x16_bf16 v[80:95], v[172:175], v[196:199], v[80:95]
    ds_read_b128 v[188:191], v243 offset:2112
    ds_read_b64_tr_b16 v[164:165], v218 offset:4096
    ds_read_b64_tr_b16 v[166:167], v218 offset:4608
    s_waitcnt lgkmcnt(8)
    s_nop 0
    v_mfma_f32_32x32x16_bf16 v[96:111], v[176:179], v[192:195], v[96:111]
    ds_read_b64_tr_b16 v[168:169], v220 offset:4096
    ds_read_b64_tr_b16 v[170:171], v220 offset:4608
    s_waitcnt lgkmcnt(8)
    v_mfma_f32_32x32x16_bf16 v[112:127], v[192:195], v[180:183], v[112:127]
    s_barrier
    s_waitcnt vmcnt(15)
    v_lshl_or_b32 v244, v17, 16, v16
    s_waitcnt vmcnt(13)
    v_lshl_or_b32 v245, v19, 16, v18
    s_waitcnt vmcnt(11)
    v_lshl_or_b32 v246, v21, 16, v20
    s_waitcnt vmcnt(9)
    v_lshl_or_b32 v247, v23, 16, v22
    s_waitcnt vmcnt(7)
    v_lshl_or_b32 v248, v25, 16, v24
    s_waitcnt vmcnt(5)
    v_lshl_or_b32 v249, v27, 16, v26
    s_waitcnt vmcnt(3)
    v_lshl_or_b32 v250, v29, 16, v28
    s_waitcnt vmcnt(1)
    v_lshl_or_b32 v251, v31, 16, v30
    s_waitcnt lgkmcnt(5)
    s_nop 0
    v_mfma_f32_32x32x16_bf16 v[64:79], v[160:163], v[184:187], v[64:79]
    ds_read_b128 v[192:195], v223 offset:3168
    ds_read_b64_tr_b16 v[172:173], v216 offset:20480
    ds_read_b64_tr_b16 v[174:175], v216 offset:21504
    s_waitcnt lgkmcnt(7)
    s_nop 0
    v_mfma_f32_32x32x16_bf16 v[80:95], v[160:163], v[188:191], v[80:95]
    ds_read_b128 v[196:199], v243 offset:3168
    ds_read_b64_tr_b16 v[176:177], v218 offset:6144
    ds_read_b64_tr_b16 v[178:179], v218 offset:6656
    s_waitcnt lgkmcnt(8)
    s_nop 0
    v_mfma_f32_32x32x16_bf16 v[96:111], v[164:167], v[184:187], v[96:111]
    ds_read_b64_tr_b16 v[180:181], v220 offset:6144
    ds_read_b64_tr_b16 v[182:183], v220 offset:6656
    s_waitcnt lgkmcnt(8)
    v_mfma_f32_32x32x16_bf16 v[112:127], v[184:187], v[168:171], v[112:127]
    s_waitcnt lgkmcnt(5)
    v_mfma_f32_32x32x16_bf16 v[64:79], v[172:175], v[192:195], v[64:79]
    s_waitcnt lgkmcnt(4)
    v_mfma_f32_32x32x16_bf16 v[80:95], v[172:175], v[196:199], v[80:95]
    s_waitcnt lgkmcnt(2)
    v_mfma_f32_32x32x16_bf16 v[96:111], v[176:179], v[192:195], v[96:111]
    s_waitcnt lgkmcnt(0)
    v_mfma_f32_32x32x16_bf16 v[112:127], v[192:195], v[180:183], v[112:127]
    s_barrier
    s_waitcnt vmcnt(0)
    v_mov_b32 v234, v234
    v_cmp_ne_u32 vcc, 1, v234
    s_nop 4
    s_cbranch_vccz SP_Z_Q1_OK
    s_mov_b32 s61, 0
SP_Z_Q1:
    buffer_load_dword v234, v235, s[52:55], 0 offen sc1
    s_add_u32 s61, s61, 1
    s_cmp_gt_u32 s61, 0x20000
    s_cbranch_scc1 SP_Z_Q1_OK
    s_waitcnt vmcnt(0)
    v_cmp_ne_u32 vcc, 1, v234
    s_nop 4
    s_cbranch_vccz SP_Z_Q1_OK
    s_sleep 4
    s_branch SP_Z_Q1
SP_Z_Q1_OK:
    v_mov_b32 v56, 0xbdd2d3e8
    v_mov_b32 v57, 0xc0135761
    v_mov_b32_e64 v241, 1
    v_mov_b32 v240, 0x7fff0000
    v_cmp_eq_u32 vcc, 0, v0
    s_nop 1
    v_cndmask_b32 v242, v240, 0, vcc
    s_setprio 3
    s_nop 0
    v_cvt_pk_bf16_f32 v160, v64, v65
    v_cvt_pk_bf16_f32 v161, v66, v67
    v_cvt_pk_bf16_f32 v162, v68, v69
    v_cvt_pk_bf16_f32 v163, v70, v71
    v_cvt_pk_bf16_f32 v164, v72, v73
    v_cvt_pk_bf16_f32 v165, v74, v75
    v_cvt_pk_bf16_f32 v166, v76, v77
    v_cvt_pk_bf16_f32 v167, v78, v79
    buffer_store_dwordx4 v[160:163], v227, s[44:47], s70 offen offset:0 sc1
    buffer_store_dwordx4 v[164:167], v227, s[44:47], s70 offen offset:1024 sc1
    v_cvt_pk_bf16_f32 v168, v80, v81
    v_cvt_pk_bf16_f32 v169, v82, v83
    v_cvt_pk_bf16_f32 v170, v84, v85
    v_cvt_pk_bf16_f32 v171, v86, v87
    v_cvt_pk_bf16_f32 v172, v88, v89
    v_cvt_pk_bf16_f32 v173, v90, v91
    v_cvt_pk_bf16_f32 v174, v92, v93
    v_cvt_pk_bf16_f32 v175, v94, v95
    buffer_store_dwordx4 v[168:171], v227, s[44:47], s59 offen offset:0 sc1
    buffer_store_dwordx4 v[172:175], v227, s[44:47], s59 offen offset:1024 sc1
    s_setprio 0
    s_nop 0
    v_cvt_pk_bf16_f32 v200, v96, v97
    v_cvt_pk_bf16_f32 v201, v98, v99
    v_cvt_pk_bf16_f32 v202, v100, v101
    v_cvt_pk_bf16_f32 v203, v102, v103
    v_cvt_pk_bf16_f32 v204, v104, v105
    v_cvt_pk_bf16_f32 v205, v106, v107
    v_cvt_pk_bf16_f32 v206, v108, v109
    v_cvt_pk_bf16_f32 v207, v110, v111
    v_mfma_f32_32x32x16_bf16 v[128:143], v[244:247], v[200:203], 0
    s_nop 0
    s_nop 0
    v_mfma_f32_32x32x16_bf16 v[128:143], v[248:251], v[204:207], v[128:143]
    v_mov_b32 v238, 0x3f803f80
    v_cvt_pk_bf16_f32 v144, v112, v113
    v_cvt_pk_bf16_f32 v145, v114, v115
    v_cvt_pk_bf16_f32 v146, v116, v117
    v_cvt_pk_bf16_f32 v147, v118, v119
    v_cvt_pk_bf16_f32 v148, v120, v121
    v_cvt_pk_bf16_f32 v149, v122, v123
    v_cvt_pk_bf16_f32 v150, v124, v125
    v_cvt_pk_bf16_f32 v151, v126, v127
    v_cndmask_b32 v144, v144, v238, s[68:69]
    v_cndmask_b32 v145, v145, v238, s[68:69]
    v_cndmask_b32 v146, v146, v238, s[68:69]
    v_cndmask_b32 v147, v147, v238, s[68:69]
    v_cndmask_b32 v148, v148, v238, s[68:69]
    v_cndmask_b32 v149, v149, v238, s[68:69]
    v_cndmask_b32 v150, v150, v238, s[68:69]
    v_cndmask_b32 v151, v151, v238, s[68:69]
    s_lshl_b32 s60, s26, 1
    s_and_b32 s61, s3, 1
    s_add_u32 s60, s60, s61
    s_lshl_b32 s60, s60, 8
    s_lshl_b32 s61, s27, 2
    s_lshr_b32 s62, s3, 1
    s_add_u32 s61, s61, s62
    s_lshl_b32 s61, s61, 2
    s_add_u32 s60, s60, s61
    s_add_u32 s60, s60, 0x1100000
    s_waitcnt vmcnt(0)
    buffer_store_dword v241, v242, s[44:47], s60 offen sc1
    v_max3_f32 v208, v128, v129, v130
    v_min3_f32 v209, v128, v129, v130
    v_max3_f32 v208, v208, v131, v132
    v_min3_f32 v209, v209, v131, v132
    v_max3_f32 v208, v208, v133, v134
    v_min3_f32 v209, v209, v133, v134
    v_max3_f32 v208, v208, v135, v136
    v_min3_f32 v209, v209, v135, v136
    v_max3_f32 v208, v208, v137, v138
    v_min3_f32 v209, v209, v137, v138
    v_max3_f32 v208, v208, v139, v140
    v_min3_f32 v209, v209, v139, v140
    v_max3_f32 v208, v208, v141, v142
    v_min3_f32 v209, v209, v141, v142
    v_max_f32 v208, v208, v143
    v_min_f32 v209, v209, v143
    v_mov_b32 v210, v208
    v_mov_b32 v211, v209
    s_nop 0
    v_permlane32_swap_b32 v208, v210
    v_permlane32_swap_b32 v209, v211
    v_max_f32 v208, v208, v210
    v_min_f32 v209, v209, v211
    v_mul_f32 v208, s67, v208
    v_mul_f32 v209, s67, v209
    v_mov_b32 v210, s67
    v_pk_fma_f32 v[96:97], v[128:129], v[210:211], v[208:209] op_sel:[0,0,1] op_sel_hi:[1,0,1] neg_lo:[1,0,0] neg_hi:[1,0,0]
    v_pk_fma_f32 v[98:99], v[130:131], v[210:211], v[208:209] op_sel:[0,0,1] op_sel_hi:[1,0,1] neg_lo:[1,0,0] neg_hi:[1,0,0]
    v_pk_fma_f32 v[100:101], v[132:133], v[210:211], v[208:209] op_sel:[0,0,1] op_sel_hi:[1,0,1] neg_lo:[1,0,0] neg_hi:[1,0,0]
    v_pk_fma_f32 v[102:103], v[134:135], v[210:211], v[208:209] op_sel:[0,0,1] op_sel_hi:[1,0,1] neg_lo:[1,0,0] neg_hi:[1,0,0]
    v_pk_fma_f32 v[104:105], v[136:137], v[210:211], v[208:209] op_sel:[0,0,1] op_sel_hi:[1,0,1] neg_lo:[1,0,0] neg_hi:[1,0,0]
    v_pk_fma_f32 v[106:107], v[138:139], v[210:211], v[208:209] op_sel:[0,0,1] op_sel_hi:[1,0,1] neg_lo:[1,0,0] neg_hi:[1,0,0]
    v_pk_fma_f32 v[108:109], v[140:141], v[210:211], v[208:209] op_sel:[0,0,1] op_sel_hi:[1,0,1] neg_lo:[1,0,0] neg_hi:[1,0,0]
    v_pk_fma_f32 v[110:111], v[142:143], v[210:211], v[208:209] op_sel:[0,0,1] op_sel_hi:[1,0,1] neg_lo:[1,0,0] neg_hi:[1,0,0]
    v_pk_fma_f32 v[128:129], v[128:129], v[210:211], v[208:209] op_sel_hi:[1,0,0] neg_lo:[0,0,1] neg_hi:[0,0,1]
    v_pk_fma_f32 v[130:131], v[130:131], v[210:211], v[208:209] op_sel_hi:[1,0,0] neg_lo:[0,0,1] neg_hi:[0,0,1]
    v_pk_fma_f32 v[132:133], v[132:133], v[210:211], v[208:209] op_sel_hi:[1,0,0] neg_lo:[0,0,1] neg_hi:[0,0,1]
    v_pk_fma_f32 v[134:135], v[134:135], v[210:211], v[208:209] op_sel_hi:[1,0,0] neg_lo:[0,0,1] neg_hi:[0,0,1]
    v_pk_fma_f32 v[136:137], v[136:137], v[210:211], v[208:209] op_sel_hi:[1,0,0] neg_lo:[0,0,1] neg_hi:[0,0,1]
    v_pk_fma_f32 v[138:139], v[138:139], v[210:211], v[208:209] op_sel_hi:[1,0,0] neg_lo:[0,0,1] neg_hi:[0,0,1]
    v_pk_fma_f32 v[140:141], v[140:141], v[210:211], v[208:209] op_sel_hi:[1,0,0] neg_lo:[0,0,1] neg_hi:[0,0,1]
    v_pk_fma_f32 v[142:143], v[142:143], v[210:211], v[208:209] op_sel_hi:[1,0,0] neg_lo:[0,0,1] neg_hi:[0,0,1]
    v_exp_f32 v96, v96
    v_exp_f32 v97, v97
    v_exp_f32 v98, v98
    v_exp_f32 v99, v99
    v_exp_f32 v100, v100
    v_exp_f32 v101, v101
    v_exp_f32 v102, v102
    v_exp_f32 v103, v103
    v_exp_f32 v104, v104
    v_exp_f32 v105, v105
    v_exp_f32 v106, v106
    v_exp_f32 v107, v107
    v_exp_f32 v108, v108
    v_exp_f32 v109, v109
    v_exp_f32 v110, v110
    v_exp_f32 v111, v111
    v_exp_f32 v128, v128
    v_exp_f32 v129, v129
    v_exp_f32 v130, v130
    v_exp_f32 v131, v131
    v_exp_f32 v132, v132
    v_exp_f32 v133, v133
    v_exp_f32 v134, v134
    v_exp_f32 v135, v135
    v_exp_f32 v136, v136
    v_exp_f32 v137, v137
    v_exp_f32 v138, v138
    v_exp_f32 v139, v139
    v_exp_f32 v140, v140
    v_exp_f32 v141, v141
    v_exp_f32 v142, v142
    v_exp_f32 v143, v143
    v_add_f32 v213, v96, v97
    v_add_f32 v215, v98, v99
    v_add_f32 v212, v128, v129
    v_add_f32 v214, v130, v131
    v_add_f32 v213, v213, v100
    v_add_f32 v215, v215, v101
    v_add_f32 v212, v212, v132
    v_add_f32 v214, v214, v133
    v_add_f32 v213, v213, v102
    v_add_f32 v215, v215, v103
    v_add_f32 v212, v212, v134
    v_add_f32 v214, v214, v135
    v_add_f32 v213, v213, v104
    v_add_f32 v215, v215, v105
    v_add_f32 v212, v212, v136
    v_add_f32 v214, v214, v137
    v_add_f32 v213, v213, v106
    v_add_f32 v215, v215, v107
    v_add_f32 v212, v212, v138
    v_add_f32 v214, v214, v139
    v_fmac_f32 v213, v108, v232
    v_fmac_f32 v215, v109, v232
    v_fmac_f32 v212, v140, v232
    v_fmac_f32 v214, v141, v232
    v_fmac_f32 v213, v110, v232
    v_fmac_f32 v215, v111, v232
    v_fmac_f32 v212, v142, v232
    v_fmac_f32 v214, v143, v232
    v_add_f32 v212, v212, v214
    v_add_f32 v213, v213, v215
    v_mov_b32 v210, v212
    v_mov_b32 v211, v213
    s_nop 0
    v_permlane32_swap_b32 v212, v210
    v_permlane32_swap_b32 v213, v211
    v_add_f32 v212, v212, v210
    v_add_f32 v213, v213, v211
    v_rcp_f32 v212, v212
    v_rcp_f32 v213, v213
    s_nop 0
    v_pk_mul_f32 v[128:129], v[128:129], v[212:213] op_sel_hi:[1,0]
    v_pk_mul_f32 v[130:131], v[130:131], v[212:213] op_sel_hi:[1,0]
    v_pk_mul_f32 v[132:133], v[132:133], v[212:213] op_sel_hi:[1,0]
    v_pk_mul_f32 v[134:135], v[134:135], v[212:213] op_sel_hi:[1,0]
    v_pk_mul_f32 v[136:137], v[136:137], v[212:213] op_sel_hi:[1,0]
    v_pk_mul_f32 v[138:139], v[138:139], v[212:213] op_sel_hi:[1,0]
    v_pk_mul_f32 v[140:141], v[140:141], v[212:213] op_sel_hi:[1,0]
    v_pk_mul_f32 v[142:143], v[142:143], v[212:213] op_sel_hi:[1,0]
    v_pk_mul_f32 v[96:97], v[96:97], v[212:213] op_sel:[0,1] op_sel_hi:[1,1]
    v_pk_mul_f32 v[98:99], v[98:99], v[212:213] op_sel:[0,1] op_sel_hi:[1,1]
    v_pk_mul_f32 v[100:101], v[100:101], v[212:213] op_sel:[0,1] op_sel_hi:[1,1]
    v_pk_mul_f32 v[102:103], v[102:103], v[212:213] op_sel:[0,1] op_sel_hi:[1,1]
    v_pk_mul_f32 v[104:105], v[104:105], v[212:213] op_sel:[0,1] op_sel_hi:[1,1]
    v_pk_mul_f32 v[106:107], v[106:107], v[212:213] op_sel:[0,1] op_sel_hi:[1,1]
    v_pk_mul_f32 v[108:109], v[108:109], v[212:213] op_sel:[0,1] op_sel_hi:[1,1]
    v_pk_mul_f32 v[110:111], v[110:111], v[212:213] op_sel:[0,1] op_sel_hi:[1,1]
    v_cvt_pk_bf16_f32 v200, v128, v129
    v_cvt_pk_bf16_f32 v201, v130, v131
    v_cvt_pk_bf16_f32 v202, v132, v133
    v_cvt_pk_bf16_f32 v203, v134, v135
    v_cvt_pk_bf16_f32 v204, v136, v137
    v_cvt_pk_bf16_f32 v205, v138, v139
    v_cvt_pk_bf16_f32 v206, v140, v141
    v_cvt_pk_bf16_f32 v207, v142, v143
    v_cvt_pk_bf16_f32 v152, v96, v97
    v_cvt_pk_bf16_f32 v153, v98, v99
    v_cvt_pk_bf16_f32 v154, v100, v101
    v_cvt_pk_bf16_f32 v155, v102, v103
    v_cvt_pk_bf16_f32 v156, v104, v105
    v_cvt_pk_bf16_f32 v157, v106, v107
    v_cvt_pk_bf16_f32 v158, v108, v109
    v_cvt_pk_bf16_f32 v159, v110, v111
    v_mfma_f32_32x32x16_bf16 v[96:111], v[200:203], v[32:35], 0
    v_mfma_f32_32x32x16_bf16 v[96:111], v[204:207], v[36:39], v[96:111]
    v_mfma_f32_32x32x16_bf16 v[128:143], v[152:155], v[32:35], 0
    v_mfma_f32_32x32x16_bf16 v[128:143], v[156:159], v[36:39], v[128:143]
    s_setprio 3
    v_lshlrev_b32 v239, 2, v0
    s_nop 7
    s_nop 0
    v_cvt_pk_bf16_f32 v200, v96, v97
    v_cvt_pk_bf16_f32 v201, v98, v99
    v_cvt_pk_bf16_f32 v202, v100, v101
    v_cvt_pk_bf16_f32 v203, v102, v103
    v_cvt_pk_bf16_f32 v204, v104, v105
    v_cvt_pk_bf16_f32 v205, v106, v107
    v_cvt_pk_bf16_f32 v206, v108, v109
    v_cvt_pk_bf16_f32 v207, v110, v111
    v_cvt_pk_bf16_f32 v208, v128, v129
    v_cvt_pk_bf16_f32 v209, v130, v131
    v_cvt_pk_bf16_f32 v210, v132, v133
    v_cvt_pk_bf16_f32 v211, v134, v135
    v_cvt_pk_bf16_f32 v212, v136, v137
    v_cvt_pk_bf16_f32 v213, v138, v139
    v_cvt_pk_bf16_f32 v214, v140, v141
    v_cvt_pk_bf16_f32 v215, v142, v143
    v_mfma_f32_32x32x16_bf16 v[96:111], v[200:203], v[144:147], 0
    v_mfma_f32_32x32x16_bf16 v[96:111], v[204:207], v[148:151], v[96:111]
    v_mfma_f32_32x32x16_bf16 v[128:143], v[208:211], v[144:147], 0
    v_mfma_f32_32x32x16_bf16 v[128:143], v[212:215], v[148:151], v[128:143]
    s_lshl_b32 s60, s3, 13
    s_add_u32 s60, s60, 0x16000
    v_add_u32 v238, s60, v227
    v_mov_b32 v1, 0x26000
    v_mov_b32 v2, 1
    s_nop 4
    ds_write_b128 v238, v[96:99] offset:0
    ds_write_b128 v238, v[100:103] offset:1024
    ds_write_b128 v238, v[104:107] offset:2048
    ds_write_b128 v238, v[108:111] offset:3072
    ds_write_b128 v238, v[128:131] offset:4096
    ds_write_b128 v238, v[132:135] offset:5120
    ds_write_b128 v238, v[136:139] offset:6144
    ds_write_b128 v238, v[140:143] offset:7168
    s_waitcnt lgkmcnt(0)
    s_mov_b64 exec, 1
    ds_add_u32 v1, v2
    s_mov_b64 exec, -1
    s_mov_b32 s61, 0
K1_Q_LSPIN:
    ds_read_b32 v3, v1
    s_add_u32 s61, s61, 1
    s_lshr_b32 s62, s61, 18
    s_waitcnt lgkmcnt(0)
    s_nop 1
    v_readfirstlane_b32 s60, v3
    s_nop 3
    s_or_b32 s60, s60, s62
    s_cmp_lt_u32 s60, 4
    s_cbranch_scc1 K1_Q_LSPIN
    s_lshl_b32 s60, s3, 11
    s_sub_u32 s60, s60, 0x2000
    s_add_u32 s77, s73, s60
    s_add_u32 s60, s60, 0x1e000
    v_add_u32 v1, s60, v239
    ds_read2st64_b32 v[128:129], v1 offset0:0 offset1:32
    ds_read2st64_b32 v[130:131], v1 offset0:64 offset1:96
    ds_read2st64_b32 v[132:133], v1 offset0:1 offset1:33
    ds_read2st64_b32 v[134:135], v1 offset0:65 offset1:97
    ds_read2st64_b32 v[136:137], v1 offset0:2 offset1:34
    ds_read2st64_b32 v[138:139], v1 offset0:66 offset1:98
    ds_read2st64_b32 v[140:141], v1 offset0:3 offset1:35
    ds_read2st64_b32 v[142:143], v1 offset0:67 offset1:99
    ds_read2st64_b32 v[144:145], v1 offset0:4 offset1:36
    ds_read2st64_b32 v[146:147], v1 offset0:68 offset1:100
    ds_read2st64_b32 v[148:149], v1 offset0:5 offset1:37
    ds_read2st64_b32 v[150:151], v1 offset0:69 offset1:101
    ds_read2st64_b32 v[152:153], v1 offset0:6 offset1:38
    ds_read2st64_b32 v[154:155], v1 offset0:70 offset1:102
    ds_read2st64_b32 v[156:157], v1 offset0:7 offset1:39
    ds_read2st64_b32 v[158:159], v1 offset0:71 offset1:103
    s_waitcnt lgkmcnt(15)
    v_add_f32 v128, v128, v129
    s_waitcnt lgkmcnt(14)
    v_add_f32 v130, v130, v131
    v_add_f32_e64 v128, v128, v130
    buffer_atomic_add_f32 v128, v239, s[44:47], s77 offen offset:0
    s_waitcnt lgkmcnt(13)
    v_add_f32 v132, v132, v133
    s_waitcnt lgkmcnt(12)
    v_add_f32 v134, v134, v135
    v_add_f32_e64 v132, v132, v134
    buffer_atomic_add_f32 v132, v239, s[44:47], s77 offen offset:256
    s_waitcnt lgkmcnt(11)
    v_add_f32 v136, v136, v137
    s_waitcnt lgkmcnt(10)
    v_add_f32 v138, v138, v139
    v_add_f32_e64 v136, v136, v138
    buffer_atomic_add_f32 v136, v239, s[44:47], s77 offen offset:512
    s_waitcnt lgkmcnt(9)
    v_add_f32 v140, v140, v141
    s_waitcnt lgkmcnt(8)
    v_add_f32 v142, v142, v143
    v_add_f32_e64 v140, v140, v142
    buffer_atomic_add_f32 v140, v239, s[44:47], s77 offen offset:768
    s_waitcnt lgkmcnt(7)
    v_add_f32 v144, v144, v145
    s_waitcnt lgkmcnt(6)
    v_add_f32 v146, v146, v147
    v_add_f32_e64 v144, v144, v146
    buffer_atomic_add_f32 v144, v239, s[44:47], s77 offen offset:1024
    s_waitcnt lgkmcnt(5)
    v_add_f32 v148, v148, v149
    s_waitcnt lgkmcnt(4)
    v_add_f32 v150, v150, v151
    v_add_f32_e64 v148, v148, v150
    buffer_atomic_add_f32 v148, v239, s[44:47], s77 offen offset:1280
    s_waitcnt lgkmcnt(3)
    v_add_f32 v152, v152, v153
    s_waitcnt lgkmcnt(2)
    v_add_f32 v154, v154, v155
    v_add_f32_e64 v152, v152, v154
    buffer_atomic_add_f32 v152, v239, s[44:47], s77 offen offset:1536
    s_waitcnt lgkmcnt(1)
    v_add_f32 v156, v156, v157
    s_waitcnt lgkmcnt(0)
    v_add_f32 v158, v158, v159
    v_add_f32_e64 v156, v156, v158
    buffer_atomic_add_f32 v156, v239, s[44:47], s77 offen offset:1792
    s_lshl_b32 s65, s26, 2
    s_add_u32 s65, s65, s3
    s_sub_u32 s65, s65, 4
    s_lshl_b32 s64, s27, 8
    s_add_u32 s64, s64, 0x1102000
    s_lshl_b32 s60, s65, 2
    s_add_u32 s60, s60, s64
    s_waitcnt vmcnt(0)
    buffer_store_dword v241, v242, s[44:47], s60 offen sc1
    s_lshr_b32 s66, s65, 1
    s_lshl_b32 s66, s66, 8
    s_lshr_b32 s60, s27, 3
    s_lshl_b32 s60, s60, 4
    s_add_u32 s66, s66, s60
    s_add_u32 s66, s66, 0x11000e0
    v_and_b32 v1, 12, v239
    s_mov_b32 s61, 0
SP_Q_Q1:
    buffer_load_dword v2, v1, s[44:47], s66 offen sc1
    s_add_u32 s61, s61, 1
    s_cmp_gt_u32 s61, 0x20000
    s_cbranch_scc1 SP_Q_Q1_OK
    s_waitcnt vmcnt(0)
    v_cmp_ne_u32 vcc, 1, v2
    s_nop 4
    s_cbranch_vccz SP_Q_Q1_OK
    s_sleep 8
    s_branch SP_Q_Q1
SP_Q_Q1_OK:
    s_lshl_b32 s60, s65, 15
    s_lshl_b32 s61, s27, 11
    s_add_u32 s60, s60, s61
    s_nop 0
    s_add_u32 s60, s60, 0xc00000
    buffer_load_dwordx4 v[8:11], v227, s[44:47], s60 offen offset:0 sc1
    buffer_load_dwordx4 v[12:15], v227, s[44:47], s60 offen offset:1024 sc1
    s_waitcnt vmcnt(1)
    v_mfma_f32_32x32x16_bf16 v[96:111], v[244:247], v[8:11], 0
    s_waitcnt vmcnt(0)
    v_mfma_f32_32x32x16_bf16 v[96:111], v[248:251], v[12:15], v[96:111]
    s_nop 11
    s_nop 0
    v_max3_f32 v16, v96, v97, v98
    v_min3_f32 v17, v96, v97, v98
    v_max3_f32 v16, v16, v99, v100
    v_min3_f32 v17, v17, v99, v100
    v_max3_f32 v16, v16, v101, v102
    v_min3_f32 v17, v17, v101, v102
    v_max3_f32 v16, v16, v103, v104
    v_min3_f32 v17, v17, v103, v104
    v_max3_f32 v16, v16, v105, v106
    v_min3_f32 v17, v17, v105, v106
    v_max3_f32 v16, v16, v107, v108
    v_min3_f32 v17, v17, v107, v108
    v_max3_f32 v16, v16, v109, v110
    v_min3_f32 v17, v17, v109, v110
    v_max_f32 v16, v16, v111
    v_min_f32 v17, v17, v111
    v_mov_b32 v18, v16
    v_mov_b32 v19, v17
    s_nop 0
    v_permlane32_swap_b32 v16, v18
    v_permlane32_swap_b32 v17, v19
    v_max_f32 v16, v16, v18
    v_min_f32 v17, v17, v19
    v_mul_f32 v16, s67, v16
    v_mul_f32_e64 v17, s67, v17
    v_fma_f32 v112, -v96, s67, v17
    v_fma_f32 v113, -v97, s67, v17
    v_fma_f32 v114, -v98, s67, v17
    v_fma_f32 v115, -v99, s67, v17
    v_fma_f32 v116, -v100, s67, v17
    v_fma_f32 v117, -v101, s67, v17
    v_fma_f32 v118, -v102, s67, v17
    v_fma_f32 v119, -v103, s67, v17
    v_fma_f32 v120, -v104, s67, v17
    v_fma_f32 v121, -v105, s67, v17
    v_fma_f32 v122, -v106, s67, v17
    v_fma_f32 v123, -v107, s67, v17
    v_fma_f32 v124, -v108, s67, v17
    v_fma_f32 v125, -v109, s67, v17
    v_fma_f32 v126, -v110, s67, v17
    v_fma_f32 v127, -v111, s67, v17
    v_fma_f32 v96, v96, s67, -v16
    v_fma_f32 v97, v97, s67, -v16
    v_fma_f32 v98, v98, s67, -v16
    v_fma_f32 v99, v99, s67, -v16
    v_fma_f32 v100, v100, s67, -v16
    v_fma_f32 v101, v101, s67, -v16
    v_fma_f32 v102, v102, s67, -v16
    v_fma_f32 v103, v103, s67, -v16
    v_fma_f32 v104, v104, s67, -v16
    v_fma_f32 v105, v105, s67, -v16
    v_fma_f32 v106, v106, s67, -v16
    v_fma_f32 v107, v107, s67, -v16
    v_fma_f32 v108, v108, s67, -v16
    v_fma_f32 v109, v109, s67, -v16
    v_fma_f32 v110, v110, s67, -v16
    v_fma_f32 v111, v111, s67, -v16
    v_exp_f32 v112, v112
    v_exp_f32 v113, v113
    v_exp_f32 v114, v114
    v_exp_f32 v115, v115
    v_exp_f32 v116, v116
    v_exp_f32 v117, v117
    v_exp_f32 v118, v118
    v_exp_f32 v119, v119
    v_exp_f32 v120, v120
    v_exp_f32 v121, v121
    v_exp_f32 v122, v122
    v_exp_f32 v123, v123
    v_exp_f32 v124, v124
    v_exp_f32 v125, v125
    v_exp_f32 v126, v126
    v_exp_f32 v127, v127
    v_exp_f32 v96, v96
    v_exp_f32 v97, v97
    v_exp_f32 v98, v98
    v_exp_f32 v99, v99
    v_exp_f32 v100, v100
    v_exp_f32 v101, v101
    v_exp_f32 v102, v102
    v_exp_f32 v103, v103
    v_exp_f32 v104, v104
    v_exp_f32 v105, v105
    v_exp_f32 v106, v106
    v_exp_f32 v107, v107
    v_exp_f32 v108, v108
    v_exp_f32 v109, v109
    v_exp_f32 v110, v110
    v_exp_f32 v111, v111
    v_add_f32 v21, v112, v113
    v_add_f32 v23, v114, v115
    v_add_f32 v20, v96, v97
    v_add_f32 v22, v98, v99
    v_add_f32 v21, v21, v116
    v_add_f32 v23, v23, v117
    v_add_f32 v20, v20, v100
    v_add_f32 v22, v22, v101
    v_add_f32 v21, v21, v118
    v_add_f32 v23, v23, v119
    v_add_f32 v20, v20, v102
    v_add_f32 v22, v22, v103
    v_add_f32 v21, v21, v120
    v_add_f32 v23, v23, v121
    v_add_f32 v20, v20, v104
    v_add_f32 v22, v22, v105
    v_add_f32 v21, v21, v122
    v_add_f32 v23, v23, v123
    v_add_f32 v20, v20, v106
    v_add_f32 v22, v22, v107
    v_fmac_f32 v21, v124, v232
    v_fmac_f32 v23, v125, v232
    v_fmac_f32 v20, v108, v232
    v_fmac_f32 v22, v109, v232
    v_fmac_f32 v21, v126, v232
    v_fmac_f32 v23, v127, v232
    v_fmac_f32 v20, v110, v232
    v_fmac_f32 v22, v111, v232
    v_add_f32 v20, v20, v22
    v_add_f32 v21, v21, v23
    v_mov_b32 v18, v20
    v_mov_b32 v19, v21
    s_nop 0
    v_permlane32_swap_b32 v20, v18
    v_permlane32_swap_b32 v21, v19
    v_add_f32 v20, v20, v18
    v_add_f32 v21, v21, v19
    v_rcp_f32 v20, v20
    v_rcp_f32 v21, v21
    v_mul_f32 v96, v96, v20
    v_mul_f32 v97, v97, v20
    v_mul_f32 v98, v98, v20
    v_mul_f32 v99, v99, v20
    v_mul_f32 v100, v100, v20
    v_mul_f32 v101, v101, v20
    v_mul_f32 v102, v102, v20
    v_mul_f32 v103, v103, v20
    v_mul_f32 v104, v104, v20
    v_mul_f32 v105, v105, v20
    v_mul_f32 v106, v106, v20
    v_mul_f32 v107, v107, v20
    v_mul_f32 v108, v108, v20
    v_mul_f32 v109, v109, v20
    v_mul_f32 v110, v110, v20
    v_mul_f32 v111, v111, v20
    v_mul_f32 v112, v112, v21
    v_mul_f32 v113, v113, v21
    v_mul_f32 v114, v114, v21
    v_mul_f32 v115, v115, v21
    v_mul_f32 v116, v116, v21
    v_mul_f32 v117, v117, v21
    v_mul_f32 v118, v118, v21
    v_mul_f32 v119, v119, v21
    v_mul_f32 v120, v120, v21
    v_mul_f32 v121, v121, v21
    v_mul_f32 v122, v122, v21
    v_mul_f32 v123, v123, v21
    v_mul_f32 v124, v124, v21
    v_mul_f32 v125, v125, v21
    v_mul_f32 v126, v126, v21
    v_mul_f32_e64 v127, v127, v21
    v_cvt_pk_bf16_f32 v24, v96, v97
    v_cvt_pk_bf16_f32 v25, v98, v99
    v_cvt_pk_bf16_f32 v26, v100, v101
    v_cvt_pk_bf16_f32 v27, v102, v103
    v_cvt_pk_bf16_f32 v28, v104, v105
    v_cvt_pk_bf16_f32 v29, v106, v107
    v_cvt_pk_bf16_f32 v30, v108, v109
    v_cvt_pk_bf16_f32 v31, v110, v111
    v_cvt_pk_bf16_f32 v32, v112, v113
    v_cvt_pk_bf16_f32 v33, v114, v115
    v_cvt_pk_bf16_f32 v34, v116, v117
    v_cvt_pk_bf16_f32 v35, v118, v119
    v_cvt_pk_bf16_f32 v36, v120, v121
    v_cvt_pk_bf16_f32 v37, v122, v123
    v_cvt_pk_bf16_f32 v38, v124, v125
    v_cvt_pk_bf16_f32 v39, v126, v127
    s_mov_b32 s61, 0
SP_K_Q1:
    buffer_load_dword v2, v239, s[44:47], s64 offen sc1
    s_add_u32 s61, s61, 1
    s_cmp_gt_u32 s61, 0x20000
    s_cbranch_scc1 SP_K_Q1_OK
    s_waitcnt vmcnt(0)
    v_cmp_ne_u32 vcc, 1, v2
    s_nop 4
    s_cbranch_vccz SP_K_Q1_OK
    s_sleep 8
    s_branch SP_K_Q1
SP_K_Q1_OK:
    s_nop 0
    s_add_u32 s61, s73, 0x1000
    buffer_load_dwordx4 v[64:67], v227, s[44:47], s73 offen offset:0 sc1
    buffer_load_dwordx4 v[68:71], v227, s[44:47], s73 offen offset:1024 sc1
    buffer_load_dwordx4 v[72:75], v227, s[44:47], s73 offen offset:2048 sc1
    buffer_load_dwordx4 v[76:79], v227, s[44:47], s73 offen offset:3072 sc1
    buffer_load_dwordx4 v[80:83], v227, s[44:47], s61 offen offset:0 sc1
    buffer_load_dwordx4 v[84:87], v227, s[44:47], s61 offen offset:1024 sc1
    buffer_load_dwordx4 v[88:91], v227, s[44:47], s61 offen offset:2048 sc1
    buffer_load_dwordx4 v[92:95], v227, s[44:47], s61 offen offset:3072 sc1
    s_waitcnt vmcnt(4)
    v_mul_f32 v76, v76, v232
    v_mul_f32 v77, v77, v232
    v_mul_f32 v78, v78, v232
    v_mul_f32 v79, v79, v232
    s_waitcnt vmcnt(0)
    v_mul_f32 v92, v92, v232
    v_mul_f32 v93, v93, v232
    v_mul_f32 v94, v94, v232
    v_mul_f32 v95, v95, v232
    v_cvt_pk_bf16_f32 v40, v64, v65
    v_cvt_pk_bf16_f32 v41, v66, v67
    v_cvt_pk_bf16_f32 v42, v68, v69
    v_cvt_pk_bf16_f32 v43, v70, v71
    v_cvt_pk_bf16_f32 v44, v72, v73
    v_cvt_pk_bf16_f32 v45, v74, v75
    v_cvt_pk_bf16_f32 v46, v76, v77
    v_cvt_pk_bf16_f32 v47, v78, v79
    v_cvt_pk_bf16_f32 v48, v80, v81
    v_cvt_pk_bf16_f32 v49, v82, v83
    v_cvt_pk_bf16_f32 v50, v84, v85
    v_cvt_pk_bf16_f32 v51, v86, v87
    v_cvt_pk_bf16_f32 v52, v88, v89
    v_cvt_pk_bf16_f32 v53, v90, v91
    v_cvt_pk_bf16_f32 v54, v92, v93
    v_cvt_pk_bf16_f32 v55, v94, v95
    v_mfma_f32_32x32x16_bf16 v[96:111], v[40:43], v[24:27], 0
    v_mfma_f32_32x32x16_bf16 v[96:111], v[44:47], v[28:31], v[96:111]
    v_mfma_f32_32x32x16_bf16 v[96:111], v[48:51], v[32:35], v[96:111]
    v_mfma_f32_32x32x16_bf16 v[96:111], v[52:55], v[36:39], v[96:111]
    s_mul_i32 s60, s65, 0x24000
    s_lshl_b32 s62, s27, 11
    s_add_u32 s60, s60, s62
    s_add_u32 s60, s60, 0x1c000
    s_lshl_b32 s61, s65, 6
    s_lshl_b32 s62, s27, 2
    s_add_u32 s61, s61, s62
    s_add_u32 s61, s61, 0x1103000
    s_nop 3
    v_mov_b32 v16, v108
    v_mov_b32 v17, v108
    s_nop 1
    v_permlane32_swap_b32 v16, v17
    v_add_f32 v17, 0x358637bd, v17
    v_rcp_f32 v17, v17
    s_nop 0
    v_mul_f32 v96, v96, v17
    v_mul_f32 v97, v97, v17
    v_mul_f32 v98, v98, v17
    v_mul_f32 v99, v99, v17
    v_mul_f32 v100, v100, v17
    v_mul_f32 v101, v101, v17
    v_mul_f32 v102, v102, v17
    v_mul_f32 v103, v103, v17
    v_mul_f32 v104, v104, v17
    v_mul_f32 v105, v105, v17
    v_mul_f32 v106, v106, v17
    v_mul_f32 v107, v107, v17
    v_mul_f32 v108, v108, v17
    v_mul_f32 v109, v109, v17
    v_mul_f32 v110, v110, v17
    v_mul_f32 v111, v111, v17
    v_cvt_pk_bf16_f32 v8, v96, v97
    v_cvt_pk_bf16_f32 v9, v98, v99
    v_cvt_pk_bf16_f32 v10, v100, v101
    v_cvt_pk_bf16_f32 v11, v102, v103
    v_cvt_pk_bf16_f32 v12, v104, v105
    v_cvt_pk_bf16_f32 v13, v106, v107
    v_cvt_pk_bf16_f32 v14, v108, v109
    v_cvt_pk_bf16_f32 v15, v110, v111
    buffer_store_dwordx4 v[8:11], v227, s[44:47], s60 offen offset:0 sc1
    buffer_store_dwordx4 v[12:15], v227, s[44:47], s60 offen offset:1024 sc1
    s_waitcnt vmcnt(0)
    buffer_store_dword v241, v242, s[44:47], s61 offen sc1
    s_endpgm
K1_END:
    s_endpgm
CODE_END:
    s_endpgm
.section .rodata,"a"
.p2align 6
.amdhsa_kernel parallel_sum__linear_kernel_hedgehog__geglu_ffn__prompt_kernel
  .amdhsa_next_free_vgpr 256
  .amdhsa_next_free_sgpr 102
  .amdhsa_accum_offset 256
  .amdhsa_group_segment_fixed_size 0
  .amdhsa_kernarg_size 88
  .amdhsa_user_sgpr_count 2
  .amdhsa_user_sgpr_kernarg_segment_ptr 1
  .amdhsa_system_sgpr_workgroup_id_x 1
.end_amdhsa_kernel
```
